```python
import torch

def _softmax(x, axis=-1):
    return torch.softmax(x, dim=axis)
def _gelu(x):
    return torch.nn.functional.gelu(x, approximate="tanh")
def _silu(x):
    return torch.nn.functional.silu(x)
def _sigmoid(x):
    return torch.sigmoid(x)
def _layernorm(x, axis=-1, eps=1e-5):
    m = x.mean(dim=axis, keepdim=True)
    v = x.var(dim=axis, keepdim=True, unbiased=False)
    return (x - m) / torch.sqrt(v + eps)
def _scatter_add(tgt, idx, src, axis=0):
    return tgt.clone().index_add_(axis, idx, src)
def _segment_sum(src, seg, n):
    out = torch.zeros((n,) + src.shape[1:], dtype=src.dtype)
    return out.index_add_(0, seg, src)
def _pad(x, pw):
    flat = tuple(v for pair in reversed(pw) for v in pair)
    return torch.nn.functional.pad(x, flat)

kernel_name = 'interleave_layers__spectral_gfnet__mha_block__prompt'

def setup_inputs():

    _w = (lambda a: (lambda t: t.to(torch.bfloat16) if t.is_floating_point() else t)(torch.as_tensor(a)))
    def _A_setup():
        B, S, D = 1, 2048, 640
        Df = D // 2 + 1
        return {
            "x": _w((lambda *s: torch.randn(*s, dtype=torch.bfloat16) * 0.05)(B, S, D)),
            "w_r": _w((lambda *s: torch.randn(*s, dtype=torch.bfloat16) * 1.6)(S, Df) * 0.02),
            "w_i": _w((lambda *s: torch.randn(*s, dtype=torch.bfloat16) * 1.6)(S, Df) * 0.02),
        }
    _A_in = _A_setup()

    def _B_setup():
        B, S, D, H = 1, 2048, 640, 32
        return {
            "x": _w((lambda *s: torch.randn(*s, dtype=torch.bfloat16) * 0.05)(B, S, D)),
            "wqkv": _w((lambda *s: torch.randn(*s, dtype=torch.bfloat16) * 0.05)(D, 3 * D)),
            "wo": _w((lambda *s: torch.randn(*s, dtype=torch.bfloat16) * 0.05)(D, D)),
        }
    _B_in = _B_setup()

    return {
        "A_x": _A_in["x"],
        "A_w_r": _A_in["w_r"],
        "A_w_i": _A_in["w_i"],
        "B_x": _B_in["x"],
        "B_wqkv": _B_in["wqkv"],
        "B_wo": _B_in["wo"],
    }

def reference(A_x, A_w_r, A_w_i, B_x, B_wqkv, B_wo):
    def _A_ref(x, w_r, w_i):
        B, S, D = x.shape
        X = (lambda x, axes=(-2,-1): torch.fft.rfft2(x.float(), dim=axes))(x, axes=(-2, -1))
        W = w_r + 1j * w_i
        X = X * W
        y = (lambda x, s, axes=(-2,-1): torch.fft.irfft2(x, s=s, dim=axes).to(torch.bfloat16))(X, (S, D), axes=(-2, -1))
        return y

    def _B_ref(x, wqkv, wo):
        B, S, D = x.shape
        H = 32
        Dh = D // H
        qkv = (lambda x, *d: x.permute(*d))((x @ wqkv).reshape(B, S, 3, H, Dh), 2, 0, 3, 1, 4)
        q, k, v = qkv[0], qkv[1], qkv[2]
        scores = torch.einsum("bhqd,bhkd->bhqk", q, k) * (Dh ** -0.5)
        p = _softmax(scores, axis=-1)
        o = torch.einsum("bhqk,bhkd->bhqd", p, v)
        return (lambda x, *d: x.permute(*d))(o, 0, 2, 1, 3).reshape(B, S, D) @ wo

    x = A_x
    x = x + _A_ref(_layernorm(x, axis=-1), A_w_r, A_w_i)
    x = x + _B_ref(_layernorm(x, axis=-1), B_wqkv, B_wo)
    x = x + _A_ref(_layernorm(x, axis=-1), A_w_r, A_w_i)
    x = x + _B_ref(_layernorm(x, axis=-1), B_wqkv, B_wo)
    return x
```

```asm
; @launch grid=(256,1,1) block=(512,1,1) lds=163840
.amdgcn_target "amdgcn-amd-amdhsa--gfx950"
.text
.globl interleave_layers__spectral_gfnet__mha_block__prompt_kernel
.p2align 8
.type interleave_layers__spectral_gfnet__mha_block__prompt_kernel,@function
interleave_layers__spectral_gfnet__mha_block__prompt_kernel:
    s_cmp_ge_u32 s2, 256
    s_cbranch_scc1 Lend
    s_load_dwordx16 s[4:19], s[0:1], 0
    s_load_dwordx2 s[20:21], s[0:1], 64
    s_getpc_b64 s[72:73]
Lpc:
    s_lshr_b32 s53, s2, 3
    v_lshlrev_b32 v6, 5, v0
    v_add_lshl_u32 v6, v6, s53, 7
    v_cmp_gt_u32 vcc, Lend-Lpc, v6
    s_nop 0
    s_and_saveexec_b64 s[74:75], vcc
    s_cbranch_execz Lp_1
    v_mov_b32 v7, s73
    v_add_co_u32 v6, vcc, s72, v6
    s_nop 1
    v_addc_co_u32 v7, vcc, 0, v7, vcc
    global_load_dword v251, v[6:7], off
Lp_1:
    s_mov_b64 exec, s[74:75]
    v_lshrrev_b32 v5, 6, v0
    v_and_b32 v1, 63, v0
    v_readfirstlane_b32 s3, v5
    v_and_b32 v2, 15, v0
    v_lshrrev_b32 v3, 4, v1
    s_and_b32 s52, s2, 7
    s_add_u32 s70, s53, s52
    s_and_b32 s59, s70, 7
    s_lshl_b32 s70, s52, 2
    s_lshr_b32 s71, s53, 3
    s_add_u32 s60, s70, s71
    s_lshr_b32 s80, s60, 1
    s_and_b32 s81, s60, 1
    s_mov_b32 s26, 2621440
    s_mov_b32 s27, 0x20000
    s_lshr_b32 s69, s3, 2
    s_cbranch_scc0 Lp_2
    s_and_b32 s82, s80, 7
    s_lshl_b32 s82, s82, 5
    s_lshr_b32 s83, s80, 3
    s_lshl_b32 s83, s83, 1
    s_add_u32 s82, s82, s83
    s_add_u32 s82, s82, s81
    s_lshl_b32 s86, s82, 3
    s_add_u32 s84, s3, s59
    s_and_b32 s84, s84, 7
    s_mov_b32 s85, 0
    s_and_b32 s72, s84, 1
    s_lshl_b32 s72, s72, 3
    v_add_u32 v5, s72, v3
    v_xor_b32 v5, v5, v2
    v_mul_u32_u24 v6, 40960, v3
    v_lshl_add_u32 v8, v5, 4, v6
    v_xor_b32 v5, 4, v5
    v_lshl_add_u32 v9, v5, 4, v6
    v_add_u32 v9, 163840, v9
    s_waitcnt lgkmcnt(0)
    s_mov_b64 s[24:25], s[4:5]
Lp_3:
    s_add_u32 s82, s86, s84
    s_mul_i32 s82, s82, 1280
    s_lshl_b32 s72, s84, 11
    s_add_u32 m0, s72, 0
    s_nop 0
    buffer_load_dwordx4 v8, s[24:27], s82 offen offset:0 lds
    s_add_u32 m0, s72, 1024
    s_nop 0
    buffer_load_dwordx4 v9, s[24:27], s82 offen offset:0 lds
    s_add_u32 m0, s72, 16128
    s_nop 0
    buffer_load_dwordx4 v8, s[24:27], s82 offen offset:256 lds
    s_add_u32 m0, s72, 17152
    s_nop 0
    buffer_load_dwordx4 v9, s[24:27], s82 offen offset:256 lds
    s_add_u32 m0, s72, 32256
    s_nop 0
    buffer_load_dwordx4 v8, s[24:27], s82 offen offset:512 lds
    s_add_u32 m0, s72, 33280
    s_nop 0
    buffer_load_dwordx4 v9, s[24:27], s82 offen offset:512 lds
    s_add_u32 m0, s72, 48384
    s_nop 0
    buffer_load_dwordx4 v8, s[24:27], s82 offen offset:768 lds
    s_add_u32 m0, s72, 49408
    s_nop 0
    buffer_load_dwordx4 v9, s[24:27], s82 offen offset:768 lds
    s_add_u32 m0, s72, 64512
    s_nop 0
    buffer_load_dwordx4 v8, s[24:27], s82 offen offset:1024 lds
    s_add_u32 m0, s72, 65536
    s_nop 0
    buffer_load_dwordx4 v9, s[24:27], s82 offen offset:1024 lds
    s_xor_b32 s84, s84, 4
    s_xor_b32 s85, s85, 1
    s_cbranch_scc1 Lp_3
Lp_2:
    v_lshlrev_b32 v4, 4, v1
    v_mov_b32 v11, 0
    s_and_b32 s70, s52, 3
    s_lshl_b32 s70, s70, 1
    s_and_b32 s71, s53, 1
    s_add_u32 s94, s70, s71
    s_lshr_b32 s70, s52, 2
    s_lshl_b32 s54, s94, 1
    s_add_u32 s54, s54, s70
    s_lshl_b32 s70, s70, 4
    s_lshr_b32 s71, s53, 1
    s_add_u32 s55, s70, s71
    s_lshr_b32 s56, s53, 4
    s_and_b32 s57, s71, 7
    s_mov_b32 s58, 0
    s_and_b32 s68, s3, 3
    s_mov_b32 s66, 0
    s_and_b32 s32, s2, 15
    s_lshl_b32 s33, s32, 11
    s_lshl_b32 s32, s32, 7
    s_mov_b32 s22, 35094528
    s_mov_b32 s23, 0x20000
    s_mov_b32 s30, 1314816
    s_mov_b32 s31, 0x20000
    s_mov_b32 s38, 2457600
    s_mov_b32 s39, 0x20000
    s_mov_b32 s42, 819200
    s_mov_b32 s43, 0x20000
    s_mov_b32 s46, 2621440
    s_mov_b32 s47, 0x20000
    s_mov_b32 s50, 256
    s_mov_b32 s51, 0x20000
    s_waitcnt lgkmcnt(0)
    s_cmp_lt_u32 s52, 4
    s_cselect_b32 s28, s6, s8
    s_cselect_b32 s29, s7, s9
    s_mov_b64 s[36:37], s[12:13]
    s_mov_b64 s[40:41], s[14:15]
    s_mov_b64 s[44:45], s[16:17]
    s_mov_b64 s[48:49], s[18:19]
    s_cmp_eq_u32 s69, 0
    s_cbranch_scc1 Lq_4
    s_mul_i32 s72, s59, 80
    s_mul_i32 s73, s68, 20
    s_add_u32 s72, s72, s73
    s_mul_i32 s72, s72, 3840
    s_lshl_b32 s73, s60, 7
    s_add_u32 s72, s72, s73
    v_mul_u32_u24 v5, 3840, v1
    s_mov_b64 exec, 0xfffff
    s_waitcnt vmcnt(6)
    buffer_load_dword v251, v5, s[36:39], s72 offen
    s_mov_b64 exec, -1
    s_branch Lq_12
Lq_4:
    s_cmp_lg_u32 s3, 3
    s_cbranch_scc1 Lq_8
    s_mul_i32 s84, s80, 163840
    s_mul_i32 s85, s59, 20480
    s_add_u32 s84, s84, s85
    s_lshl_b32 s85, s81, 7
    s_add_u32 s84, s84, s85
    s_add_u32 s84, s84, 1048576
    s_lshl_b32 s85, s80, 11
    s_lshl_b32 s86, s59, 8
    s_add_u32 s85, s85, s86
    s_lshl_b32 s86, s81, 7
    s_add_u32 s85, s85, s86
    s_add_u32 s85, s85, 11534336
    s_lshl_b32 s70, s2, 7
    v_lshrrev_b32 v5, 2, v1
    v_and_b32 v6, 3, v1
    v_lshlrev_b32 v6, 4, v6
    v_lshl_add_u32 v5, v5, 15, v6
    v_mov_b32 v60, 0
    v_mov_b32 v61, 0
    v_mov_b32 v62, 0
    v_mov_b32 v63, 0
    v_mov_b32 v6, 161792
    s_lshl_b32 s71, s2, 10
    s_add_u32 s71, s71, 786432
    buffer_store_dwordx4 v[60:63], v4, s[20:23], s71 offen sc1
    s_bfm_b64 exec, 52, 0
    buffer_store_dwordx4 v[60:63], v5, s[20:23], s70 offen sc1
    s_lshl_b32 s71, s2, 7
    s_add_u32 s71, s71, 11599872
    v_mov_b32 v64, -1
    v_mov_b32 v65, -1
    v_mov_b32 v66, -1
    v_mov_b32 v67, -1
    s_mov_b64 exec, 0xff
    buffer_store_dwordx4 v[64:67], v4, s[20:23], s71 offen sc1
    buffer_store_dwordx4 v[64:67], v4, s[20:23], s85 offen sc1
    ds_write_b128 v6, v[60:63]
    ds_write_b128 v6, v[60:63] offset:16
    s_mov_b64 exec, -1
Lq_8:
    s_mov_b32 s15, s3
Lq_9:
    s_mov_b32 s72, s15
    s_mul_i32 s73, s59, 80
    s_lshl_b32 s74, s72, 4
    s_add_u32 s73, s73, s74
    v_add_u32 v12, s73, v2
    v_lshrrev_b32 v14, 1, v12
    v_and_b32 v15, 1, v12
    v_cmp_ne_u32 vcc, 0, v12
    v_mov_b32 v255, 0x140
    s_nop 0
    v_cndmask_b32 v14, v255, v14, vcc
    v_cmp_ne_u32 vcc, 1, v12
    s_nop 1
    v_cndmask_b32 v15, 0, v15, vcc
    v_cvt_f32_u32 v14, v14
    v_cvt_f32_u32 v15, v15
    v_lshlrev_b32 v13, 3, v3
    v_cvt_f32_u32 v13, v13
    v_mul_f32 v10, 0x3acccccd, v14
    v_mul_f32 v14, 0x3d4ccccd, v14
    v_mul_f32 v15, 0x3e800000, v15
    v_fma_f32 v16, v13, v10, v15
    s_lshl_b32 s72, s72, 10
    s_add_u32 s72, s72, 81920
    v_add_u32 v12, s72, v4
    v_add_f32 v17, v16, v10
    v_add_f32 v18, v17, v10
    v_add_f32 v19, v18, v10
    v_add_f32 v20, v19, v10
    v_add_f32 v21, v20, v10
    v_add_f32 v22, v21, v10
    v_add_f32 v23, v22, v10
    v_pk_add_f32 v[24:25], v[16:17], v[14:15] op_sel_hi:[1,0]
    v_pk_add_f32 v[26:27], v[18:19], v[14:15] op_sel_hi:[1,0]
    v_pk_add_f32 v[28:29], v[20:21], v[14:15] op_sel_hi:[1,0]
    v_pk_add_f32 v[30:31], v[22:23], v[14:15] op_sel_hi:[1,0]
    v_cos_f32 v14, v14
    v_cos_f32 v16, v16
    v_cos_f32 v17, v17
    v_cos_f32 v18, v18
    v_cos_f32 v19, v19
    v_cos_f32 v20, v20
    v_cos_f32 v21, v21
    v_cos_f32 v22, v22
    v_cos_f32 v23, v23
    v_cos_f32 v24, v24
    v_cos_f32 v25, v25
    v_cos_f32 v26, v26
    v_cos_f32 v27, v27
    v_cos_f32 v28, v28
    v_cos_f32 v29, v29
    v_cos_f32 v30, v30
    v_cos_f32 v31, v31
    v_add_f32 v14, v14, v14
    v_cvt_pk_bf16_f32 v32, v16, v17
    v_cvt_pk_bf16_f32 v33, v18, v19
    v_cvt_pk_bf16_f32 v34, v20, v21
    v_cvt_pk_bf16_f32 v35, v22, v23
    ds_write_b128 v12, v[32:35] offset:0
    v_cvt_pk_bf16_f32 v36, v24, v25
    v_cvt_pk_bf16_f32 v37, v26, v27
    v_cvt_pk_bf16_f32 v38, v28, v29
    v_cvt_pk_bf16_f32 v39, v30, v31
    ds_write_b128 v12, v[36:39] offset:5120
    v_pk_fma_f32 v[16:17], v[24:25], v[14:15], v[16:17] op_sel_hi:[1,0,1] neg_lo:[0,0,1] neg_hi:[0,0,1]
    v_pk_fma_f32 v[18:19], v[26:27], v[14:15], v[18:19] op_sel_hi:[1,0,1] neg_lo:[0,0,1] neg_hi:[0,0,1]
    v_pk_fma_f32 v[20:21], v[28:29], v[14:15], v[20:21] op_sel_hi:[1,0,1] neg_lo:[0,0,1] neg_hi:[0,0,1]
    v_pk_fma_f32 v[22:23], v[30:31], v[14:15], v[22:23] op_sel_hi:[1,0,1] neg_lo:[0,0,1] neg_hi:[0,0,1]
    v_cvt_pk_bf16_f32 v32, v16, v17
    v_cvt_pk_bf16_f32 v33, v18, v19
    v_cvt_pk_bf16_f32 v34, v20, v21
    v_cvt_pk_bf16_f32 v35, v22, v23
    ds_write_b128 v12, v[32:35] offset:10240
    v_pk_fma_f32 v[24:25], v[16:17], v[14:15], v[24:25] op_sel_hi:[1,0,1] neg_lo:[0,0,1] neg_hi:[0,0,1]
    v_pk_fma_f32 v[26:27], v[18:19], v[14:15], v[26:27] op_sel_hi:[1,0,1] neg_lo:[0,0,1] neg_hi:[0,0,1]
    v_pk_fma_f32 v[28:29], v[20:21], v[14:15], v[28:29] op_sel_hi:[1,0,1] neg_lo:[0,0,1] neg_hi:[0,0,1]
    v_pk_fma_f32 v[30:31], v[22:23], v[14:15], v[30:31] op_sel_hi:[1,0,1] neg_lo:[0,0,1] neg_hi:[0,0,1]
    v_cvt_pk_bf16_f32 v36, v24, v25
    v_cvt_pk_bf16_f32 v37, v26, v27
    v_cvt_pk_bf16_f32 v38, v28, v29
    v_cvt_pk_bf16_f32 v39, v30, v31
    ds_write_b128 v12, v[36:39] offset:15360
    v_pk_fma_f32 v[16:17], v[24:25], v[14:15], v[16:17] op_sel_hi:[1,0,1] neg_lo:[0,0,1] neg_hi:[0,0,1]
    v_pk_fma_f32 v[18:19], v[26:27], v[14:15], v[18:19] op_sel_hi:[1,0,1] neg_lo:[0,0,1] neg_hi:[0,0,1]
    v_pk_fma_f32 v[20:21], v[28:29], v[14:15], v[20:21] op_sel_hi:[1,0,1] neg_lo:[0,0,1] neg_hi:[0,0,1]
    v_pk_fma_f32 v[22:23], v[30:31], v[14:15], v[22:23] op_sel_hi:[1,0,1] neg_lo:[0,0,1] neg_hi:[0,0,1]
    v_cvt_pk_bf16_f32 v32, v16, v17
    v_cvt_pk_bf16_f32 v33, v18, v19
    v_cvt_pk_bf16_f32 v34, v20, v21
    v_cvt_pk_bf16_f32 v35, v22, v23
    ds_write_b128 v12, v[32:35] offset:20480
    v_pk_fma_f32 v[24:25], v[16:17], v[14:15], v[24:25] op_sel_hi:[1,0,1] neg_lo:[0,0,1] neg_hi:[0,0,1]
    v_pk_fma_f32 v[26:27], v[18:19], v[14:15], v[26:27] op_sel_hi:[1,0,1] neg_lo:[0,0,1] neg_hi:[0,0,1]
    v_pk_fma_f32 v[28:29], v[20:21], v[14:15], v[28:29] op_sel_hi:[1,0,1] neg_lo:[0,0,1] neg_hi:[0,0,1]
    v_pk_fma_f32 v[30:31], v[22:23], v[14:15], v[30:31] op_sel_hi:[1,0,1] neg_lo:[0,0,1] neg_hi:[0,0,1]
    v_cvt_pk_bf16_f32 v36, v24, v25
    v_cvt_pk_bf16_f32 v37, v26, v27
    v_cvt_pk_bf16_f32 v38, v28, v29
    v_cvt_pk_bf16_f32 v39, v30, v31
    ds_write_b128 v12, v[36:39] offset:25600
    v_pk_fma_f32 v[16:17], v[24:25], v[14:15], v[16:17] op_sel_hi:[1,0,1] neg_lo:[0,0,1] neg_hi:[0,0,1]
    v_pk_fma_f32 v[18:19], v[26:27], v[14:15], v[18:19] op_sel_hi:[1,0,1] neg_lo:[0,0,1] neg_hi:[0,0,1]
    v_pk_fma_f32 v[20:21], v[28:29], v[14:15], v[20:21] op_sel_hi:[1,0,1] neg_lo:[0,0,1] neg_hi:[0,0,1]
    v_pk_fma_f32 v[22:23], v[30:31], v[14:15], v[22:23] op_sel_hi:[1,0,1] neg_lo:[0,0,1] neg_hi:[0,0,1]
    v_cvt_pk_bf16_f32 v32, v16, v17
    v_cvt_pk_bf16_f32 v33, v18, v19
    v_cvt_pk_bf16_f32 v34, v20, v21
    v_cvt_pk_bf16_f32 v35, v22, v23
    ds_write_b128 v12, v[32:35] offset:30720
    v_pk_fma_f32 v[24:25], v[16:17], v[14:15], v[24:25] op_sel_hi:[1,0,1] neg_lo:[0,0,1] neg_hi:[0,0,1]
    v_pk_fma_f32 v[26:27], v[18:19], v[14:15], v[26:27] op_sel_hi:[1,0,1] neg_lo:[0,0,1] neg_hi:[0,0,1]
    v_pk_fma_f32 v[28:29], v[20:21], v[14:15], v[28:29] op_sel_hi:[1,0,1] neg_lo:[0,0,1] neg_hi:[0,0,1]
    v_pk_fma_f32 v[30:31], v[22:23], v[14:15], v[30:31] op_sel_hi:[1,0,1] neg_lo:[0,0,1] neg_hi:[0,0,1]
    v_cvt_pk_bf16_f32 v36, v24, v25
    v_cvt_pk_bf16_f32 v37, v26, v27
    v_cvt_pk_bf16_f32 v38, v28, v29
    v_cvt_pk_bf16_f32 v39, v30, v31
    ds_write_b128 v12, v[36:39] offset:35840
    v_pk_fma_f32 v[16:17], v[24:25], v[14:15], v[16:17] op_sel_hi:[1,0,1] neg_lo:[0,0,1] neg_hi:[0,0,1]
    v_pk_fma_f32 v[18:19], v[26:27], v[14:15], v[18:19] op_sel_hi:[1,0,1] neg_lo:[0,0,1] neg_hi:[0,0,1]
    v_pk_fma_f32 v[20:21], v[28:29], v[14:15], v[20:21] op_sel_hi:[1,0,1] neg_lo:[0,0,1] neg_hi:[0,0,1]
    v_pk_fma_f32 v[22:23], v[30:31], v[14:15], v[22:23] op_sel_hi:[1,0,1] neg_lo:[0,0,1] neg_hi:[0,0,1]
    v_cvt_pk_bf16_f32 v32, v16, v17
    v_cvt_pk_bf16_f32 v33, v18, v19
    v_cvt_pk_bf16_f32 v34, v20, v21
    v_cvt_pk_bf16_f32 v35, v22, v23
    ds_write_b128 v12, v[32:35] offset:40960
    v_pk_fma_f32 v[24:25], v[16:17], v[14:15], v[24:25] op_sel_hi:[1,0,1] neg_lo:[0,0,1] neg_hi:[0,0,1]
    v_pk_fma_f32 v[26:27], v[18:19], v[14:15], v[26:27] op_sel_hi:[1,0,1] neg_lo:[0,0,1] neg_hi:[0,0,1]
    v_pk_fma_f32 v[28:29], v[20:21], v[14:15], v[28:29] op_sel_hi:[1,0,1] neg_lo:[0,0,1] neg_hi:[0,0,1]
    v_pk_fma_f32 v[30:31], v[22:23], v[14:15], v[30:31] op_sel_hi:[1,0,1] neg_lo:[0,0,1] neg_hi:[0,0,1]
    v_cvt_pk_bf16_f32 v36, v24, v25
    v_cvt_pk_bf16_f32 v37, v26, v27
    v_cvt_pk_bf16_f32 v38, v28, v29
    v_cvt_pk_bf16_f32 v39, v30, v31
    ds_write_b128 v12, v[36:39] offset:46080
    s_add_u32 s15, s15, 4
    s_cmp_eq_u32 s15, 4
    s_cbranch_scc1 Lq_9
    s_cmp_ge_u32 s53, 20
    s_cbranch_scc1 Lq_17
    s_sub_u32 s15, s3, 1
    s_cmp_ge_u32 s15, 2
    s_cbranch_scc1 Lq_17
    v_and_b32 v5, 31, v1
    v_lshrrev_b32 v6, 5, v1
    s_mov_b32 s74, s15
Lk_19:
    v_lshl_add_u32 v7, v5, 1, v6
    s_lshl_b32 s72, s74, 3
    v_mul_u32_u24 v8, s72, v7
    s_lshl_b32 s72, s74, 5
    s_sub_u32 s72, s72, 127
    v_lshl_add_u32 v9, v6, 4, s72
    v_mul_u32_u24 v9, v9, v5
    v_lshlrev_b32 v10, 1, v5
    s_cmp_lt_u32 s74, 4
    s_cselect_b64 vcc, -1, 0
    v_cndmask_b32 v8, v9, v8, vcc
    v_cndmask_b32 v7, v10, v7, vcc
    v_cvt_f32_u32 v8, v8
    v_cvt_f32_u32 v7, v7
    v_mul_f32 v60, 0x3c800000, v8
    v_mul_f32 v7, 0x3c800000, v7
    s_lshl_b32 s73, s74, 10
    s_add_u32 s73, s73, 145408
    v_add_f32 v61, v60, v7
    v_add_f32 v62, v61, v7
    v_add_f32 v63, v62, v7
    v_add_f32 v64, v63, v7
    v_add_f32 v65, v64, v7
    v_add_f32 v66, v65, v7
    v_add_f32 v67, v66, v7
    v_sin_f32 v68, v60
    v_cos_f32 v60, v60
    v_sin_f32 v69, v61
    v_cos_f32 v61, v61
    v_sin_f32 v70, v62
    v_cos_f32 v62, v62
    v_sin_f32 v71, v63
    v_cos_f32 v63, v63
    v_sin_f32 v72, v64
    v_cos_f32 v64, v64
    v_sin_f32 v73, v65
    v_cos_f32 v65, v65
    v_sin_f32 v74, v66
    v_cos_f32 v66, v66
    v_sin_f32 v75, v67
    v_cos_f32 v67, v67
    v_add_u32 v9, s73, v4
    v_cvt_pk_bf16_f32 v76, v60, v61
    v_cvt_pk_bf16_f32 v80, v68, v69
    v_cvt_pk_bf16_f32 v77, v62, v63
    v_cvt_pk_bf16_f32 v81, v70, v71
    v_cvt_pk_bf16_f32 v78, v64, v65
    v_cvt_pk_bf16_f32 v82, v72, v73
    v_cvt_pk_bf16_f32 v79, v66, v67
    v_cvt_pk_bf16_f32 v83, v74, v75
    s_add_u32 s74, s74, 2
    s_cmp_lt_u32 s74, 6
    ds_write_b128 v9, v[76:79]
    ds_write_b128 v9, v[80:83] offset:6144
    s_cbranch_scc1 Lk_19
Lq_17:
    s_mul_i32 s84, s80, 163840
    s_mul_i32 s85, s59, 20480
    s_add_u32 s84, s84, s85
    s_lshl_b32 s85, s81, 7
    s_add_u32 s84, s84, s85
    s_add_u32 s84, s84, 1048576
    s_lshl_b32 s85, s80, 11
    s_lshl_b32 s86, s59, 8
    s_add_u32 s85, s85, s86
    s_lshl_b32 s86, s81, 7
    s_add_u32 s85, s85, s86
    s_add_u32 s85, s85, 11534336
    s_cmp_lg_u32 s3, 3
    s_cbranch_scc1 Lq_7
    s_and_b32 s70, s2, 1
    s_lshl_b32 s70, s70, 7
    v_mov_b32 v60, 0
    v_mov_b32 v61, 1
    s_mov_b64 exec, 1
    s_waitcnt vmcnt(0)
    buffer_atomic_add v61, v60, s[48:51], s70 offen sc1
    s_mov_b64 exec, -1
Lq_7:
    s_waitcnt lgkmcnt(0)
    s_barrier
    s_lshl_b32 s72, s68, 12
    v_xor_b32 v5, v3, v2
    v_lshlrev_b32 v5, 4, v5
    v_lshl_add_u32 v5, v2, 8, v5
    v_add_u32 v60, s72, v5
    v_xor_b32 v61, 64, v60
    v_xor_b32 v62, 128, v60
    v_xor_b32 v63, 192, v60
    ds_read_b128 v[164:167], v60 offset:0
    ds_read_b128 v[168:171], v61 offset:0
    ds_read_b128 v[172:175], v62 offset:0
    ds_read_b128 v[176:179], v63 offset:0
    ds_read_b128 v[180:183], v60 offset:16384
    ds_read_b128 v[184:187], v61 offset:16384
    ds_read_b128 v[188:191], v62 offset:16384
    ds_read_b128 v[192:195], v63 offset:16384
    ds_read_b128 v[196:199], v60 offset:32768
    ds_read_b128 v[200:203], v61 offset:32768
    ds_read_b128 v[204:207], v62 offset:32768
    ds_read_b128 v[208:211], v63 offset:32768
    ds_read_b128 v[212:215], v60 offset:49152
    ds_read_b128 v[216:219], v61 offset:49152
    ds_read_b128 v[220:223], v62 offset:49152
    ds_read_b128 v[224:227], v63 offset:49152
    v_add_u32 v64, 0x10000, v60
    v_add_u32 v65, 0x10000, v61
    v_add_u32 v66, 0x10000, v62
    v_add_u32 v67, 0x10000, v63
    ds_read_b128 v[228:231], v64 offset:0
    ds_read_b128 v[232:235], v65 offset:0
    ds_read_b128 v[236:239], v66 offset:0
    ds_read_b128 v[240:243], v67 offset:0
    v_mov_b32 v52, 0x3d64f92e
    v_lshlrev_b32 v5, 30, v2
    v_and_b32 v5, 0x80000000, v5
    v_xor_b32 v54, v5, v52
    s_cmp_eq_u32 s59, 0
    s_cselect_b32 s72, 2, 0
    v_cmp_le_u32 vcc, s72, v2
    v_mov_b32 v255, 0x3d21e89b
    s_nop 0
    v_cndmask_b32 v56, v255, v52, vcc
    v_xor_b32 v58, v5, v56
    v_mul_u32_u24 v5, 144, v2
    v_lshl_add_u32 v5, v3, 3, v5
    s_lshl_b32 s72, s68, 5
    s_add_u32 s72, s72, 133120
    v_add_u32 v140, s72, v5
    s_movk_i32 s79, 144
    v_lshrrev_b32 v5, 3, v0
    v_and_b32 v6, 7, v0
    v_lshlrev_b32 v6, 4, v6
    v_mad_u32_u24 v141, v5, s79, v6
    v_lshl_add_u32 v142, v5, 8, v6
    v_add_u32 v141, 133120, v141
    s_waitcnt lgkmcnt(0)
    s_barrier
    v_lshlrev_b32 v143, 7, v1
    s_movk_i32 s89, 128
    v_add_u32 v6, 81920, v4
    ds_read_b128 v[60:63], v6 offset:0
    ds_read_b128 v[64:67], v6 offset:1024
    ds_read_b128 v[68:71], v6 offset:2048
    ds_read_b128 v[72:75], v6 offset:3072
    ds_read_b128 v[76:79], v6 offset:4096
    ds_read_b128 v[80:83], v6 offset:5120
    ds_read_b128 v[84:87], v6 offset:6144
    ds_read_b128 v[88:91], v6 offset:7168
    ds_read_b128 v[92:95], v6 offset:8192
    ds_read_b128 v[96:99], v6 offset:9216
    s_waitcnt lgkmcnt(5)
    v_mfma_f32_16x16x32_bf16 v[144:147], v[164:167], v[60:63], 0
    ds_read_b128 v[100:103], v6 offset:10240
    v_mfma_f32_16x16x32_bf16 v[120:123], v[204:207], v[60:63], 0
    v_mfma_f32_16x16x32_bf16 v[148:151], v[164:167], v[64:67], 0
    ds_read_b128 v[104:107], v6 offset:11264
    v_mfma_f32_16x16x32_bf16 v[124:127], v[204:207], v[64:67], 0
    v_mfma_f32_16x16x32_bf16 v[152:155], v[164:167], v[68:71], 0
    ds_read_b128 v[108:111], v6 offset:12288
    v_mfma_f32_16x16x32_bf16 v[128:131], v[204:207], v[68:71], 0
    v_mfma_f32_16x16x32_bf16 v[156:159], v[164:167], v[72:75], 0
    ds_read_b128 v[112:115], v6 offset:13312
    v_mfma_f32_16x16x32_bf16 v[132:135], v[204:207], v[72:75], 0
    v_mfma_f32_16x16x32_bf16 v[160:163], v[164:167], v[76:79], 0
    ds_read_b128 v[116:119], v6 offset:14336
    v_mfma_f32_16x16x32_bf16 v[136:139], v[204:207], v[76:79], 0
    s_waitcnt lgkmcnt(5)
    v_mfma_f32_16x16x32_bf16 v[144:147], v[168:171], v[80:83], v[144:147]
    ds_read_b128 v[60:63], v6 offset:15360
    v_mfma_f32_16x16x32_bf16 v[120:123], v[208:211], v[80:83], v[120:123]
    v_mfma_f32_16x16x32_bf16 v[148:151], v[168:171], v[84:87], v[148:151]
    ds_read_b128 v[64:67], v6 offset:16384
    v_mfma_f32_16x16x32_bf16 v[124:127], v[208:211], v[84:87], v[124:127]
    v_mfma_f32_16x16x32_bf16 v[152:155], v[168:171], v[88:91], v[152:155]
    ds_read_b128 v[68:71], v6 offset:17408
    v_mfma_f32_16x16x32_bf16 v[128:131], v[208:211], v[88:91], v[128:131]
    v_mfma_f32_16x16x32_bf16 v[156:159], v[168:171], v[92:95], v[156:159]
    ds_read_b128 v[72:75], v6 offset:18432
    v_mfma_f32_16x16x32_bf16 v[132:135], v[208:211], v[92:95], v[132:135]
    v_mfma_f32_16x16x32_bf16 v[160:163], v[168:171], v[96:99], v[160:163]
    ds_read_b128 v[76:79], v6 offset:19456
    v_mfma_f32_16x16x32_bf16 v[136:139], v[208:211], v[96:99], v[136:139]
    s_waitcnt lgkmcnt(5)
    v_mfma_f32_16x16x32_bf16 v[144:147], v[172:175], v[100:103], v[144:147]
    ds_read_b128 v[80:83], v6 offset:20480
    v_mfma_f32_16x16x32_bf16 v[120:123], v[212:215], v[100:103], v[120:123]
    v_mfma_f32_16x16x32_bf16 v[148:151], v[172:175], v[104:107], v[148:151]
    ds_read_b128 v[84:87], v6 offset:21504
    v_mfma_f32_16x16x32_bf16 v[124:127], v[212:215], v[104:107], v[124:127]
    v_mfma_f32_16x16x32_bf16 v[152:155], v[172:175], v[108:111], v[152:155]
    ds_read_b128 v[88:91], v6 offset:22528
    v_mfma_f32_16x16x32_bf16 v[128:131], v[212:215], v[108:111], v[128:131]
    v_mfma_f32_16x16x32_bf16 v[156:159], v[172:175], v[112:115], v[156:159]
    ds_read_b128 v[92:95], v6 offset:23552
    v_mfma_f32_16x16x32_bf16 v[132:135], v[212:215], v[112:115], v[132:135]
    v_mfma_f32_16x16x32_bf16 v[160:163], v[172:175], v[116:119], v[160:163]
    ds_read_b128 v[96:99], v6 offset:24576
    v_mfma_f32_16x16x32_bf16 v[136:139], v[212:215], v[116:119], v[136:139]
    s_waitcnt lgkmcnt(5)
    v_mfma_f32_16x16x32_bf16 v[144:147], v[176:179], v[60:63], v[144:147]
    ds_read_b128 v[100:103], v6 offset:25600
    v_mfma_f32_16x16x32_bf16 v[120:123], v[216:219], v[60:63], v[120:123]
    v_mfma_f32_16x16x32_bf16 v[148:151], v[176:179], v[64:67], v[148:151]
    ds_read_b128 v[104:107], v6 offset:26624
    v_mfma_f32_16x16x32_bf16 v[124:127], v[216:219], v[64:67], v[124:127]
    v_mfma_f32_16x16x32_bf16 v[152:155], v[176:179], v[68:71], v[152:155]
    ds_read_b128 v[108:111], v6 offset:27648
    v_mfma_f32_16x16x32_bf16 v[128:131], v[216:219], v[68:71], v[128:131]
    v_mfma_f32_16x16x32_bf16 v[156:159], v[176:179], v[72:75], v[156:159]
    ds_read_b128 v[112:115], v6 offset:28672
    v_mfma_f32_16x16x32_bf16 v[132:135], v[216:219], v[72:75], v[132:135]
    v_mfma_f32_16x16x32_bf16 v[160:163], v[176:179], v[76:79], v[160:163]
    ds_read_b128 v[116:119], v6 offset:29696
    v_mfma_f32_16x16x32_bf16 v[136:139], v[216:219], v[76:79], v[136:139]
    s_waitcnt lgkmcnt(5)
    v_mfma_f32_16x16x32_bf16 v[144:147], v[180:183], v[80:83], v[144:147]
    ds_read_b128 v[60:63], v6 offset:30720
    v_mfma_f32_16x16x32_bf16 v[120:123], v[220:223], v[80:83], v[120:123]
    v_mfma_f32_16x16x32_bf16 v[148:151], v[180:183], v[84:87], v[148:151]
    ds_read_b128 v[64:67], v6 offset:31744
    v_mfma_f32_16x16x32_bf16 v[124:127], v[220:223], v[84:87], v[124:127]
    v_mfma_f32_16x16x32_bf16 v[152:155], v[180:183], v[88:91], v[152:155]
    ds_read_b128 v[68:71], v6 offset:32768
    v_mfma_f32_16x16x32_bf16 v[128:131], v[220:223], v[88:91], v[128:131]
    v_mfma_f32_16x16x32_bf16 v[156:159], v[180:183], v[92:95], v[156:159]
    ds_read_b128 v[72:75], v6 offset:33792
    v_mfma_f32_16x16x32_bf16 v[132:135], v[220:223], v[92:95], v[132:135]
    v_mfma_f32_16x16x32_bf16 v[160:163], v[180:183], v[96:99], v[160:163]
    ds_read_b128 v[76:79], v6 offset:34816
    v_mfma_f32_16x16x32_bf16 v[136:139], v[220:223], v[96:99], v[136:139]
    s_waitcnt lgkmcnt(5)
    v_mfma_f32_16x16x32_bf16 v[144:147], v[184:187], v[100:103], v[144:147]
    ds_read_b128 v[80:83], v6 offset:35840
    v_mfma_f32_16x16x32_bf16 v[120:123], v[224:227], v[100:103], v[120:123]
    v_mfma_f32_16x16x32_bf16 v[148:151], v[184:187], v[104:107], v[148:151]
    ds_read_b128 v[84:87], v6 offset:36864
    v_mfma_f32_16x16x32_bf16 v[124:127], v[224:227], v[104:107], v[124:127]
    v_mfma_f32_16x16x32_bf16 v[152:155], v[184:187], v[108:111], v[152:155]
    ds_read_b128 v[88:91], v6 offset:37888
    v_mfma_f32_16x16x32_bf16 v[128:131], v[224:227], v[108:111], v[128:131]
    v_mfma_f32_16x16x32_bf16 v[156:159], v[184:187], v[112:115], v[156:159]
    ds_read_b128 v[92:95], v6 offset:38912
    v_mfma_f32_16x16x32_bf16 v[132:135], v[224:227], v[112:115], v[132:135]
    v_mfma_f32_16x16x32_bf16 v[160:163], v[184:187], v[116:119], v[160:163]
    ds_read_b128 v[96:99], v6 offset:39936
    v_mfma_f32_16x16x32_bf16 v[136:139], v[224:227], v[116:119], v[136:139]
    s_waitcnt lgkmcnt(5)
    v_mfma_f32_16x16x32_bf16 v[144:147], v[188:191], v[60:63], v[144:147]
    ds_read_b128 v[100:103], v6 offset:40960
    v_mfma_f32_16x16x32_bf16 v[120:123], v[228:231], v[60:63], v[120:123]
    v_mfma_f32_16x16x32_bf16 v[148:151], v[188:191], v[64:67], v[148:151]
    ds_read_b128 v[104:107], v6 offset:41984
    v_mfma_f32_16x16x32_bf16 v[124:127], v[228:231], v[64:67], v[124:127]
    v_mfma_f32_16x16x32_bf16 v[152:155], v[188:191], v[68:71], v[152:155]
    ds_read_b128 v[108:111], v6 offset:43008
    v_mfma_f32_16x16x32_bf16 v[128:131], v[228:231], v[68:71], v[128:131]
    v_mfma_f32_16x16x32_bf16 v[156:159], v[188:191], v[72:75], v[156:159]
    ds_read_b128 v[112:115], v6 offset:44032
    v_mfma_f32_16x16x32_bf16 v[132:135], v[228:231], v[72:75], v[132:135]
    v_mfma_f32_16x16x32_bf16 v[160:163], v[188:191], v[76:79], v[160:163]
    ds_read_b128 v[116:119], v6 offset:45056
    v_mfma_f32_16x16x32_bf16 v[136:139], v[228:231], v[76:79], v[136:139]
    s_waitcnt lgkmcnt(5)
    v_mfma_f32_16x16x32_bf16 v[144:147], v[192:195], v[80:83], v[144:147]
    ds_read_b128 v[60:63], v6 offset:46080
    v_mfma_f32_16x16x32_bf16 v[120:123], v[232:235], v[80:83], v[120:123]
    v_mfma_f32_16x16x32_bf16 v[148:151], v[192:195], v[84:87], v[148:151]
    ds_read_b128 v[64:67], v6 offset:47104
    v_mfma_f32_16x16x32_bf16 v[124:127], v[232:235], v[84:87], v[124:127]
    v_mfma_f32_16x16x32_bf16 v[152:155], v[192:195], v[88:91], v[152:155]
    ds_read_b128 v[68:71], v6 offset:48128
    v_mfma_f32_16x16x32_bf16 v[128:131], v[232:235], v[88:91], v[128:131]
    v_mfma_f32_16x16x32_bf16 v[156:159], v[192:195], v[92:95], v[156:159]
    ds_read_b128 v[72:75], v6 offset:49152
    v_mfma_f32_16x16x32_bf16 v[132:135], v[232:235], v[92:95], v[132:135]
    v_mfma_f32_16x16x32_bf16 v[160:163], v[192:195], v[96:99], v[160:163]
    ds_read_b128 v[76:79], v6 offset:50176
    v_mfma_f32_16x16x32_bf16 v[136:139], v[232:235], v[96:99], v[136:139]
    s_waitcnt lgkmcnt(5)
    v_mfma_f32_16x16x32_bf16 v[144:147], v[196:199], v[100:103], v[144:147]
    v_mfma_f32_16x16x32_bf16 v[120:123], v[236:239], v[100:103], v[120:123]
    v_mfma_f32_16x16x32_bf16 v[148:151], v[196:199], v[104:107], v[148:151]
    v_mfma_f32_16x16x32_bf16 v[124:127], v[236:239], v[104:107], v[124:127]
    v_mfma_f32_16x16x32_bf16 v[152:155], v[196:199], v[108:111], v[152:155]
    v_mfma_f32_16x16x32_bf16 v[128:131], v[236:239], v[108:111], v[128:131]
    v_mfma_f32_16x16x32_bf16 v[156:159], v[196:199], v[112:115], v[156:159]
    v_mfma_f32_16x16x32_bf16 v[132:135], v[236:239], v[112:115], v[132:135]
    v_mfma_f32_16x16x32_bf16 v[160:163], v[196:199], v[116:119], v[160:163]
    v_mfma_f32_16x16x32_bf16 v[136:139], v[236:239], v[116:119], v[136:139]
    s_waitcnt lgkmcnt(0)
    v_mfma_f32_16x16x32_bf16 v[144:147], v[200:203], v[60:63], v[144:147]
    v_mfma_f32_16x16x32_bf16 v[120:123], v[240:243], v[60:63], v[120:123]
    v_mfma_f32_16x16x32_bf16 v[148:151], v[200:203], v[64:67], v[148:151]
    v_mfma_f32_16x16x32_bf16 v[124:127], v[240:243], v[64:67], v[124:127]
    v_mfma_f32_16x16x32_bf16 v[152:155], v[200:203], v[68:71], v[152:155]
    v_mfma_f32_16x16x32_bf16 v[128:131], v[240:243], v[68:71], v[128:131]
    v_mfma_f32_16x16x32_bf16 v[156:159], v[200:203], v[72:75], v[156:159]
    v_mfma_f32_16x16x32_bf16 v[132:135], v[240:243], v[72:75], v[132:135]
    v_mfma_f32_16x16x32_bf16 v[160:163], v[200:203], v[76:79], v[160:163]
    v_mfma_f32_16x16x32_bf16 v[136:139], v[240:243], v[76:79], v[136:139]
    v_pk_mul_f32 v[144:145], v[144:145], v[56:57] op_sel_hi:[1,0]
    v_pk_fma_f32 v[144:145], v[120:121], v[58:59], v[144:145] op_sel_hi:[1,0,1]
    v_pk_mul_f32 v[146:147], v[146:147], v[56:57] op_sel_hi:[1,0]
    v_pk_fma_f32 v[146:147], v[122:123], v[58:59], v[146:147] op_sel_hi:[1,0,1]
    v_cvt_pk_bf16_f32 v60, v144, v145
    v_cvt_pk_bf16_f32 v61, v146, v147
    v_min_u32 v60, -2, v60
    v_min_u32 v61, -2, v61
    ds_write_b64 v140, v[60:61] offset:0
    v_pk_mul_f32 v[148:149], v[148:149], v[52:53] op_sel_hi:[1,0]
    v_pk_fma_f32 v[148:149], v[124:125], v[54:55], v[148:149] op_sel_hi:[1,0,1]
    v_pk_mul_f32 v[150:151], v[150:151], v[52:53] op_sel_hi:[1,0]
    v_pk_fma_f32 v[150:151], v[126:127], v[54:55], v[150:151] op_sel_hi:[1,0,1]
    v_cvt_pk_bf16_f32 v62, v148, v149
    v_cvt_pk_bf16_f32 v63, v150, v151
    v_min_u32 v62, -2, v62
    v_min_u32 v63, -2, v63
    ds_write_b64 v140, v[62:63] offset:2304
    v_pk_mul_f32 v[152:153], v[152:153], v[52:53] op_sel_hi:[1,0]
    v_pk_fma_f32 v[152:153], v[128:129], v[54:55], v[152:153] op_sel_hi:[1,0,1]
    v_pk_mul_f32 v[154:155], v[154:155], v[52:53] op_sel_hi:[1,0]
    v_pk_fma_f32 v[154:155], v[130:131], v[54:55], v[154:155] op_sel_hi:[1,0,1]
    v_cvt_pk_bf16_f32 v64, v152, v153
    v_cvt_pk_bf16_f32 v65, v154, v155
    v_min_u32 v64, -2, v64
    v_min_u32 v65, -2, v65
    ds_write_b64 v140, v[64:65] offset:4608
    v_pk_mul_f32 v[156:157], v[156:157], v[52:53] op_sel_hi:[1,0]
    v_pk_fma_f32 v[156:157], v[132:133], v[54:55], v[156:157] op_sel_hi:[1,0,1]
    v_pk_mul_f32 v[158:159], v[158:159], v[52:53] op_sel_hi:[1,0]
    v_pk_fma_f32 v[158:159], v[134:135], v[54:55], v[158:159] op_sel_hi:[1,0,1]
    v_cvt_pk_bf16_f32 v66, v156, v157
    v_cvt_pk_bf16_f32 v67, v158, v159
    v_min_u32 v66, -2, v66
    v_min_u32 v67, -2, v67
    ds_write_b64 v140, v[66:67] offset:6912
    v_pk_mul_f32 v[160:161], v[160:161], v[52:53] op_sel_hi:[1,0]
    v_pk_fma_f32 v[160:161], v[136:137], v[54:55], v[160:161] op_sel_hi:[1,0,1]
    v_pk_mul_f32 v[162:163], v[162:163], v[52:53] op_sel_hi:[1,0]
    v_pk_fma_f32 v[162:163], v[138:139], v[54:55], v[162:163] op_sel_hi:[1,0,1]
    v_cvt_pk_bf16_f32 v68, v160, v161
    v_cvt_pk_bf16_f32 v69, v162, v163
    v_min_u32 v68, -2, v68
    v_min_u32 v69, -2, v69
    ds_write_b64 v140, v[68:69] offset:9216
    v_mov_b32 v5, 161796
    v_mov_b32 v6, 1
    s_mov_b64 exec, 1
    ds_add_u32 v5, v6
Lhs_20:
    ds_read_b32 v6, v5
    s_waitcnt lgkmcnt(0)
    v_cmp_gt_u32 vcc, 4, v6
    s_nop 4
    s_cbranch_vccnz Lhs_20
    s_mov_b64 exec, -1
    ds_read_b128 v[84:87], v141 offset:0
    ds_read_b128 v[88:91], v141 offset:4608
    ds_read_b128 v[92:95], v141 offset:9216
    s_add_u32 s72, s84, 8192
    s_add_u32 s73, s84, 16384
    s_waitcnt lgkmcnt(2)
    buffer_store_dwordx4 v[84:87], v142, s[20:23], s84 offen sc1
    s_waitcnt lgkmcnt(1)
    buffer_store_dwordx4 v[88:91], v142, s[20:23], s72 offen sc1
    s_cmp_gt_u32 s3, 1
    s_waitcnt lgkmcnt(0)
    s_cbranch_scc1 Le_21
    buffer_store_dwordx4 v[92:95], v142, s[20:23], s73 offen sc1
Le_21:
    s_cmp_eq_u32 s59, 0
    s_cselect_b32 s72, 1, 99
    v_cmp_ne_u32 vcc, s72, v2
    v_pk_mul_f32 v[76:77], v[148:149], v[148:149]
    v_pk_mul_f32 v[78:79], v[150:151], v[150:151]
    v_cndmask_b32 v144, 0, v144, vcc
    v_cndmask_b32 v145, 0, v145, vcc
    v_cndmask_b32 v146, 0, v146, vcc
    v_cndmask_b32 v147, 0, v147, vcc
    v_pk_fma_f32 v[76:77], v[152:153], v[152:153], v[76:77]
    v_pk_fma_f32 v[78:79], v[154:155], v[154:155], v[78:79]
    v_pk_fma_f32 v[76:77], v[156:157], v[156:157], v[76:77]
    v_pk_fma_f32 v[78:79], v[158:159], v[158:159], v[78:79]
    v_pk_fma_f32 v[76:77], v[160:161], v[160:161], v[76:77]
    v_pk_fma_f32 v[78:79], v[162:163], v[162:163], v[78:79]
    v_pk_fma_f32 v[76:77], v[144:145], v[144:145], v[76:77]
    v_pk_fma_f32 v[78:79], v[146:147], v[146:147], v[78:79]
    s_nop 0
    v_add_f32 v76, v76, v76 row_ror:8 row_mask:0xf bank_mask:0xf
    v_add_f32 v77, v77, v77 row_ror:8 row_mask:0xf bank_mask:0xf
    v_add_f32 v78, v78, v78 row_ror:8 row_mask:0xf bank_mask:0xf
    v_add_f32 v79, v79, v79 row_ror:8 row_mask:0xf bank_mask:0xf
    v_add_f32 v76, v76, v76 row_ror:4 row_mask:0xf bank_mask:0xf
    v_add_f32 v77, v77, v77 row_ror:4 row_mask:0xf bank_mask:0xf
    v_add_f32 v78, v78, v78 row_ror:4 row_mask:0xf bank_mask:0xf
    v_add_f32 v79, v79, v79 row_ror:4 row_mask:0xf bank_mask:0xf
    v_add_f32 v76, v76, v76 row_ror:2 row_mask:0xf bank_mask:0xf
    v_add_f32 v77, v77, v77 row_ror:2 row_mask:0xf bank_mask:0xf
    v_add_f32 v78, v78, v78 row_ror:2 row_mask:0xf bank_mask:0xf
    v_add_f32 v79, v79, v79 row_ror:2 row_mask:0xf bank_mask:0xf
    v_add_f32 v76, v76, v76 row_ror:1 row_mask:0xf bank_mask:0xf
    v_add_f32 v77, v77, v77 row_ror:1 row_mask:0xf bank_mask:0xf
    v_add_f32 v78, v78, v78 row_ror:1 row_mask:0xf bank_mask:0xf
    v_add_f32 v79, v79, v79 row_ror:1 row_mask:0xf bank_mask:0xf
    v_cvt_pk_bf16_f32 v76, v76, v77
    v_cvt_pk_bf16_f32 v77, v78, v79
    v_lshlrev_b32 v5, 3, v3
    v_min_u32 v76, -2, v76
    v_min_u32 v77, -2, v77
    s_lshl_b32 s72, s68, 5
    s_add_u32 s72, s72, s85
    s_mov_b32 exec_lo, 0x00010001
    s_mov_b32 exec_hi, 0x00010001
    buffer_store_dwordx2 v[76:77], v5, s[20:23], s72 offen sc1
    s_mov_b64 exec, -1
    s_lshl_b32 s19, s52, 5
    s_add_u32 s19, s19, s53
    s_bfe_u32 s72, s19, 0x20005
    s_and_b32 s76, s72, 1
    s_lshl_b32 s76, s76, 5
    s_and_b32 s73, s19, 16
    s_add_u32 s76, s76, s73
    s_lshr_b32 s73, s72, 1
    s_add_u32 s76, s76, s73
    s_and_b32 s73, s19, 12
    s_lshl_b32 s73, s73, 7
    s_add_u32 s76, s76, s73
    s_mul_i32 s76, s76, 642
    s_and_b32 s75, s19, 3
    s_mul_i32 s75, s75, 160
    s_lshl_b32 s73, s68, 4
    s_add_u32 s13, s75, s73
    s_and_b32 s73, s72, 2
    s_add_u32 s13, s13, s73
    s_add_u32 s76, s76, s13
    v_lshrrev_b32 v5, 3, v1
    v_and_b32 v6, 7, v1
    v_lshl_add_u32 v5, v6, 5, v5
    v_mul_u32_u24 v244, 1284, v5
    s_mov_b32 s18, s76
    s_cmp_lg_u32 s3, 3
    s_cbranch_scc1 Lq_24
    s_mov_b64 exec, 3
    buffer_load_dword v251, v143, s[48:51], 0 offen sc1
    s_mov_b64 exec, -1
Lq_24:
    buffer_load_dwordx4 v[164:167], v244, s[28:31], s18 offen
    buffer_load_dwordx4 v[168:171], v244, s[28:31], s18 offen offset:64
    s_cmp_gt_u32 s68, 1
    s_cbranch_scc1 Lw_25
    buffer_load_dwordx4 v[172:175], v244, s[28:31], s18 offen offset:128
    s_cmp_lg_u32 s13, 0
    s_cbranch_scc1 Lw_25
    buffer_load_ushort v176, v244, s[28:31], s18 offen offset:640
Lw_25:
    s_bfe_u32 s72, s19, 0x20005
    s_lshl_b32 s72, s72, 11
    s_lshr_b32 s73, s19, 7
    s_lshl_b32 s73, s73, 10
    s_add_u32 s72, s72, s73
    s_bfe_u32 s73, s19, 0x20002
    s_lshl_b32 s73, s73, 8
    s_add_u32 s72, s72, s73
    s_bfe_u32 s73, s19, 0x10004
    s_lshl_b32 s73, s73, 7
    s_add_u32 s72, s72, s73
    s_add_u32 s72, s72, 11665408
    s_lshl_b32 s74, s68, 10
    s_add_u32 s74, s74, 157696
    v_lshrrev_b32 v5, 3, v1
    v_and_b32 v6, 7, v1
    v_xor_b32 v7, v5, v6
    v_lshl_add_u32 v7, v7, 4, s74
    v_lshl_add_u32 v245, v6, 7, v7
    v_lshl_add_u32 v250, v5, 7, v7
    v_add_u32 v246, s74, v4
    v_lshlrev_b32 v247, 4, v6
    s_lshr_b32 s73, s13, 1
    v_add_u32 v5, s73, v5
    v_cmp_ne_u32 vcc, 0x100, v5
    v_lshl_add_u32 v247, v5, 13, v247
    v_subrev_u32 v249, 2621440, v247
    v_cndmask_b32 v249, v249, v247, vcc
    v_add_u32 v249, 524288, v249
    v_bfe_u32 v5, v1, 1, 1
    v_lshl_add_u32 v5, v3, 1, v5
    v_bfe_u32 v6, v1, 2, 2
    v_lshl_add_u32 v5, v5, 3, v6
    v_and_b32 v6, 1, v1
    v_lshlrev_b32 v6, 3, v6
    v_lshl_add_u32 v5, v5, 4, v6
    v_add_u32 v248, s74, v5
    s_mov_b32 s17, s72
    s_cmp_lt_u32 s3, 2
    s_cbranch_scc1 Lq_22
    s_waitcnt vmcnt(2)
Lq_22:
    s_waitcnt vmcnt(3)
    s_cmp_lg_u32 s3, 3
    s_cbranch_scc1 Lq_23
    s_mov_b64 exec, 3
    v_cmp_gt_u32 vcc, s89, v251
    s_mov_b64 exec, -1
    s_nop 3
    s_cbranch_vccz Lq_23
    s_mov_b32 s88, 65536
    s_mov_b64 exec, 0x3
Lp_26:
    buffer_load_dword v6, v143, s[48:51], 0 offen sc1
    s_sub_u32 s88, s88, 1
    s_cbranch_scc1 Ld_27
    s_waitcnt vmcnt(0)
    v_cmpx_gt_u32 vcc, s89, v6
    s_nop 4
    s_cbranch_execz Ld_27
    s_sleep 12
    s_branch Lp_26
Ld_27:
    s_waitcnt vmcnt(0)
    s_mov_b64 exec, -1
Lq_23:
    v_mov_b32 v5, 161792
    v_mov_b32 v6, 1
    s_mov_b64 exec, 1
    ds_add_rtn_u32 v7, v5, v6
    s_waitcnt lgkmcnt(0)
    v_cmp_eq_u32 vcc, 3, v7
    s_mov_b64 exec, -1
    s_nop 3
    s_cbranch_vccz Lar_28
    v_lshlrev_b32 v5, 11, v1
    v_mov_b32 v6, 1
    s_bfm_b64 exec, 16, 0
    buffer_atomic_add v6, v5, s[20:23], s32 offen sc1
    s_mov_b64 exec, -1
Lsg_29:
Lar_28:
    v_mov_b32 v5, 161804
    v_mov_b32 v6, 1
    s_mov_b64 exec, 1
    ds_add_u32 v5, v6
Lhs_30:
    ds_read_b32 v6, v5
    s_waitcnt lgkmcnt(0)
    v_cmp_gt_u32 vcc, 4, v6
    s_nop 4
    s_cbranch_vccnz Lhs_30
    s_mov_b64 exec, -1
    s_cmp_ge_u32 s53, 20
    s_cbranch_scc1 Lk_31
    s_call_b64 s[70:71], Lcolearly
Lk_31:
    s_waitcnt vmcnt(0)
    s_cmp_lg_u32 s13, 0
    s_cbranch_scc1 Lw_32
    v_and_b32 v164, 0xffff0000, v164
    v_or_b32 v164, v164, v176
Lw_32:
    ds_write_b128 v246, v[164:167]
    ds_read_b64_tr_b16 v[164:165], v248 offset:0
    ds_read_b64_tr_b16 v[166:167], v248 offset:64
    ds_write_b128 v246, v[168:171]
    ds_read_b64_tr_b16 v[168:169], v248 offset:0
    ds_read_b64_tr_b16 v[170:171], v248 offset:64
    ds_write_b128 v246, v[172:175]
    ds_read_b64_tr_b16 v[172:173], v248 offset:0
    ds_read_b64_tr_b16 v[174:175], v248 offset:64
    s_waitcnt lgkmcnt(6)
    ds_write_b128 v245, v[164:167]
    ds_read_b128 v[164:167], v250
    s_waitcnt lgkmcnt(5)
    ds_write_b128 v245, v[168:171]
    ds_read_b128 v[168:171], v250
    s_waitcnt lgkmcnt(4)
    ds_write_b128 v245, v[172:175]
    ds_read_b128 v[172:175], v250
    s_waitcnt lgkmcnt(0)
    buffer_store_dwordx4 v[164:167], v247, s[20:23], s17 offen sc1
    s_add_u32 s74, s17, 262144
    buffer_store_dwordx4 v[168:171], v247, s[20:23], s74 offen sc1
    s_add_u32 s74, s17, 262144
    s_cmp_gt_u32 s68, 1
    s_cbranch_scc1 Lw_33
    buffer_store_dwordx4 v[172:175], v249, s[20:23], s17 offen sc1
    s_add_u32 s74, s17, 262144
Lw_33:
    s_branch Lq_16
Lq_12:
    s_waitcnt vmcnt(1)
    s_barrier
    s_lshl_b32 s19, s52, 5
    s_add_u32 s19, s19, s53
    s_bfe_u32 s72, s19, 0x20005
    s_and_b32 s76, s72, 1
    s_lshl_b32 s76, s76, 5
    s_and_b32 s73, s19, 16
    s_add_u32 s76, s76, s73
    s_lshr_b32 s73, s72, 1
    s_add_u32 s76, s76, s73
    s_and_b32 s73, s19, 12
    s_lshl_b32 s73, s73, 7
    s_add_u32 s76, s76, s73
    s_mul_i32 s76, s76, 642
    s_and_b32 s75, s19, 3
    s_mul_i32 s75, s75, 160
    s_lshl_b32 s73, s68, 4
    s_add_u32 s13, s75, s73
    s_and_b32 s73, s72, 2
    s_add_u32 s13, s13, s73
    s_add_u32 s76, s76, s13
    v_lshrrev_b32 v5, 3, v1
    v_and_b32 v6, 7, v1
    v_lshl_add_u32 v5, v6, 5, v5
    v_mul_u32_u24 v244, 1284, v5
    s_mov_b32 s18, s76
    v_lshrrev_b32 v5, 3, v1
    v_bfe_u32 v6, v1, 4, 1
    s_and_b32 s72, s3, 1
    s_lshl_b32 s72, s72, 1
    v_or_b32 v6, s72, v6
    v_lshlrev_b32 v6, 1, v6
    v_and_b32 v7, 7, v1
    v_xor_b32 v6, v6, v7
    v_mul_u32_u24 v5, 3840, v5
    v_lshl_add_u32 v58, v6, 4, v5
    s_mul_i32 s72, s68, 30720
    s_lshl_b32 s73, s60, 7
    s_add_u32 s72, s72, s73
    s_lshl_b32 s73, s68, 10
    s_barrier
    s_add_u32 m0, s73, 0
    s_nop 0
    buffer_load_dwordx4 v58, s[36:39], s72 offen lds
    s_add_u32 s72, s72, 122880
    s_add_u32 m0, s73, 4096
    s_nop 0
    buffer_load_dwordx4 v58, s[36:39], s72 offen lds
    s_add_u32 s72, s72, 122880
    s_add_u32 m0, s73, 8192
    s_nop 0
    buffer_load_dwordx4 v58, s[36:39], s72 offen lds
    s_add_u32 s72, s72, 122880
    s_add_u32 m0, s73, 12288
    s_nop 0
    buffer_load_dwordx4 v58, s[36:39], s72 offen lds
    s_add_u32 s72, s72, 122880
    s_add_u32 m0, s73, 16384
    s_nop 0
    buffer_load_dwordx4 v58, s[36:39], s72 offen lds
    s_add_u32 s72, s72, 122880
    s_add_u32 m0, s73, 20480
    s_nop 0
    buffer_load_dwordx4 v58, s[36:39], s72 offen lds
    s_add_u32 s72, s72, 122880
    s_add_u32 m0, s73, 24576
    s_nop 0
    buffer_load_dwordx4 v58, s[36:39], s72 offen lds
    s_add_u32 s72, s72, 122880
    s_add_u32 m0, s73, 28672
    s_nop 0
    buffer_load_dwordx4 v58, s[36:39], s72 offen lds
    s_add_u32 s72, s72, 122880
    s_add_u32 m0, s73, 32768
    s_nop 0
    buffer_load_dwordx4 v58, s[36:39], s72 offen lds
    s_add_u32 s72, s72, 122880
    s_add_u32 m0, s73, 36864
    s_nop 0
    buffer_load_dwordx4 v58, s[36:39], s72 offen lds
    s_add_u32 s72, s72, 122880
    s_add_u32 m0, s73, 40960
    s_nop 0
    buffer_load_dwordx4 v58, s[36:39], s72 offen lds
    s_add_u32 s72, s72, 122880
    s_add_u32 m0, s73, 45056
    s_nop 0
    buffer_load_dwordx4 v58, s[36:39], s72 offen lds
    s_add_u32 s72, s72, 122880
    s_add_u32 m0, s73, 49152
    s_nop 0
    buffer_load_dwordx4 v58, s[36:39], s72 offen lds
    s_add_u32 s72, s72, 122880
    s_add_u32 m0, s73, 53248
    s_nop 0
    buffer_load_dwordx4 v58, s[36:39], s72 offen lds
    s_add_u32 s72, s72, 122880
    s_add_u32 m0, s73, 57344
    s_nop 0
    buffer_load_dwordx4 v58, s[36:39], s72 offen lds
    s_add_u32 s72, s72, 122880
    s_add_u32 m0, s73, 61440
    s_nop 0
    buffer_load_dwordx4 v58, s[36:39], s72 offen lds
    s_add_u32 s72, s72, 122880
    s_add_u32 m0, s73, 65536
    s_nop 0
    buffer_load_dwordx4 v58, s[36:39], s72 offen lds
    s_add_u32 s72, s72, 122880
    s_add_u32 m0, s73, 69632
    s_nop 0
    buffer_load_dwordx4 v58, s[36:39], s72 offen lds
    s_add_u32 s72, s72, 122880
    s_add_u32 m0, s73, 73728
    s_nop 0
    buffer_load_dwordx4 v58, s[36:39], s72 offen lds
    s_add_u32 s72, s72, 122880
    s_add_u32 m0, s73, 77824
    s_nop 0
    buffer_load_dwordx4 v58, s[36:39], s72 offen lds
    s_add_u32 s72, s72, 122880
    s_cmp_eq_u32 s68, 3
    s_cbranch_scc1 Lq_34
    s_sub_u32 s73, s18, s13
    s_and_b32 s74, s53, 3
    s_mul_i32 s74, s74, 2568
    s_add_u32 s73, s73, s74
    s_lshl_b32 s74, s68, 8
    s_add_u32 s73, s73, s74
    v_and_b32 v5, 7, v1
    v_bfe_u32 v6, v1, 3, 1
    v_lshl_add_u32 v5, v5, 5, v6
    v_mul_u32_u24 v5, 1284, v5
    v_lshl_add_u32 v5, v3, 7, v5
    v_add_u32 v5, s73, v5
    v_and_b32 v5, 0xffffff80, v5
    s_mov_b32 exec_hi, 0
    buffer_load_dword v251, v5, s[28:31], 0 offen sc1
    s_mov_b32 exec_hi, -1
    s_branch Lq_35
Lq_34:
    s_mul_i32 s72, s2, 3200
    v_lshlrev_b32 v5, 7, v1
    s_bfm_b64 exec, 25, 0
    buffer_load_dword v251, v5, s[40:43], s72 offen
    s_mov_b64 exec, -1
Lq_35:
    v_bfe_u32 v5, v1, 2, 2
    v_lshl_add_u32 v6, v3, 3, v5
    v_lshlrev_b32 v6, 7, v6
    v_lshrrev_b32 v5, 1, v5
    v_and_b32 v7, 1, v3
    v_lshl_add_u32 v5, v7, 1, v5
    v_xor_b32 v5, s68, v5
    v_lshl_add_u32 v6, v5, 5, v6
    v_and_b32 v5, 3, v1
    v_lshl_add_u32 v56, v5, 3, v6
    v_add_u32 v57, 0xa000, v56
    s_lshl_b32 s72, s60, 6
    s_lshl_b32 s73, s68, 4
    s_add_u32 s72, s72, s73
    v_add_u32 v5, s72, v2
    s_cmp_ge_u32 s60, 10
    s_cselect_b32 s74, 1, 0
    s_cmp_ge_u32 s60, 20
    s_cselect_b32 s74, 2, s74
    s_mul_i32 s73, s74, 640
    v_subrev_u32 v5, s73, v5
    v_mul_u32_u24 v6, 3277, v5
    v_lshrrev_b32 v6, 16, v6
    v_mul_u32_u24 v7, 20, v6
    v_sub_u32 v7, v5, v7
    s_mov_b32 s73, 81920
    v_mul_lo_u32 v52, v6, s73
    s_lshl_b32 s75, s74, 4
    v_add_u32 v53, s75, v7
    s_lshl_b32 s75, s74, 2
    s_add_u32 s75, s75, 48
    v_add_u32 v55, s75, v7
    v_cmp_gt_u32 vcc, 16, v7
    s_nop 1
    v_cndmask_b32 v53, v55, v53, vcc
    v_add_u32 v55, 72, v7
    s_cmp_eq_u32 s74, 2
    s_cselect_b64 vcc, -1, 0
    v_cndmask_b32 v53, v53, v55, vcc
    v_lshl_add_u32 v52, v53, 4, v52
    v_subrev_u32 v5, 640, v5
    v_lshrrev_b32 v6, 2, v5
    v_mul_lo_u32 v6, v6, s73
    v_and_b32 v5, 3, v5
    v_lshl_add_u32 v6, v5, 4, v6
    v_add_u32 v6, 1472, v6
    s_cmp_ge_u32 s60, 30
    s_cselect_b64 vcc, -1, 0
    v_cndmask_b32 v52, v52, v6, vcc
    v_lshrrev_b32 v5, 1, v3
    v_lshl_add_u32 v52, v5, 9, v52
    v_and_b32 v5, 1, v3
    v_lshl_add_u32 v52, v5, 11, v52
    s_mov_b32 s87, 0x3d64f92e
    s_cmp_eq_u32 s74, 0
    s_cselect_b32 s75, 0x3c93bb63, s87
    s_mul_i32 s72, s59, 10240
    s_add_u32 s72, s72, 14286848
    v_mov_b32 v54, s75
    s_mov_b32 s78, s72
    s_cmp_ge_u32 s53, 20
    s_cbranch_scc1 Lk_36
    s_call_b64 s[70:71], Lcolearly
Lk_36:
    s_mov_b32 s72, s78
    s_waitcnt vmcnt(1)
    v_mov_b32 v5, 161800
    v_mov_b32 v6, 1
    s_mov_b64 exec, 1
    ds_add_u32 v5, v6
Lhs_37:
    ds_read_b32 v6, v5
    s_waitcnt lgkmcnt(0)
    v_cmp_gt_u32 vcc, 4, v6
    s_nop 4
    s_cbranch_vccnz Lhs_37
    s_mov_b64 exec, -1
    ds_read_b64_tr_b16 v[164:165], v56 offset:0
    ds_read_b64_tr_b16 v[166:167], v56 offset:512
    ds_read_b64_tr_b16 v[168:169], v56 offset:4096
    ds_read_b64_tr_b16 v[170:171], v56 offset:4608
    ds_read_b64_tr_b16 v[172:173], v56 offset:8192
    ds_read_b64_tr_b16 v[174:175], v56 offset:8704
    ds_read_b64_tr_b16 v[176:177], v56 offset:12288
    ds_read_b64_tr_b16 v[178:179], v56 offset:12800
    ds_read_b64_tr_b16 v[180:181], v56 offset:16384
    ds_read_b64_tr_b16 v[182:183], v56 offset:16896
    ds_read_b64_tr_b16 v[184:185], v56 offset:20480
    ds_read_b64_tr_b16 v[186:187], v56 offset:20992
    ds_read_b64_tr_b16 v[188:189], v56 offset:24576
    ds_read_b64_tr_b16 v[190:191], v56 offset:25088
    ds_read_b64_tr_b16 v[192:193], v56 offset:28672
    ds_read_b64_tr_b16 v[194:195], v56 offset:29184
    ds_read_b64_tr_b16 v[196:197], v56 offset:32768
    ds_read_b64_tr_b16 v[198:199], v56 offset:33280
    ds_read_b64_tr_b16 v[200:201], v56 offset:36864
    ds_read_b64_tr_b16 v[202:203], v56 offset:37376
    ds_read_b64_tr_b16 v[204:205], v57 offset:0
    ds_read_b64_tr_b16 v[206:207], v57 offset:512
    ds_read_b64_tr_b16 v[208:209], v57 offset:4096
    ds_read_b64_tr_b16 v[210:211], v57 offset:4608
    ds_read_b64_tr_b16 v[212:213], v57 offset:8192
    ds_read_b64_tr_b16 v[214:215], v57 offset:8704
    ds_read_b64_tr_b16 v[216:217], v57 offset:12288
    ds_read_b64_tr_b16 v[218:219], v57 offset:12800
    ds_read_b64_tr_b16 v[220:221], v57 offset:16384
    ds_read_b64_tr_b16 v[222:223], v57 offset:16896
    ds_read_b64_tr_b16 v[224:225], v57 offset:20480
    ds_read_b64_tr_b16 v[226:227], v57 offset:20992
    ds_read_b64_tr_b16 v[228:229], v57 offset:24576
    ds_read_b64_tr_b16 v[230:231], v57 offset:25088
    ds_read_b64_tr_b16 v[232:233], v57 offset:28672
    ds_read_b64_tr_b16 v[234:235], v57 offset:29184
    ds_read_b64_tr_b16 v[236:237], v57 offset:32768
    ds_read_b64_tr_b16 v[238:239], v57 offset:33280
    ds_read_b64_tr_b16 v[240:241], v57 offset:36864
    ds_read_b64_tr_b16 v[242:243], v57 offset:37376
    v_mov_b32 v5, 161808
    v_mov_b32 v6, 1
    s_mov_b64 exec, 1
    ds_add_u32 v5, v6
    s_mov_b64 exec, -1
    s_cmp_ge_u32 s60, 30
    s_cbranch_scc1 Lb_39
    v_add_u32 v6, 81920, v4
    ds_read_b128 v[60:63], v6 offset:0
    ds_read_b128 v[64:67], v6 offset:1024
    ds_read_b128 v[68:71], v6 offset:2048
    ds_read_b128 v[72:75], v6 offset:3072
    ds_read_b128 v[76:79], v6 offset:4096
    ds_read_b128 v[80:83], v6 offset:5120
    ds_read_b128 v[84:87], v6 offset:6144
    ds_read_b128 v[88:91], v6 offset:7168
    ds_read_b128 v[92:95], v6 offset:8192
    ds_read_b128 v[96:99], v6 offset:9216
    s_waitcnt lgkmcnt(5)
    v_mfma_f32_16x16x32_bf16 v[144:147], v[60:63], v[164:167], 0
    ds_read_b128 v[100:103], v6 offset:10240
    v_mfma_f32_16x16x32_bf16 v[120:123], v[60:63], v[204:207], 0
    v_mfma_f32_16x16x32_bf16 v[148:151], v[64:67], v[164:167], 0
    ds_read_b128 v[104:107], v6 offset:11264
    v_mfma_f32_16x16x32_bf16 v[124:127], v[64:67], v[204:207], 0
    v_mfma_f32_16x16x32_bf16 v[152:155], v[68:71], v[164:167], 0
    ds_read_b128 v[108:111], v6 offset:12288
    v_mfma_f32_16x16x32_bf16 v[128:131], v[68:71], v[204:207], 0
    v_mfma_f32_16x16x32_bf16 v[156:159], v[72:75], v[164:167], 0
    ds_read_b128 v[112:115], v6 offset:13312
    v_mfma_f32_16x16x32_bf16 v[132:135], v[72:75], v[204:207], 0
    v_mfma_f32_16x16x32_bf16 v[160:163], v[76:79], v[164:167], 0
    ds_read_b128 v[116:119], v6 offset:14336
    v_mfma_f32_16x16x32_bf16 v[136:139], v[76:79], v[204:207], 0
    s_waitcnt lgkmcnt(5)
    v_mfma_f32_16x16x32_bf16 v[144:147], v[80:83], v[168:171], v[144:147]
    ds_read_b128 v[60:63], v6 offset:15360
    v_mfma_f32_16x16x32_bf16 v[120:123], v[80:83], v[208:211], v[120:123]
    v_mfma_f32_16x16x32_bf16 v[148:151], v[84:87], v[168:171], v[148:151]
    ds_read_b128 v[64:67], v6 offset:16384
    v_mfma_f32_16x16x32_bf16 v[124:127], v[84:87], v[208:211], v[124:127]
    v_mfma_f32_16x16x32_bf16 v[152:155], v[88:91], v[168:171], v[152:155]
    ds_read_b128 v[68:71], v6 offset:17408
    v_mfma_f32_16x16x32_bf16 v[128:131], v[88:91], v[208:211], v[128:131]
    v_mfma_f32_16x16x32_bf16 v[156:159], v[92:95], v[168:171], v[156:159]
    ds_read_b128 v[72:75], v6 offset:18432
    v_mfma_f32_16x16x32_bf16 v[132:135], v[92:95], v[208:211], v[132:135]
    v_mfma_f32_16x16x32_bf16 v[160:163], v[96:99], v[168:171], v[160:163]
    ds_read_b128 v[76:79], v6 offset:19456
    v_mfma_f32_16x16x32_bf16 v[136:139], v[96:99], v[208:211], v[136:139]
    s_waitcnt lgkmcnt(5)
    v_mfma_f32_16x16x32_bf16 v[144:147], v[100:103], v[172:175], v[144:147]
    ds_read_b128 v[80:83], v6 offset:20480
    v_mfma_f32_16x16x32_bf16 v[120:123], v[100:103], v[212:215], v[120:123]
    v_mfma_f32_16x16x32_bf16 v[148:151], v[104:107], v[172:175], v[148:151]
    ds_read_b128 v[84:87], v6 offset:21504
    v_mfma_f32_16x16x32_bf16 v[124:127], v[104:107], v[212:215], v[124:127]
    v_mfma_f32_16x16x32_bf16 v[152:155], v[108:111], v[172:175], v[152:155]
    ds_read_b128 v[88:91], v6 offset:22528
    v_mfma_f32_16x16x32_bf16 v[128:131], v[108:111], v[212:215], v[128:131]
    v_mfma_f32_16x16x32_bf16 v[156:159], v[112:115], v[172:175], v[156:159]
    ds_read_b128 v[92:95], v6 offset:23552
    v_mfma_f32_16x16x32_bf16 v[132:135], v[112:115], v[212:215], v[132:135]
    v_mfma_f32_16x16x32_bf16 v[160:163], v[116:119], v[172:175], v[160:163]
    ds_read_b128 v[96:99], v6 offset:24576
    v_mfma_f32_16x16x32_bf16 v[136:139], v[116:119], v[212:215], v[136:139]
    s_waitcnt lgkmcnt(5)
    v_mfma_f32_16x16x32_bf16 v[144:147], v[60:63], v[176:179], v[144:147]
    ds_read_b128 v[100:103], v6 offset:25600
    v_mfma_f32_16x16x32_bf16 v[120:123], v[60:63], v[216:219], v[120:123]
    v_mfma_f32_16x16x32_bf16 v[148:151], v[64:67], v[176:179], v[148:151]
    ds_read_b128 v[104:107], v6 offset:26624
    v_mfma_f32_16x16x32_bf16 v[124:127], v[64:67], v[216:219], v[124:127]
    v_mfma_f32_16x16x32_bf16 v[152:155], v[68:71], v[176:179], v[152:155]
    ds_read_b128 v[108:111], v6 offset:27648
    v_mfma_f32_16x16x32_bf16 v[128:131], v[68:71], v[216:219], v[128:131]
    v_mfma_f32_16x16x32_bf16 v[156:159], v[72:75], v[176:179], v[156:159]
    ds_read_b128 v[112:115], v6 offset:28672
    v_mfma_f32_16x16x32_bf16 v[132:135], v[72:75], v[216:219], v[132:135]
    v_mfma_f32_16x16x32_bf16 v[160:163], v[76:79], v[176:179], v[160:163]
    ds_read_b128 v[116:119], v6 offset:29696
    v_mfma_f32_16x16x32_bf16 v[136:139], v[76:79], v[216:219], v[136:139]
    s_waitcnt lgkmcnt(5)
    v_mfma_f32_16x16x32_bf16 v[144:147], v[80:83], v[180:183], v[144:147]
    ds_read_b128 v[60:63], v6 offset:30720
    v_mfma_f32_16x16x32_bf16 v[120:123], v[80:83], v[220:223], v[120:123]
    v_mfma_f32_16x16x32_bf16 v[148:151], v[84:87], v[180:183], v[148:151]
    ds_read_b128 v[64:67], v6 offset:31744
    v_mfma_f32_16x16x32_bf16 v[124:127], v[84:87], v[220:223], v[124:127]
    v_mfma_f32_16x16x32_bf16 v[152:155], v[88:91], v[180:183], v[152:155]
    ds_read_b128 v[68:71], v6 offset:32768
    v_mfma_f32_16x16x32_bf16 v[128:131], v[88:91], v[220:223], v[128:131]
    v_mfma_f32_16x16x32_bf16 v[156:159], v[92:95], v[180:183], v[156:159]
    ds_read_b128 v[72:75], v6 offset:33792
    v_mfma_f32_16x16x32_bf16 v[132:135], v[92:95], v[220:223], v[132:135]
    v_mfma_f32_16x16x32_bf16 v[160:163], v[96:99], v[180:183], v[160:163]
    ds_read_b128 v[76:79], v6 offset:34816
    v_mfma_f32_16x16x32_bf16 v[136:139], v[96:99], v[220:223], v[136:139]
    s_waitcnt lgkmcnt(5)
    v_mfma_f32_16x16x32_bf16 v[144:147], v[100:103], v[184:187], v[144:147]
    ds_read_b128 v[80:83], v6 offset:35840
    v_mfma_f32_16x16x32_bf16 v[120:123], v[100:103], v[224:227], v[120:123]
    v_mfma_f32_16x16x32_bf16 v[148:151], v[104:107], v[184:187], v[148:151]
    ds_read_b128 v[84:87], v6 offset:36864
    v_mfma_f32_16x16x32_bf16 v[124:127], v[104:107], v[224:227], v[124:127]
    v_mfma_f32_16x16x32_bf16 v[152:155], v[108:111], v[184:187], v[152:155]
    ds_read_b128 v[88:91], v6 offset:37888
    v_mfma_f32_16x16x32_bf16 v[128:131], v[108:111], v[224:227], v[128:131]
    v_mfma_f32_16x16x32_bf16 v[156:159], v[112:115], v[184:187], v[156:159]
    ds_read_b128 v[92:95], v6 offset:38912
    v_mfma_f32_16x16x32_bf16 v[132:135], v[112:115], v[224:227], v[132:135]
    v_mfma_f32_16x16x32_bf16 v[160:163], v[116:119], v[184:187], v[160:163]
    ds_read_b128 v[96:99], v6 offset:39936
    v_mfma_f32_16x16x32_bf16 v[136:139], v[116:119], v[224:227], v[136:139]
    s_waitcnt lgkmcnt(5)
    v_mfma_f32_16x16x32_bf16 v[144:147], v[60:63], v[188:191], v[144:147]
    ds_read_b128 v[100:103], v6 offset:40960
    v_mfma_f32_16x16x32_bf16 v[120:123], v[60:63], v[228:231], v[120:123]
    v_mfma_f32_16x16x32_bf16 v[148:151], v[64:67], v[188:191], v[148:151]
    ds_read_b128 v[104:107], v6 offset:41984
    v_mfma_f32_16x16x32_bf16 v[124:127], v[64:67], v[228:231], v[124:127]
    v_mfma_f32_16x16x32_bf16 v[152:155], v[68:71], v[188:191], v[152:155]
    ds_read_b128 v[108:111], v6 offset:43008
    v_mfma_f32_16x16x32_bf16 v[128:131], v[68:71], v[228:231], v[128:131]
    v_mfma_f32_16x16x32_bf16 v[156:159], v[72:75], v[188:191], v[156:159]
    ds_read_b128 v[112:115], v6 offset:44032
    v_mfma_f32_16x16x32_bf16 v[132:135], v[72:75], v[228:231], v[132:135]
    v_mfma_f32_16x16x32_bf16 v[160:163], v[76:79], v[188:191], v[160:163]
    ds_read_b128 v[116:119], v6 offset:45056
    v_mfma_f32_16x16x32_bf16 v[136:139], v[76:79], v[228:231], v[136:139]
    s_waitcnt lgkmcnt(5)
    v_mfma_f32_16x16x32_bf16 v[144:147], v[80:83], v[192:195], v[144:147]
    ds_read_b128 v[60:63], v6 offset:46080
    v_mfma_f32_16x16x32_bf16 v[120:123], v[80:83], v[232:235], v[120:123]
    v_mfma_f32_16x16x32_bf16 v[148:151], v[84:87], v[192:195], v[148:151]
    ds_read_b128 v[64:67], v6 offset:47104
    v_mfma_f32_16x16x32_bf16 v[124:127], v[84:87], v[232:235], v[124:127]
    v_mfma_f32_16x16x32_bf16 v[152:155], v[88:91], v[192:195], v[152:155]
    ds_read_b128 v[68:71], v6 offset:48128
    v_mfma_f32_16x16x32_bf16 v[128:131], v[88:91], v[232:235], v[128:131]
    v_mfma_f32_16x16x32_bf16 v[156:159], v[92:95], v[192:195], v[156:159]
    ds_read_b128 v[72:75], v6 offset:49152
    v_mfma_f32_16x16x32_bf16 v[132:135], v[92:95], v[232:235], v[132:135]
    v_mfma_f32_16x16x32_bf16 v[160:163], v[96:99], v[192:195], v[160:163]
    ds_read_b128 v[76:79], v6 offset:50176
    v_mfma_f32_16x16x32_bf16 v[136:139], v[96:99], v[232:235], v[136:139]
    s_waitcnt lgkmcnt(5)
    v_mfma_f32_16x16x32_bf16 v[144:147], v[100:103], v[196:199], v[144:147]
    v_mfma_f32_16x16x32_bf16 v[120:123], v[100:103], v[236:239], v[120:123]
    v_mfma_f32_16x16x32_bf16 v[148:151], v[104:107], v[196:199], v[148:151]
    v_mfma_f32_16x16x32_bf16 v[124:127], v[104:107], v[236:239], v[124:127]
    v_mfma_f32_16x16x32_bf16 v[152:155], v[108:111], v[196:199], v[152:155]
    v_mfma_f32_16x16x32_bf16 v[128:131], v[108:111], v[236:239], v[128:131]
    v_mfma_f32_16x16x32_bf16 v[156:159], v[112:115], v[196:199], v[156:159]
    v_mfma_f32_16x16x32_bf16 v[132:135], v[112:115], v[236:239], v[132:135]
    v_mfma_f32_16x16x32_bf16 v[160:163], v[116:119], v[196:199], v[160:163]
    v_mfma_f32_16x16x32_bf16 v[136:139], v[116:119], v[236:239], v[136:139]
    s_waitcnt lgkmcnt(0)
    v_mfma_f32_16x16x32_bf16 v[144:147], v[60:63], v[200:203], v[144:147]
    v_mfma_f32_16x16x32_bf16 v[120:123], v[60:63], v[240:243], v[120:123]
    v_mfma_f32_16x16x32_bf16 v[148:151], v[64:67], v[200:203], v[148:151]
    v_mfma_f32_16x16x32_bf16 v[124:127], v[64:67], v[240:243], v[124:127]
    v_mfma_f32_16x16x32_bf16 v[152:155], v[68:71], v[200:203], v[152:155]
    v_mfma_f32_16x16x32_bf16 v[128:131], v[68:71], v[240:243], v[128:131]
    v_mfma_f32_16x16x32_bf16 v[156:159], v[72:75], v[200:203], v[156:159]
    v_mfma_f32_16x16x32_bf16 v[132:135], v[72:75], v[240:243], v[132:135]
    v_mfma_f32_16x16x32_bf16 v[160:163], v[76:79], v[200:203], v[160:163]
    v_mfma_f32_16x16x32_bf16 v[136:139], v[76:79], v[240:243], v[136:139]
    v_pk_add_f32 v[144:145], v[144:145], v[120:121]
    v_pk_add_f32 v[146:147], v[146:147], v[122:123] neg_lo:[0,1] neg_hi:[0,1]
    v_pk_mul_f32 v[144:145], v[144:145], v[54:55] op_sel_hi:[1,0]
    v_pk_mul_f32 v[146:147], v[146:147], v[54:55] op_sel_hi:[1,0]
    v_pk_add_f32 v[148:149], v[148:149], v[124:125]
    v_pk_add_f32 v[150:151], v[150:151], v[126:127] neg_lo:[0,1] neg_hi:[0,1]
    v_pk_mul_f32 v[148:149], v[148:149], v[54:55] op_sel_hi:[1,0]
    v_pk_mul_f32 v[150:151], v[150:151], v[54:55] op_sel_hi:[1,0]
    v_pk_add_f32 v[152:153], v[152:153], v[128:129]
    v_pk_add_f32 v[154:155], v[154:155], v[130:131] neg_lo:[0,1] neg_hi:[0,1]
    v_pk_mul_f32 v[152:153], v[152:153], v[54:55] op_sel_hi:[1,0]
    v_pk_mul_f32 v[154:155], v[154:155], v[54:55] op_sel_hi:[1,0]
    v_pk_add_f32 v[156:157], v[156:157], v[132:133]
    v_pk_add_f32 v[158:159], v[158:159], v[134:135] neg_lo:[0,1] neg_hi:[0,1]
    v_pk_mul_f32 v[156:157], v[156:157], v[54:55] op_sel_hi:[1,0]
    v_pk_mul_f32 v[158:159], v[158:159], v[54:55] op_sel_hi:[1,0]
    v_pk_add_f32 v[160:161], v[160:161], v[136:137]
    v_pk_add_f32 v[162:163], v[162:163], v[138:139] neg_lo:[0,1] neg_hi:[0,1]
    v_pk_mul_f32 v[160:161], v[160:161], v[54:55] op_sel_hi:[1,0]
    v_pk_mul_f32 v[162:163], v[162:163], v[54:55] op_sel_hi:[1,0]
    s_cmp_eq_u32 s59, 0
    s_cselect_b32 s73, 16, 0
    v_cmp_le_u32 vcc, s73, v1
    v_mul_f32 v5, 0x3f3504f3, v144
    s_nop 0
    v_cndmask_b32 v144, v5, v144, vcc
    v_cndmask_b32 v145, 0, v145, vcc
    v_cvt_pk_bf16_f32 v60, v144, v145
    v_cvt_pk_bf16_f32 v61, v146, v147
    v_cvt_pk_bf16_f32 v62, v148, v149
    v_cvt_pk_bf16_f32 v63, v150, v151
    v_cvt_pk_bf16_f32 v64, v152, v153
    v_cvt_pk_bf16_f32 v65, v154, v155
    v_cvt_pk_bf16_f32 v66, v156, v157
    v_cvt_pk_bf16_f32 v67, v158, v159
    v_cvt_pk_bf16_f32 v68, v160, v161
    v_cvt_pk_bf16_f32 v69, v162, v163
Lb_40:
    v_permlane16_swap_b32 v60, v62
    v_permlane16_swap_b32 v61, v63
    buffer_store_dwordx4 v[60:63], v52, s[20:23], s72 offen sc1
    s_add_u32 s72, s72, 4096
    v_permlane16_swap_b32 v64, v66
    v_permlane16_swap_b32 v65, v67
    buffer_store_dwordx4 v[64:67], v52, s[20:23], s72 offen sc1
    s_add_u32 s72, s72, 4096
    v_permlane16_swap_b32 v68, v70
    v_permlane16_swap_b32 v69, v71
    s_mov_b32 exec_lo, 0xffff
    s_mov_b32 exec_hi, 0xffff
    buffer_store_dwordx4 v[68:71], v52, s[20:23], s72 offen sc1
    s_add_u32 s72, s72, 4096
    s_mov_b64 exec, -1
Lb_38:
    v_mov_b32 v5, 161804
    v_mov_b32 v6, 1
    s_mov_b64 exec, 1
Lhs_41:
    ds_read_b32 v6, v5
    s_waitcnt lgkmcnt(0)
    v_cmp_gt_u32 vcc, 4, v6
    s_nop 4
    s_cbranch_vccnz Lhs_41
    s_mov_b64 exec, -1
Lq_16:
    s_mov_b32 s61, 1048576
    s_mov_b32 s62, 3670016
    s_mov_b32 s63, 19365888
    s_mov_b32 s64, 29851648
    s_mov_b32 s65, 11534336
    s_mov_b32 s35, 0
Llayer:
    s_cmp_ge_u32 s53, 20
    s_cbranch_scc1 Lm_42
    s_lshl_b32 s72, s3, 8
    s_add_u32 s72, s72, s33
    s_add_u32 s72, s72, s66
    v_lshlrev_b32 v5, 7, v1
    v_mov_b32 v240, 0
    s_mov_b64 exec, 3
    buffer_atomic_add v240, v5, s[20:23], s72 offen sc0 sc1
    s_mov_b64 exec, -1
    s_lshl_b32 s74, s68, 8
    s_add_u32 s74, s74, 145408
    v_lshrrev_b32 v7, 2, v2
    v_and_b32 v6, 3, v2
    v_lshl_add_u32 v7, v7, 3, v6
    v_lshlrev_b32 v5, 10, v3
    v_lshl_add_u32 v6, v2, 4, v5
    v_add_u32 v6, s74, v6
    v_lshl_add_u32 v5, v7, 4, v5
    v_add_u32 v5, 145408, v5
    v_lshlrev_b32 v19, 9, v3
    v_lshl_add_u32 v19, v7, 4, v19
    v_add_u32 v19, 149504, v19
    ds_read_b128 v[56:59], v6 offset:6144
    ds_read_b128 v[72:75], v5 offset:6144
    ds_read_b128 v[104:107], v19 offset:6144
    ds_read_b128 v[76:79], v5 offset:6208
    ds_read_b128 v[108:111], v19 offset:6208
    ds_read_b128 v[52:55], v6
    ds_read_b128 v[64:67], v5 offset:0
    ds_read_b128 v[96:99], v19 offset:0
    ds_read_b128 v[68:71], v5 offset:64
    ds_read_b128 v[100:103], v19 offset:64
    s_bitcmp0_b32 s68, 0
    s_cselect_b32 s75, 0x80008000, 0
    s_mov_b32 s74, 0x80008000
    s_mov_b32 s76, 0x3acccccd
    s_mov_b32 s87, 0x3a000000
    s_lshl_b32 s72, s69, 3
    s_add_u32 s72, s72, s68
    s_mul_i32 s84, s72, 163840
    s_lshr_b32 s73, s4, 2
    s_lshl_b32 s73, s73, 10
    s_add_u32 s84, s84, s73
    s_add_u32 s84, s84, s61
    s_add_u32 s85, s84, 655360
    s_lshl_b32 s77, s72, 11
    s_add_u32 s77, s77, s65
    s_add_u32 s86, s77, 8192
    s_cmp_eq_u32 s4, 1
    s_cselect_b32 s87, 0, s87
    v_mov_b32 v232, 0
    v_mov_b32 v233, 0
    v_mov_b32 v234, v16
    v_mov_b32 v235, v17
    v_mov_b32 v236, 0
    v_mov_b32 v237, 0
    s_add_u32 s82, s5, s62
    s_add_u32 s83, s82, 655360
    s_waitcnt lgkmcnt(5)
    v_xor_b32 v60, s74, v56
    v_xor_b32 v61, s74, v57
    v_xor_b32 v62, s74, v58
    v_xor_b32 v63, s74, v59
    v_xor_b32 v80, s74, v72
    v_xor_b32 v88, s75, v72
    v_xor_b32 v104, s75, v104
    v_xor_b32 v81, s74, v73
    v_xor_b32 v89, s75, v73
    v_xor_b32 v105, s75, v105
    v_xor_b32 v82, s74, v74
    v_xor_b32 v90, s75, v74
    v_xor_b32 v106, s75, v106
    v_xor_b32 v83, s74, v75
    v_xor_b32 v91, s75, v75
    v_xor_b32 v107, s75, v107
    v_xor_b32 v84, s74, v76
    v_xor_b32 v92, s75, v76
    v_xor_b32 v108, s75, v108
    v_xor_b32 v85, s74, v77
    v_xor_b32 v93, s75, v77
    v_xor_b32 v109, s75, v109
    v_xor_b32 v86, s74, v78
    v_xor_b32 v94, s75, v78
    v_xor_b32 v110, s75, v110
    v_xor_b32 v87, s74, v79
    v_xor_b32 v95, s75, v79
    v_xor_b32 v111, s75, v111
    s_mov_b32 s35, 1
    s_lshl_b32 s78, s68, 12
    s_mul_i32 s79, s55, 81920
    s_add_u32 s79, s79, 14286848
    s_mul_i32 s80, s3, 10240
    s_add_u32 s81, s79, s80
    s_add_u32 s79, s79, s78
    s_cmp_eq_u32 s58, 0
    s_cbranch_scc1 Lk_55
    buffer_load_dwordx4 v[112:115], v4, s[20:23], s10 offen sc1
    buffer_load_dwordx4 v[116:119], v4, s[20:23], s10 offen offset:1024 sc1
    s_branch Lk_58
Lk_55:
    s_cmp_lg_u32 s69, 0
    s_cbranch_scc1 Lk_58
    v_mov_b32 v192, -1
    v_mov_b32 v193, -1
    v_mov_b32 v194, -1
    v_mov_b32 v195, -1
    buffer_store_dwordx4 v[192:195], v11, s[20:23], s82 offen offset:0 sc1
    buffer_store_dwordx4 v[192:195], v11, s[20:23], s82 offen offset:512 sc1
    buffer_store_dwordx4 v[192:195], v11, s[20:23], s83 offen offset:0 sc1
    buffer_store_dwordx4 v[192:195], v11, s[20:23], s83 offen offset:512 sc1
Lk_58:
    s_lshl_b32 s72, s3, 8
    s_add_u32 s72, s72, s33
    s_add_u32 s73, s72, 262144
    s_add_u32 s72, s72, s66
    v_lshlrev_b32 v5, 7, v1
    s_waitcnt vmcnt(0)
    s_mov_b64 exec, 3
    v_cmp_gt_u32 vcc, 16, v240
    s_mov_b64 exec, -1
    s_nop 3
    s_cbranch_vccz Lk_61
    v_lshlrev_b32 v5, 7, v1
    s_mov_b32 s88, 65536
    s_mov_b64 exec, 0x3
Lp_62:
    v_mov_b32 v6, 0
    buffer_atomic_add v6, v5, s[20:23], s72 offen sc0 sc1
    s_sub_u32 s88, s88, 1
    s_cbranch_scc1 Ld_63
    s_waitcnt vmcnt(0)
    v_cmpx_gt_u32 vcc, 16, v6
    s_nop 4
    s_cbranch_execnz Lp_62
Ld_63:
    s_waitcnt vmcnt(0)
    s_mov_b64 exec, -1
Lk_61:
    s_barrier
    s_cmp_lg_u32 s58, 0
    s_cbranch_scc1 Lk_59
    s_add_u32 s72, s32, 262144
    s_cmp_lg_u32 s3, 0
    s_cbranch_scc1 Lsg_64
    v_lshlrev_b32 v5, 11, v1
    v_mov_b32 v6, 1
    s_bfm_b64 exec, 16, 0
    buffer_atomic_add v6, v5, s[20:23], s72 offen sc1
    s_mov_b64 exec, -1
Lsg_64:
    v_lshlrev_b32 v5, 7, v1
Lk_59:
    s_mov_b32 s88, 65536
Lk_56:
    buffer_load_dwordx4 v[192:195], v4, s[20:23], s77 offen offset:0 sc1
    buffer_load_dwordx4 v[196:199], v4, s[20:23], s77 offen offset:1024 sc1
    buffer_load_dwordx4 v[200:203], v4, s[20:23], s86 offen offset:0 sc1
    buffer_load_dwordx4 v[204:207], v4, s[20:23], s86 offen offset:1024 sc1
    buffer_load_dwordx4 v[136:139], v4, s[20:23], s84 offen sc1
    buffer_load_dwordx4 v[140:143], v4, s[20:23], s85 offen sc1
    s_mov_b64 exec, 3
    v_mov_b32 v19, 0
    buffer_atomic_add v19, v5, s[20:23], s73 offen sc0 sc1
    s_mov_b64 exec, -1
    s_waitcnt vmcnt(5)
    v_mfma_f32_16x16x32_bf16 v[160:163], v[234:237], v[192:195], 0
    v_mfma_f32_16x16x32_bf16 v[164:167], v[232:235], v[192:195], 0
    v_mfma_f32_16x16x32_bf16 v[160:163], v[234:237], v[196:199], v[160:163]
    v_mfma_f32_16x16x32_bf16 v[164:167], v[232:235], v[196:199], v[164:167]
    s_waitcnt vmcnt(3)
    v_mfma_f32_16x16x32_bf16 v[168:171], v[234:237], v[200:203], 0
    v_mfma_f32_16x16x32_bf16 v[172:175], v[232:235], v[200:203], 0
    v_mfma_f32_16x16x32_bf16 v[168:171], v[234:237], v[204:207], v[168:171]
    v_mfma_f32_16x16x32_bf16 v[172:175], v[232:235], v[204:207], v[172:175]
    v_max3_u32 v6, v192, v193, v194
    v_max3_u32 v6, v6, v195, v196
    v_max3_u32 v6, v6, v197, v198
    v_max3_u32 v6, v6, v199, v200
    v_max3_u32 v6, v6, v201, v202
    v_max3_u32 v6, v6, v203, v204
    v_max3_u32 v6, v6, v205, v206
    v_max_u32 v6, v6, v207
    v_fma_f32 v160, v160, s76, v18
    v_fma_f32 v161, v161, s76, v18
    v_fma_f32 v162, v162, s76, v18
    v_fma_f32 v163, v163, s76, v18
    v_fma_f32 v164, v164, s76, v18
    v_fma_f32 v165, v165, s76, v18
    v_fma_f32 v166, v166, s76, v18
    v_fma_f32 v167, v167, s76, v18
    v_fma_f32 v168, v168, s76, v18
    v_fma_f32 v169, v169, s76, v18
    v_fma_f32 v170, v170, s76, v18
    v_fma_f32 v171, v171, s76, v18
    v_fma_f32 v172, v172, s76, v18
    v_fma_f32 v173, v173, s76, v18
    v_fma_f32 v174, v174, s76, v18
    v_fma_f32 v175, v175, s76, v18
    v_rsq_f32 v160, v160
    v_rsq_f32 v161, v161
    v_rsq_f32 v162, v162
    v_rsq_f32 v163, v163
    v_rsq_f32 v164, v164
    v_rsq_f32 v165, v165
    v_rsq_f32 v166, v166
    v_rsq_f32 v167, v167
    v_rsq_f32 v168, v168
    v_rsq_f32 v169, v169
    v_rsq_f32 v170, v170
    v_rsq_f32 v171, v171
    v_rsq_f32 v172, v172
    v_rsq_f32 v173, v173
    v_rsq_f32 v174, v174
    v_rsq_f32 v175, v175
    s_waitcnt vmcnt(1)
    v_max3_u32 v6, v6, v136, v137
    v_max3_u32 v6, v6, v138, v139
    v_max3_u32 v6, v6, v140, v141
    v_max3_u32 v6, v6, v142, v143
    v_cmp_eq_u32 vcc, -1, v6
    ds_write_b128 v12, v[136:139]
    ds_write_b128 v12, v[140:143] offset:1024
    v_lshlrev_b32 v144, 16, v136
    v_and_b32 v145, 0xffff0000, v136
    v_lshlrev_b32 v146, 16, v137
    v_and_b32 v147, 0xffff0000, v137
    v_lshlrev_b32 v148, 16, v138
    v_and_b32 v149, 0xffff0000, v138
    v_lshlrev_b32 v150, 16, v139
    v_and_b32 v151, 0xffff0000, v139
    v_lshlrev_b32 v152, 16, v140
    v_and_b32 v153, 0xffff0000, v140
    v_lshlrev_b32 v154, 16, v141
    v_and_b32 v155, 0xffff0000, v141
    v_lshlrev_b32 v156, 16, v142
    v_and_b32 v157, 0xffff0000, v142
    v_lshlrev_b32 v158, 16, v143
    v_and_b32 v159, 0xffff0000, v143
    s_cbranch_vccz Lk_57
    s_waitcnt vmcnt(0)
    s_sub_u32 s88, s88, 1
    s_cbranch_scc0 Lk_56
Lk_57:
    s_cmp_gt_u32 s4, 3
    s_cbranch_scc1 Lnz_54
    s_mov_b32 exec_lo, 0xffff0000
    s_mov_b32 exec_hi, 0
    v_mov_b32 v160, 0
    v_mov_b32 v161, 0
    v_mov_b32 v162, 0
    v_mov_b32 v163, 0
    v_mov_b32 v164, 0
    v_mov_b32 v165, 0
    v_mov_b32 v166, 0
    v_mov_b32 v167, 0
    v_mov_b32 v168, 0
    v_mov_b32 v169, 0
    v_mov_b32 v170, 0
    v_mov_b32 v171, 0
    v_mov_b32 v172, 0
    v_mov_b32 v173, 0
    v_mov_b32 v174, 0
    v_mov_b32 v175, 0
    s_mov_b64 exec, -1
Lnz_54:
    v_pk_mul_f32 v[176:177], v[144:145], v[160:161]
    v_pk_fma_f32 v[192:193], v[152:153], v[168:169], v[176:177]
    v_pk_fma_f32 v[200:201], v[152:153], v[168:169], v[176:177] neg_lo:[1,0,0] neg_hi:[1,0,0]
    v_pk_mul_f32 v[178:179], v[146:147], v[162:163]
    v_pk_fma_f32 v[194:195], v[154:155], v[170:171], v[178:179]
    v_pk_fma_f32 v[202:203], v[154:155], v[170:171], v[178:179] neg_lo:[1,0,0] neg_hi:[1,0,0]
    v_pk_mul_f32 v[180:181], v[148:149], v[164:165]
    v_pk_fma_f32 v[196:197], v[156:157], v[172:173], v[180:181]
    v_pk_fma_f32 v[204:205], v[156:157], v[172:173], v[180:181] neg_lo:[1,0,0] neg_hi:[1,0,0]
    v_pk_mul_f32 v[182:183], v[150:151], v[166:167]
    v_pk_fma_f32 v[198:199], v[158:159], v[174:175], v[182:183]
    v_pk_fma_f32 v[206:207], v[158:159], v[174:175], v[182:183] neg_lo:[1,0,0] neg_hi:[1,0,0]
    v_cvt_pk_bf16_f32 v208, v192, v193
    v_cvt_pk_bf16_f32 v209, v194, v195
    v_cvt_pk_bf16_f32 v210, v196, v197
    v_cvt_pk_bf16_f32 v211, v198, v199
    ds_write_b128 v14, v[208:211]
    v_cvt_pk_bf16_f32 v212, v200, v201
    v_cvt_pk_bf16_f32 v213, v202, v203
    v_cvt_pk_bf16_f32 v214, v204, v205
    v_cvt_pk_bf16_f32 v215, v206, v207
    ds_write_b128 v14, v[212:215] offset:4096
    s_waitcnt vmcnt(0)
    s_mov_b64 exec, 3
    v_cmp_gt_u32 vcc, 16, v19
    s_mov_b64 exec, -1
    s_nop 3
    s_cbranch_vccz Lk_60
    s_mov_b32 s88, 65536
    s_mov_b64 exec, 0x3
Lp_65:
    v_mov_b32 v6, 0
    buffer_atomic_add v6, v5, s[20:23], s73 offen sc0 sc1
    s_sub_u32 s88, s88, 1
    s_cbranch_scc1 Ld_66
    s_waitcnt vmcnt(0)
    v_cmpx_gt_u32 vcc, 16, v6
    s_nop 4
    s_cbranch_execnz Lp_65
Ld_66:
    s_waitcnt vmcnt(0)
    s_mov_b64 exec, -1
Lk_60:
    s_waitcnt lgkmcnt(0)
    s_barrier
    ds_read_b128 v[216:219], v15 offset:0
    ds_read_b128 v[220:223], v15 offset:1024
    ds_read_b128 v[224:227], v15 offset:2048
    ds_read_b128 v[228:231], v15 offset:3072
    s_cmp_lg_u32 s58, 0
    s_cbranch_scc1 Lk_67
    buffer_load_dwordx4 v[112:115], v4, s[20:23], s10 offen sc1
    buffer_load_dwordx4 v[116:119], v4, s[20:23], s10 offen offset:1024 sc1
Lk_67:
    s_add_u32 m0, s80, 0
    s_add_u32 s72, s81, 0
    buffer_load_dwordx4 v4, s[20:23], s72 offen offset:0 sc1 lds
    buffer_load_dwordx4 v4, s[20:23], s72 offen offset:1024 sc1 lds
    s_waitcnt lgkmcnt(2)
    v_mfma_f32_16x16x32_bf16 v[176:179], v[216:219], v[52:55], 0
    v_mfma_f32_16x16x32_bf16 v[184:187], v[216:219], v[60:63], 0
    v_mfma_f32_16x16x32_bf16 v[180:183], v[220:223], v[52:55], 0
    v_mfma_f32_16x16x32_bf16 v[188:191], v[220:223], v[60:63], 0
    s_waitcnt lgkmcnt(0)
    v_mfma_f32_16x16x32_bf16 v[176:179], v[224:227], v[56:59], v[176:179]
    v_mfma_f32_16x16x32_bf16 v[184:187], v[224:227], v[52:55], v[184:187]
    v_mfma_f32_16x16x32_bf16 v[180:183], v[228:231], v[56:59], v[180:183]
    v_mfma_f32_16x16x32_bf16 v[188:191], v[228:231], v[52:55], v[188:191]
    s_add_u32 m0, s80, 2048
    s_add_u32 s72, s81, 2048
    buffer_load_dwordx4 v4, s[20:23], s72 offen offset:0 sc1 lds
    buffer_load_dwordx4 v4, s[20:23], s72 offen offset:1024 sc1 lds
    s_nop 0
    v_pk_mul_f32 v[192:193], v[176:177], v[20:21]
    v_pk_mul_f32 v[200:201], v[184:185], v[20:21]
    v_pk_fma_f32 v[192:193], v[184:185], v[28:29], v[192:193] neg_lo:[1,0,0] neg_hi:[1,0,0]
    v_pk_fma_f32 v[200:201], v[176:177], v[28:29], v[200:201]
    v_pk_mul_f32 v[194:195], v[178:179], v[22:23]
    v_pk_mul_f32 v[202:203], v[186:187], v[22:23]
    v_pk_fma_f32 v[194:195], v[186:187], v[30:31], v[194:195] neg_lo:[1,0,0] neg_hi:[1,0,0]
    v_pk_fma_f32 v[202:203], v[178:179], v[30:31], v[202:203]
    v_pk_mul_f32 v[196:197], v[180:181], v[24:25]
    v_pk_mul_f32 v[204:205], v[188:189], v[24:25]
    v_pk_fma_f32 v[196:197], v[188:189], v[32:33], v[196:197] neg_lo:[1,0,0] neg_hi:[1,0,0]
    v_pk_fma_f32 v[204:205], v[180:181], v[32:33], v[204:205]
    v_pk_mul_f32 v[198:199], v[182:183], v[26:27]
    v_pk_mul_f32 v[206:207], v[190:191], v[26:27]
    v_pk_fma_f32 v[198:199], v[190:191], v[34:35], v[198:199] neg_lo:[1,0,0] neg_hi:[1,0,0]
    v_pk_fma_f32 v[206:207], v[182:183], v[34:35], v[206:207]
    v_cvt_pk_bf16_f32 v208, v192, v193
    v_cvt_pk_bf16_f32 v212, v200, v201
    v_cvt_pk_bf16_f32 v209, v194, v195
    v_cvt_pk_bf16_f32 v213, v202, v203
    v_cvt_pk_bf16_f32 v210, v196, v197
    v_cvt_pk_bf16_f32 v214, v204, v205
    v_cvt_pk_bf16_f32 v211, v198, v199
    v_cvt_pk_bf16_f32 v215, v206, v207
    s_nop 0
    v_mfma_f32_16x16x32_bf16 v[176:179], v[64:67], v[208:211], 0
    v_mfma_f32_16x16x32_bf16 v[184:187], v[80:83], v[208:211], 0
    v_mfma_f32_16x16x32_bf16 v[180:183], v[68:71], v[208:211], 0
    v_mfma_f32_16x16x32_bf16 v[188:191], v[84:87], v[208:211], 0
    v_mfma_f32_16x16x32_bf16 v[176:179], v[72:75], v[212:215], v[176:179]
    v_mfma_f32_16x16x32_bf16 v[184:187], v[64:67], v[212:215], v[184:187]
    v_mfma_f32_16x16x32_bf16 v[180:183], v[76:79], v[212:215], v[180:183]
    v_mfma_f32_16x16x32_bf16 v[188:191], v[68:71], v[212:215], v[188:191]
    s_add_u32 m0, s80, 4096
    s_add_u32 s72, s81, 4096
    buffer_load_dwordx4 v4, s[20:23], s72 offen offset:0 sc1 lds
    buffer_load_dwordx4 v4, s[20:23], s72 offen offset:1024 sc1 lds
    s_waitcnt vmcnt(6)
    v_lshlrev_b32 v120, 16, v112
    v_and_b32 v121, 0xffff0000, v112
    v_lshlrev_b32 v122, 16, v113
    v_and_b32 v123, 0xffff0000, v113
    v_lshlrev_b32 v124, 16, v114
    v_and_b32 v125, 0xffff0000, v114
    v_lshlrev_b32 v126, 16, v115
    v_and_b32 v127, 0xffff0000, v115
    v_lshlrev_b32 v128, 16, v116
    v_and_b32 v129, 0xffff0000, v116
    v_lshlrev_b32 v130, 16, v117
    v_and_b32 v131, 0xffff0000, v117
    v_lshlrev_b32 v132, 16, v118
    v_and_b32 v133, 0xffff0000, v118
    v_lshlrev_b32 v134, 16, v119
    v_and_b32 v135, 0xffff0000, v119
    v_pk_mul_f32 v[192:193], v[176:177], v[120:121]
    v_pk_mul_f32 v[200:201], v[184:185], v[120:121]
    v_pk_fma_f32 v[192:193], v[184:185], v[128:129], v[192:193] neg_lo:[1,0,0] neg_hi:[1,0,0]
    v_pk_fma_f32 v[200:201], v[176:177], v[128:129], v[200:201]
    v_pk_mul_f32 v[194:195], v[178:179], v[122:123]
    v_pk_mul_f32 v[202:203], v[186:187], v[122:123]
    v_pk_fma_f32 v[194:195], v[186:187], v[130:131], v[194:195] neg_lo:[1,0,0] neg_hi:[1,0,0]
    v_pk_fma_f32 v[202:203], v[178:179], v[130:131], v[202:203]
    v_pk_mul_f32 v[196:197], v[180:181], v[124:125]
    v_pk_mul_f32 v[204:205], v[188:189], v[124:125]
    v_pk_fma_f32 v[196:197], v[188:189], v[132:133], v[196:197] neg_lo:[1,0,0] neg_hi:[1,0,0]
    v_pk_fma_f32 v[204:205], v[180:181], v[132:133], v[204:205]
    v_pk_mul_f32 v[198:199], v[182:183], v[126:127]
    v_pk_mul_f32 v[206:207], v[190:191], v[126:127]
    v_pk_fma_f32 v[198:199], v[190:191], v[134:135], v[198:199] neg_lo:[1,0,0] neg_hi:[1,0,0]
    v_pk_fma_f32 v[206:207], v[182:183], v[134:135], v[206:207]
    v_cvt_pk_bf16_f32 v208, v192, v193
    v_cvt_pk_bf16_f32 v212, v200, v201
    v_cvt_pk_bf16_f32 v209, v194, v195
    v_cvt_pk_bf16_f32 v213, v202, v203
    v_cvt_pk_bf16_f32 v210, v196, v197
    v_cvt_pk_bf16_f32 v214, v204, v205
    v_cvt_pk_bf16_f32 v211, v198, v199
    v_cvt_pk_bf16_f32 v215, v206, v207
    s_nop 0
    v_mfma_f32_16x16x32_bf16 v[176:179], v[208:211], v[64:67], 0
    v_mfma_f32_16x16x32_bf16 v[184:187], v[208:211], v[72:75], 0
    v_mfma_f32_16x16x32_bf16 v[180:183], v[208:211], v[68:71], 0
    v_mfma_f32_16x16x32_bf16 v[188:191], v[208:211], v[76:79], 0
    v_mfma_f32_16x16x32_bf16 v[176:179], v[212:215], v[80:83], v[176:179]
    v_mfma_f32_16x16x32_bf16 v[184:187], v[212:215], v[64:67], v[184:187]
    v_mfma_f32_16x16x32_bf16 v[180:183], v[212:215], v[84:87], v[180:183]
    v_mfma_f32_16x16x32_bf16 v[188:191], v[212:215], v[68:71], v[188:191]
    ds_read_b128 v[136:139], v13
    ds_read_b128 v[140:143], v13 offset:1024
    s_add_u32 m0, s80, 6144
    s_add_u32 s72, s81, 6144
    buffer_load_dwordx4 v4, s[20:23], s72 offen offset:0 sc1 lds
    buffer_load_dwordx4 v4, s[20:23], s72 offen offset:1024 sc1 lds
    v_pk_mul_f32 v[192:193], v[176:177], v[36:37]
    v_pk_mul_f32 v[200:201], v[184:185], v[36:37]
    v_pk_fma_f32 v[192:193], v[184:185], v[44:45], v[192:193] neg_lo:[1,0,0] neg_hi:[1,0,0]
    v_pk_fma_f32 v[200:201], v[176:177], v[44:45], v[200:201]
    v_pk_mul_f32 v[194:195], v[178:179], v[38:39]
    v_pk_mul_f32 v[202:203], v[186:187], v[38:39]
    v_pk_fma_f32 v[194:195], v[186:187], v[46:47], v[194:195] neg_lo:[1,0,0] neg_hi:[1,0,0]
    v_pk_fma_f32 v[202:203], v[178:179], v[46:47], v[202:203]
    v_pk_mul_f32 v[196:197], v[180:181], v[40:41]
    v_pk_mul_f32 v[204:205], v[188:189], v[40:41]
    v_pk_fma_f32 v[196:197], v[188:189], v[48:49], v[196:197] neg_lo:[1,0,0] neg_hi:[1,0,0]
    v_pk_fma_f32 v[204:205], v[180:181], v[48:49], v[204:205]
    v_pk_mul_f32 v[198:199], v[182:183], v[42:43]
    v_pk_mul_f32 v[206:207], v[190:191], v[42:43]
    v_pk_fma_f32 v[198:199], v[190:191], v[50:51], v[198:199] neg_lo:[1,0,0] neg_hi:[1,0,0]
    v_pk_fma_f32 v[206:207], v[182:183], v[50:51], v[206:207]
    v_cvt_pk_bf16_f32 v208, v192, v193
    v_cvt_pk_bf16_f32 v212, v200, v201
    v_cvt_pk_bf16_f32 v209, v194, v195
    v_cvt_pk_bf16_f32 v213, v202, v203
    v_cvt_pk_bf16_f32 v210, v196, v197
    v_cvt_pk_bf16_f32 v214, v204, v205
    v_cvt_pk_bf16_f32 v211, v198, v199
    v_cvt_pk_bf16_f32 v215, v206, v207
    ds_write_b64 v8, v[208:209] offset:16384
    ds_write_b64 v8, v[212:213] offset:18432
    ds_write_b64 v8, v[210:211] offset:16448
    ds_write_b64 v8, v[214:215] offset:18496
    s_add_u32 m0, s80, 8192
    s_add_u32 s72, s81, 8192
    buffer_load_dwordx4 v4, s[20:23], s72 offen offset:0 sc1 lds
    buffer_load_dwordx4 v4, s[20:23], s72 offen offset:1024 sc1 lds
    s_cmp_eq_u32 s69, 0
    s_cbranch_scc1 Lk_68
    s_cmp_eq_u32 s58, 0
    s_cselect_b32 s89, 16, 6
    s_cselect_b32 s72, 0, 65536
    s_add_u32 s72, s72, 262144
    s_add_u32 s72, s72, s33
    s_lshl_b32 s73, s68, 9
    s_add_u32 s72, s72, s73
    v_lshlrev_b32 v5, 7, v1
    v_mov_b32 v19, 0
    s_mov_b64 exec, 15
    buffer_atomic_add v19, v5, s[20:23], s72 offen sc0 sc1
    s_mov_b64 exec, -1
Lk_68:
    s_waitcnt lgkmcnt(0)
    s_barrier
    ds_read_b128 v[216:219], v9 offset:0
    ds_read_b128 v[224:227], v9 offset:4096
    ds_read_b128 v[220:223], v10 offset:0
    ds_read_b128 v[228:231], v10 offset:4096
    s_lshl_b32 s72, s4, 5
    s_and_b32 s72, s72, 0x780
    s_add_u32 s72, s72, s66
    s_add_u32 s72, s72, 32768
    s_cmp_lg_u32 s3, 0
    s_cbranch_scc1 Lsg_69
    v_lshlrev_b32 v5, 11, v1
    v_mov_b32 v6, 1
    s_bfm_b64 exec, 16, 0
    buffer_atomic_add v6, v5, s[20:23], s72 offen sc1
    s_mov_b64 exec, -1
Lsg_69:
    v_lshlrev_b32 v144, 16, v136
    v_and_b32 v145, 0xffff0000, v136
    v_lshlrev_b32 v146, 16, v137
    v_and_b32 v147, 0xffff0000, v137
    v_lshlrev_b32 v148, 16, v138
    v_and_b32 v149, 0xffff0000, v138
    v_lshlrev_b32 v150, 16, v139
    v_and_b32 v151, 0xffff0000, v139
    v_lshlrev_b32 v152, 16, v140
    v_and_b32 v153, 0xffff0000, v140
    v_lshlrev_b32 v154, 16, v141
    v_and_b32 v155, 0xffff0000, v141
    v_lshlrev_b32 v156, 16, v142
    v_and_b32 v157, 0xffff0000, v142
    v_lshlrev_b32 v158, 16, v143
    v_and_b32 v159, 0xffff0000, v143
    v_mov_b32 v6, s87
    s_waitcnt lgkmcnt(2)
    v_mfma_f32_16x16x32_bf16 v[176:179], v[64:67], v[216:219], 0
    v_mfma_f32_16x16x32_bf16 v[184:187], v[96:99], v[224:227], 0
    v_mfma_f32_16x16x32_bf16 v[180:183], v[68:71], v[216:219], 0
    v_mfma_f32_16x16x32_bf16 v[188:191], v[100:103], v[224:227], 0
    s_waitcnt lgkmcnt(0)
    v_mfma_f32_16x16x32_bf16 v[176:179], v[88:91], v[220:223], v[176:179]
    v_mfma_f32_16x16x32_bf16 v[184:187], v[104:107], v[228:231], v[184:187]
    v_mfma_f32_16x16x32_bf16 v[180:183], v[92:95], v[220:223], v[180:183]
    v_mfma_f32_16x16x32_bf16 v[188:191], v[108:111], v[228:231], v[188:191]
    s_nop 5
    v_pk_add_f32 v[192:193], v[176:177], v[184:185]
    v_pk_fma_f32 v[192:193], v[192:193], v[6:7], v[144:145] op_sel_hi:[1,0,1]
    v_pk_add_f32 v[194:195], v[178:179], v[186:187]
    v_pk_fma_f32 v[194:195], v[194:195], v[6:7], v[146:147] op_sel_hi:[1,0,1]
    v_pk_add_f32 v[196:197], v[180:181], v[188:189]
    v_pk_fma_f32 v[196:197], v[196:197], v[6:7], v[148:149] op_sel_hi:[1,0,1]
    v_pk_add_f32 v[198:199], v[182:183], v[190:191]
    v_pk_fma_f32 v[198:199], v[198:199], v[6:7], v[150:151] op_sel_hi:[1,0,1]
    v_cvt_pk_bf16_f32 v208, v192, v193
    v_cvt_pk_bf16_f32 v209, v194, v195
    v_cvt_pk_bf16_f32 v210, v196, v197
    v_cvt_pk_bf16_f32 v211, v198, v199
    v_min_u32 v208, -2, v208
    v_min_u32 v209, -2, v209
    v_min_u32 v210, -2, v210
    v_min_u32 v211, -2, v211
    buffer_store_dwordx4 v[208:211], v11, s[20:23], s82 offen sc1
    v_pk_add_f32 v[200:201], v[176:177], v[184:185] neg_lo:[0,1] neg_hi:[0,1]
    v_pk_fma_f32 v[200:201], v[200:201], v[6:7], v[152:153] op_sel_hi:[1,0,1]
    v_pk_add_f32 v[202:203], v[178:179], v[186:187] neg_lo:[0,1] neg_hi:[0,1]
    v_pk_fma_f32 v[202:203], v[202:203], v[6:7], v[154:155] op_sel_hi:[1,0,1]
    v_pk_add_f32 v[204:205], v[180:181], v[188:189] neg_lo:[0,1] neg_hi:[0,1]
    v_pk_fma_f32 v[204:205], v[204:205], v[6:7], v[156:157] op_sel_hi:[1,0,1]
    v_pk_add_f32 v[206:207], v[182:183], v[190:191] neg_lo:[0,1] neg_hi:[0,1]
    v_pk_fma_f32 v[206:207], v[206:207], v[6:7], v[158:159] op_sel_hi:[1,0,1]
    v_cvt_pk_bf16_f32 v212, v200, v201
    v_cvt_pk_bf16_f32 v213, v202, v203
    v_cvt_pk_bf16_f32 v214, v204, v205
    v_cvt_pk_bf16_f32 v215, v206, v207
    v_min_u32 v212, -2, v212
    v_min_u32 v213, -2, v213
    v_min_u32 v214, -2, v214
    v_min_u32 v215, -2, v215
    buffer_store_dwordx4 v[212:215], v11, s[20:23], s83 offen sc1
    s_branch Lm_43
Lm_42:
    s_cmp_lg_u32 s58, 0
    s_cbranch_scc1 Lm_44
    s_add_u32 s72, s32, 262144
    s_waitcnt vmcnt(0)
    v_mov_b32 v5, 161820
    v_mov_b32 v6, 1
    s_mov_b64 exec, 1
    ds_add_rtn_u32 v7, v5, v6
    s_waitcnt lgkmcnt(0)
    v_cmp_eq_u32 vcc, 7, v7
    s_mov_b64 exec, -1
    s_nop 3
    s_cbranch_vccz Lar_75
    v_lshlrev_b32 v5, 11, v1
    v_mov_b32 v6, 1
    s_bfm_b64 exec, 16, 0
    buffer_atomic_add v6, v5, s[20:23], s72 offen sc1
    s_mov_b64 exec, -1
Lsg_76:
Lar_75:
    s_cmp_lg_u32 s69, 0
    s_cbranch_scc1 Lc_70
    s_sub_u32 s80, s53, 12
    s_cmp_ge_u32 s53, 24
    s_cselect_b32 s80, s52, s80
    s_cmp_ge_u32 s80, 10
    s_cbranch_scc1 Lc_70
    v_mov_b32 v5, 161808
    v_mov_b32 v6, 1
    s_mov_b64 exec, 1
Lhs_77:
    ds_read_b32 v6, v5
    s_waitcnt lgkmcnt(0)
    v_cmp_gt_u32 vcc, 4, v6
    s_nop 4
    s_cbranch_vccnz Lhs_77
    s_mov_b64 exec, -1
    s_mov_b32 s14, s3
Lc_73:
    s_lshl_b32 s81, s80, 1
    s_lshr_b32 s82, s14, 2
    s_add_u32 s81, s81, s82
    s_and_b32 s82, s14, 3
    s_lshl_b32 s83, s81, 1
    s_lshr_b32 s84, s82, 1
    s_add_u32 s83, s83, s84
    s_mul_i32 s83, s83, 20
    s_and_b32 s84, s82, 1
    s_lshl_b32 s84, s84, 2
    s_add_u32 s83, s83, s84
    s_sub_u32 s84, s81, 16
    s_lshl_b32 s84, s84, 3
    s_lshl_b32 s85, s82, 1
    s_add_u32 s84, s84, s85
    s_mul_i32 s84, s84, 20
    s_add_u32 s84, s84, 16
    s_cmp_lt_u32 s80, 8
    s_cselect_b32 s82, s83, s84
    s_cselect_b32 s83, 8, 20
    s_mul_i32 s82, s82, 1280
    s_mul_i32 s83, s83, 1280
    s_and_b32 s72, s14, 1
    s_lshl_b32 s72, s72, 3
    v_add_u32 v5, s72, v3
    v_xor_b32 v5, v5, v2
    v_mul_u32_u24 v6, 1280, v3
    v_lshl_add_u32 v8, v5, 4, v6
    v_xor_b32 v5, 4, v5
    v_lshl_add_u32 v9, v5, 4, v6
    v_add_u32 v9, s83, v9
    s_lshl_b32 s72, s14, 11
    s_add_u32 m0, s72, 0
    s_nop 0
    buffer_load_dwordx4 v8, s[40:43], s82 offen offset:0 lds
    s_add_u32 m0, s72, 1024
    s_nop 0
    buffer_load_dwordx4 v9, s[40:43], s82 offen offset:0 lds
    s_add_u32 m0, s72, 16128
    s_nop 0
    buffer_load_dwordx4 v8, s[40:43], s82 offen offset:256 lds
    s_add_u32 m0, s72, 17152
    s_nop 0
    buffer_load_dwordx4 v9, s[40:43], s82 offen offset:256 lds
    s_add_u32 m0, s72, 32256
    s_nop 0
    buffer_load_dwordx4 v8, s[40:43], s82 offen offset:512 lds
    s_add_u32 m0, s72, 33280
    s_nop 0
    buffer_load_dwordx4 v9, s[40:43], s82 offen offset:512 lds
    s_add_u32 m0, s72, 48384
    s_nop 0
    buffer_load_dwordx4 v8, s[40:43], s82 offen offset:768 lds
    s_add_u32 m0, s72, 49408
    s_nop 0
    buffer_load_dwordx4 v9, s[40:43], s82 offen offset:768 lds
    s_add_u32 m0, s72, 64512
    s_nop 0
    buffer_load_dwordx4 v8, s[40:43], s82 offen offset:1024 lds
    s_add_u32 m0, s72, 65536
    s_nop 0
    buffer_load_dwordx4 v9, s[40:43], s82 offen offset:1024 lds
    s_add_u32 s14, s14, 4
    s_cmp_lt_u32 s14, 8
    s_cbranch_scc1 Lc_73
    s_waitcnt vmcnt(0)
    v_mov_b32 v5, 161812
    v_mov_b32 v6, 1
    s_mov_b64 exec, 1
    ds_add_u32 v5, v6
Lhs_78:
    ds_read_b32 v6, v5
    s_waitcnt lgkmcnt(0)
    v_cmp_gt_u32 vcc, 4, v6
    s_nop 4
    s_cbranch_vccnz Lhs_78
    s_mov_b64 exec, -1
    s_lshl_b32 s72, s68, 12
    v_xor_b32 v5, v3, v2
    v_lshlrev_b32 v5, 4, v5
    v_lshl_add_u32 v5, v2, 8, v5
    v_add_u32 v60, s72, v5
    v_xor_b32 v61, 64, v60
    v_xor_b32 v62, 128, v60
    v_xor_b32 v63, 192, v60
    ds_read_b128 v[164:167], v60 offset:0
    ds_read_b128 v[168:171], v61 offset:0
    ds_read_b128 v[172:175], v62 offset:0
    ds_read_b128 v[176:179], v63 offset:0
    ds_read_b128 v[180:183], v60 offset:16384
    ds_read_b128 v[184:187], v61 offset:16384
    ds_read_b128 v[188:191], v62 offset:16384
    ds_read_b128 v[192:195], v63 offset:16384
    ds_read_b128 v[196:199], v60 offset:32768
    ds_read_b128 v[200:203], v61 offset:32768
    ds_read_b128 v[204:207], v62 offset:32768
    ds_read_b128 v[208:211], v63 offset:32768
    ds_read_b128 v[212:215], v60 offset:49152
    ds_read_b128 v[216:219], v61 offset:49152
    ds_read_b128 v[220:223], v62 offset:49152
    ds_read_b128 v[224:227], v63 offset:49152
    v_add_u32 v64, 0x10000, v60
    v_add_u32 v65, 0x10000, v61
    v_add_u32 v66, 0x10000, v62
    v_add_u32 v67, 0x10000, v63
    ds_read_b128 v[228:231], v64 offset:0
    ds_read_b128 v[232:235], v65 offset:0
    ds_read_b128 v[236:239], v66 offset:0
    ds_read_b128 v[240:243], v67 offset:0
    v_add_u32 v6, 81920, v4
    ds_read_b128 v[60:63], v6 offset:0
    ds_read_b128 v[64:67], v6 offset:1024
    ds_read_b128 v[68:71], v6 offset:2048
    ds_read_b128 v[72:75], v6 offset:3072
    ds_read_b128 v[76:79], v6 offset:4096
    ds_read_b128 v[80:83], v6 offset:5120
    ds_read_b128 v[84:87], v6 offset:6144
    ds_read_b128 v[88:91], v6 offset:7168
    ds_read_b128 v[92:95], v6 offset:8192
    ds_read_b128 v[96:99], v6 offset:9216
    s_waitcnt lgkmcnt(5)
    v_mfma_f32_16x16x32_bf16 v[144:147], v[164:167], v[60:63], 0
    ds_read_b128 v[100:103], v6 offset:10240
    v_mfma_f32_16x16x32_bf16 v[120:123], v[204:207], v[60:63], 0
    v_mfma_f32_16x16x32_bf16 v[148:151], v[164:167], v[64:67], 0
    ds_read_b128 v[104:107], v6 offset:11264
    v_mfma_f32_16x16x32_bf16 v[124:127], v[204:207], v[64:67], 0
    v_mfma_f32_16x16x32_bf16 v[152:155], v[164:167], v[68:71], 0
    ds_read_b128 v[108:111], v6 offset:12288
    v_mfma_f32_16x16x32_bf16 v[128:131], v[204:207], v[68:71], 0
    v_mfma_f32_16x16x32_bf16 v[156:159], v[164:167], v[72:75], 0
    ds_read_b128 v[112:115], v6 offset:13312
    v_mfma_f32_16x16x32_bf16 v[132:135], v[204:207], v[72:75], 0
    v_mfma_f32_16x16x32_bf16 v[160:163], v[164:167], v[76:79], 0
    ds_read_b128 v[116:119], v6 offset:14336
    v_mfma_f32_16x16x32_bf16 v[136:139], v[204:207], v[76:79], 0
    s_waitcnt lgkmcnt(5)
    v_mfma_f32_16x16x32_bf16 v[144:147], v[168:171], v[80:83], v[144:147]
    ds_read_b128 v[60:63], v6 offset:15360
    v_mfma_f32_16x16x32_bf16 v[120:123], v[208:211], v[80:83], v[120:123]
    v_mfma_f32_16x16x32_bf16 v[148:151], v[168:171], v[84:87], v[148:151]
    ds_read_b128 v[64:67], v6 offset:16384
    v_mfma_f32_16x16x32_bf16 v[124:127], v[208:211], v[84:87], v[124:127]
    v_mfma_f32_16x16x32_bf16 v[152:155], v[168:171], v[88:91], v[152:155]
    ds_read_b128 v[68:71], v6 offset:17408
    v_mfma_f32_16x16x32_bf16 v[128:131], v[208:211], v[88:91], v[128:131]
    v_mfma_f32_16x16x32_bf16 v[156:159], v[168:171], v[92:95], v[156:159]
    ds_read_b128 v[72:75], v6 offset:18432
    v_mfma_f32_16x16x32_bf16 v[132:135], v[208:211], v[92:95], v[132:135]
    v_mfma_f32_16x16x32_bf16 v[160:163], v[168:171], v[96:99], v[160:163]
    ds_read_b128 v[76:79], v6 offset:19456
    v_mfma_f32_16x16x32_bf16 v[136:139], v[208:211], v[96:99], v[136:139]
    s_waitcnt lgkmcnt(5)
    v_mfma_f32_16x16x32_bf16 v[144:147], v[172:175], v[100:103], v[144:147]
    ds_read_b128 v[80:83], v6 offset:20480
    v_mfma_f32_16x16x32_bf16 v[120:123], v[212:215], v[100:103], v[120:123]
    v_mfma_f32_16x16x32_bf16 v[148:151], v[172:175], v[104:107], v[148:151]
    ds_read_b128 v[84:87], v6 offset:21504
    v_mfma_f32_16x16x32_bf16 v[124:127], v[212:215], v[104:107], v[124:127]
    v_mfma_f32_16x16x32_bf16 v[152:155], v[172:175], v[108:111], v[152:155]
    ds_read_b128 v[88:91], v6 offset:22528
    v_mfma_f32_16x16x32_bf16 v[128:131], v[212:215], v[108:111], v[128:131]
    v_mfma_f32_16x16x32_bf16 v[156:159], v[172:175], v[112:115], v[156:159]
    ds_read_b128 v[92:95], v6 offset:23552
    v_mfma_f32_16x16x32_bf16 v[132:135], v[212:215], v[112:115], v[132:135]
    v_mfma_f32_16x16x32_bf16 v[160:163], v[172:175], v[116:119], v[160:163]
    ds_read_b128 v[96:99], v6 offset:24576
    v_mfma_f32_16x16x32_bf16 v[136:139], v[212:215], v[116:119], v[136:139]
    s_waitcnt lgkmcnt(5)
    v_mfma_f32_16x16x32_bf16 v[144:147], v[176:179], v[60:63], v[144:147]
    ds_read_b128 v[100:103], v6 offset:25600
    v_mfma_f32_16x16x32_bf16 v[120:123], v[216:219], v[60:63], v[120:123]
    v_mfma_f32_16x16x32_bf16 v[148:151], v[176:179], v[64:67], v[148:151]
    ds_read_b128 v[104:107], v6 offset:26624
    v_mfma_f32_16x16x32_bf16 v[124:127], v[216:219], v[64:67], v[124:127]
    v_mfma_f32_16x16x32_bf16 v[152:155], v[176:179], v[68:71], v[152:155]
    ds_read_b128 v[108:111], v6 offset:27648
    v_mfma_f32_16x16x32_bf16 v[128:131], v[216:219], v[68:71], v[128:131]
    v_mfma_f32_16x16x32_bf16 v[156:159], v[176:179], v[72:75], v[156:159]
    ds_read_b128 v[112:115], v6 offset:28672
    v_mfma_f32_16x16x32_bf16 v[132:135], v[216:219], v[72:75], v[132:135]
    v_mfma_f32_16x16x32_bf16 v[160:163], v[176:179], v[76:79], v[160:163]
    ds_read_b128 v[116:119], v6 offset:29696
    v_mfma_f32_16x16x32_bf16 v[136:139], v[216:219], v[76:79], v[136:139]
    s_waitcnt lgkmcnt(5)
    v_mfma_f32_16x16x32_bf16 v[144:147], v[180:183], v[80:83], v[144:147]
    ds_read_b128 v[60:63], v6 offset:30720
    v_mfma_f32_16x16x32_bf16 v[120:123], v[220:223], v[80:83], v[120:123]
    v_mfma_f32_16x16x32_bf16 v[148:151], v[180:183], v[84:87], v[148:151]
    ds_read_b128 v[64:67], v6 offset:31744
    v_mfma_f32_16x16x32_bf16 v[124:127], v[220:223], v[84:87], v[124:127]
    v_mfma_f32_16x16x32_bf16 v[152:155], v[180:183], v[88:91], v[152:155]
    ds_read_b128 v[68:71], v6 offset:32768
    v_mfma_f32_16x16x32_bf16 v[128:131], v[220:223], v[88:91], v[128:131]
    v_mfma_f32_16x16x32_bf16 v[156:159], v[180:183], v[92:95], v[156:159]
    ds_read_b128 v[72:75], v6 offset:33792
    v_mfma_f32_16x16x32_bf16 v[132:135], v[220:223], v[92:95], v[132:135]
    v_mfma_f32_16x16x32_bf16 v[160:163], v[180:183], v[96:99], v[160:163]
    ds_read_b128 v[76:79], v6 offset:34816
    v_mfma_f32_16x16x32_bf16 v[136:139], v[220:223], v[96:99], v[136:139]
    s_waitcnt lgkmcnt(5)
    v_mfma_f32_16x16x32_bf16 v[144:147], v[184:187], v[100:103], v[144:147]
    ds_read_b128 v[80:83], v6 offset:35840
    v_mfma_f32_16x16x32_bf16 v[120:123], v[224:227], v[100:103], v[120:123]
    v_mfma_f32_16x16x32_bf16 v[148:151], v[184:187], v[104:107], v[148:151]
    ds_read_b128 v[84:87], v6 offset:36864
    v_mfma_f32_16x16x32_bf16 v[124:127], v[224:227], v[104:107], v[124:127]
    v_mfma_f32_16x16x32_bf16 v[152:155], v[184:187], v[108:111], v[152:155]
    ds_read_b128 v[88:91], v6 offset:37888
    v_mfma_f32_16x16x32_bf16 v[128:131], v[224:227], v[108:111], v[128:131]
    v_mfma_f32_16x16x32_bf16 v[156:159], v[184:187], v[112:115], v[156:159]
    ds_read_b128 v[92:95], v6 offset:38912
    v_mfma_f32_16x16x32_bf16 v[132:135], v[224:227], v[112:115], v[132:135]
    v_mfma_f32_16x16x32_bf16 v[160:163], v[184:187], v[116:119], v[160:163]
    ds_read_b128 v[96:99], v6 offset:39936
    v_mfma_f32_16x16x32_bf16 v[136:139], v[224:227], v[116:119], v[136:139]
    s_waitcnt lgkmcnt(5)
    v_mfma_f32_16x16x32_bf16 v[144:147], v[188:191], v[60:63], v[144:147]
    ds_read_b128 v[100:103], v6 offset:40960
    v_mfma_f32_16x16x32_bf16 v[120:123], v[228:231], v[60:63], v[120:123]
    v_mfma_f32_16x16x32_bf16 v[148:151], v[188:191], v[64:67], v[148:151]
    ds_read_b128 v[104:107], v6 offset:41984
    v_mfma_f32_16x16x32_bf16 v[124:127], v[228:231], v[64:67], v[124:127]
    v_mfma_f32_16x16x32_bf16 v[152:155], v[188:191], v[68:71], v[152:155]
    ds_read_b128 v[108:111], v6 offset:43008
    v_mfma_f32_16x16x32_bf16 v[128:131], v[228:231], v[68:71], v[128:131]
    v_mfma_f32_16x16x32_bf16 v[156:159], v[188:191], v[72:75], v[156:159]
    ds_read_b128 v[112:115], v6 offset:44032
    v_mfma_f32_16x16x32_bf16 v[132:135], v[228:231], v[72:75], v[132:135]
    v_mfma_f32_16x16x32_bf16 v[160:163], v[188:191], v[76:79], v[160:163]
    ds_read_b128 v[116:119], v6 offset:45056
    v_mfma_f32_16x16x32_bf16 v[136:139], v[228:231], v[76:79], v[136:139]
    s_waitcnt lgkmcnt(5)
    v_mfma_f32_16x16x32_bf16 v[144:147], v[192:195], v[80:83], v[144:147]
    ds_read_b128 v[60:63], v6 offset:46080
    v_mfma_f32_16x16x32_bf16 v[120:123], v[232:235], v[80:83], v[120:123]
    v_mfma_f32_16x16x32_bf16 v[148:151], v[192:195], v[84:87], v[148:151]
    ds_read_b128 v[64:67], v6 offset:47104
    v_mfma_f32_16x16x32_bf16 v[124:127], v[232:235], v[84:87], v[124:127]
    v_mfma_f32_16x16x32_bf16 v[152:155], v[192:195], v[88:91], v[152:155]
    ds_read_b128 v[68:71], v6 offset:48128
    v_mfma_f32_16x16x32_bf16 v[128:131], v[232:235], v[88:91], v[128:131]
    v_mfma_f32_16x16x32_bf16 v[156:159], v[192:195], v[92:95], v[156:159]
    ds_read_b128 v[72:75], v6 offset:49152
    v_mfma_f32_16x16x32_bf16 v[132:135], v[232:235], v[92:95], v[132:135]
    v_mfma_f32_16x16x32_bf16 v[160:163], v[192:195], v[96:99], v[160:163]
    ds_read_b128 v[76:79], v6 offset:50176
    v_mfma_f32_16x16x32_bf16 v[136:139], v[232:235], v[96:99], v[136:139]
    s_waitcnt lgkmcnt(5)
    v_mfma_f32_16x16x32_bf16 v[144:147], v[196:199], v[100:103], v[144:147]
    v_mfma_f32_16x16x32_bf16 v[120:123], v[236:239], v[100:103], v[120:123]
    v_mfma_f32_16x16x32_bf16 v[148:151], v[196:199], v[104:107], v[148:151]
    v_mfma_f32_16x16x32_bf16 v[124:127], v[236:239], v[104:107], v[124:127]
    v_mfma_f32_16x16x32_bf16 v[152:155], v[196:199], v[108:111], v[152:155]
    v_mfma_f32_16x16x32_bf16 v[128:131], v[236:239], v[108:111], v[128:131]
    v_mfma_f32_16x16x32_bf16 v[156:159], v[196:199], v[112:115], v[156:159]
    v_mfma_f32_16x16x32_bf16 v[132:135], v[236:239], v[112:115], v[132:135]
    v_mfma_f32_16x16x32_bf16 v[160:163], v[196:199], v[116:119], v[160:163]
    v_mfma_f32_16x16x32_bf16 v[136:139], v[236:239], v[116:119], v[136:139]
    s_waitcnt lgkmcnt(0)
    v_mfma_f32_16x16x32_bf16 v[144:147], v[200:203], v[60:63], v[144:147]
    v_mfma_f32_16x16x32_bf16 v[120:123], v[240:243], v[60:63], v[120:123]
    v_mfma_f32_16x16x32_bf16 v[148:151], v[200:203], v[64:67], v[148:151]
    v_mfma_f32_16x16x32_bf16 v[124:127], v[240:243], v[64:67], v[124:127]
    v_mfma_f32_16x16x32_bf16 v[152:155], v[200:203], v[68:71], v[152:155]
    v_mfma_f32_16x16x32_bf16 v[128:131], v[240:243], v[68:71], v[128:131]
    v_mfma_f32_16x16x32_bf16 v[156:159], v[200:203], v[72:75], v[156:159]
    v_mfma_f32_16x16x32_bf16 v[132:135], v[240:243], v[72:75], v[132:135]
    v_mfma_f32_16x16x32_bf16 v[160:163], v[200:203], v[76:79], v[160:163]
    v_mfma_f32_16x16x32_bf16 v[136:139], v[240:243], v[76:79], v[136:139]
    v_pk_mul_f32 v[144:145], v[144:145], v[56:57] op_sel_hi:[1,0]
    v_pk_fma_f32 v[144:145], v[120:121], v[58:59], v[144:145] op_sel_hi:[1,0,1]
    v_pk_mul_f32 v[146:147], v[146:147], v[56:57] op_sel_hi:[1,0]
    v_pk_fma_f32 v[146:147], v[122:123], v[58:59], v[146:147] op_sel_hi:[1,0,1]
    v_cvt_pk_bf16_f32 v60, v144, v145
    v_cvt_pk_bf16_f32 v61, v146, v147
    v_min_u32 v60, -2, v60
    v_min_u32 v61, -2, v61
    ds_write_b64 v140, v[60:61] offset:0
    v_pk_mul_f32 v[148:149], v[148:149], v[52:53] op_sel_hi:[1,0]
    v_pk_fma_f32 v[148:149], v[124:125], v[54:55], v[148:149] op_sel_hi:[1,0,1]
    v_pk_mul_f32 v[150:151], v[150:151], v[52:53] op_sel_hi:[1,0]
    v_pk_fma_f32 v[150:151], v[126:127], v[54:55], v[150:151] op_sel_hi:[1,0,1]
    v_cvt_pk_bf16_f32 v62, v148, v149
    v_cvt_pk_bf16_f32 v63, v150, v151
    v_min_u32 v62, -2, v62
    v_min_u32 v63, -2, v63
    ds_write_b64 v140, v[62:63] offset:2304
    v_pk_mul_f32 v[152:153], v[152:153], v[52:53] op_sel_hi:[1,0]
    v_pk_fma_f32 v[152:153], v[128:129], v[54:55], v[152:153] op_sel_hi:[1,0,1]
    v_pk_mul_f32 v[154:155], v[154:155], v[52:53] op_sel_hi:[1,0]
    v_pk_fma_f32 v[154:155], v[130:131], v[54:55], v[154:155] op_sel_hi:[1,0,1]
    v_cvt_pk_bf16_f32 v64, v152, v153
    v_cvt_pk_bf16_f32 v65, v154, v155
    v_min_u32 v64, -2, v64
    v_min_u32 v65, -2, v65
    ds_write_b64 v140, v[64:65] offset:4608
    v_pk_mul_f32 v[156:157], v[156:157], v[52:53] op_sel_hi:[1,0]
    v_pk_fma_f32 v[156:157], v[132:133], v[54:55], v[156:157] op_sel_hi:[1,0,1]
    v_pk_mul_f32 v[158:159], v[158:159], v[52:53] op_sel_hi:[1,0]
    v_pk_fma_f32 v[158:159], v[134:135], v[54:55], v[158:159] op_sel_hi:[1,0,1]
    v_cvt_pk_bf16_f32 v66, v156, v157
    v_cvt_pk_bf16_f32 v67, v158, v159
    v_min_u32 v66, -2, v66
    v_min_u32 v67, -2, v67
    ds_write_b64 v140, v[66:67] offset:6912
    v_pk_mul_f32 v[160:161], v[160:161], v[52:53] op_sel_hi:[1,0]
    v_pk_fma_f32 v[160:161], v[136:137], v[54:55], v[160:161] op_sel_hi:[1,0,1]
    v_pk_mul_f32 v[162:163], v[162:163], v[52:53] op_sel_hi:[1,0]
    v_pk_fma_f32 v[162:163], v[138:139], v[54:55], v[162:163] op_sel_hi:[1,0,1]
    v_cvt_pk_bf16_f32 v68, v160, v161
    v_cvt_pk_bf16_f32 v69, v162, v163
    v_min_u32 v68, -2, v68
    v_min_u32 v69, -2, v69
    ds_write_b64 v140, v[68:69] offset:9216
    v_mov_b32 v5, 161816
    v_mov_b32 v6, 1
    s_mov_b64 exec, 1
    ds_add_u32 v5, v6
Lhs_79:
    ds_read_b32 v6, v5
    s_waitcnt lgkmcnt(0)
    v_cmp_gt_u32 vcc, 4, v6
    s_nop 4
    s_cbranch_vccnz Lhs_79
    s_mov_b64 exec, -1
    s_mul_i32 s81, s59, 102400
    s_mul_i32 s82, s80, 10240
    s_add_u32 s81, s81, s82
    s_add_u32 s81, s81, 16908288
    v_mul_u32_u24 v5, 144, v2
    v_lshl_add_u32 v5, v3, 4, v5
    s_mov_b32 s82, s3
Lc_72:
    s_cmp_ge_u32 s82, 5
    s_cselect_b32 s83, -11456, 0
    s_mul_i32 s84, s82, 2304
    s_add_u32 s83, s83, s84
    s_add_u32 s83, s83, 133120
    v_add_u32 v6, s83, v5
    ds_read_b128 v[8:11], v6
    s_lshl_b32 s84, s82, 10
    s_add_u32 s84, s84, s81
    s_add_u32 s82, s82, 4
    s_cmp_lt_u32 s82, 10
    s_waitcnt lgkmcnt(0)
    buffer_store_dwordx4 v[8:11], v4, s[20:23], s84 offen sc1
    s_cbranch_scc1 Lc_72
Lc_70:
    s_branch Lm_45
Lm_44:
    s_sub_u32 s80, s53, 20
    s_lshl_b32 s80, s80, 3
    s_add_u32 s80, s80, s52
    s_lshl_b32 s80, s80, 3
    s_add_u32 s80, s80, s3
    s_mov_b32 s77, 0x3acccccd
Lc_80:
    s_mul_i32 s81, s80, 656
    s_lshr_b32 s81, s81, 16
    s_mul_i32 s82, s81, 100
    s_sub_u32 s82, s80, s82
    s_mul_i32 s83, s82, 205
    s_lshr_b32 s83, s83, 10
    s_mul_i32 s84, s83, 5
    s_sub_u32 s84, s82, s84
    s_mul_i32 s81, s81, 80
    s_lshl_b32 s84, s84, 4
    s_add_u32 s81, s81, s84
    v_add_u32 v8, s81, v2
    s_mul_i32 s84, s83, 40
    s_sub_u32 s85, s83, 16
    s_mul_i32 s85, s85, 160
    s_add_u32 s85, s85, 16
    s_cmp_lt_u32 s83, 16
    s_cselect_b32 s84, s84, s85
    s_cselect_b32 s85, 8, 20
    s_cselect_b64 vcc, -1, 0
    v_lshrrev_b32 v5, 1, v3
    v_mul_u32_u24 v5, 20, v5
    v_and_b32 v6, 1, v3
    v_lshl_add_u32 v5, v6, 2, v5
    v_mul_u32_u24 v6, 40, v3
    v_cndmask_b32 v5, v6, v5, vcc
    v_mul_u32_u24 v5, 1280, v5
    v_lshl_add_u32 v5, v8, 1, v5
    s_mul_i32 s84, s84, 1280
    s_mul_i32 s85, s85, 1280
    s_add_u32 s85, s85, s84
    buffer_load_ushort v32, v5, s[40:43], s84 offen offset:0
    buffer_load_ushort v33, v5, s[40:43], s84 offen offset:1280
    buffer_load_ushort v34, v5, s[40:43], s84 offen offset:2560
    buffer_load_ushort v35, v5, s[40:43], s84 offen offset:3840
    buffer_load_ushort v36, v5, s[40:43], s85 offen offset:0
    buffer_load_ushort v37, v5, s[40:43], s85 offen offset:1280
    buffer_load_ushort v38, v5, s[40:43], s85 offen offset:2560
    buffer_load_ushort v39, v5, s[40:43], s85 offen offset:3840
    v_and_b32 v5, 1, v3
    v_lshrrev_b32 v6, 1, v3
    v_lshlrev_b32 v5, 3, v5
    v_lshl_add_u32 v5, v6, 2, v5
    s_lshl_b32 s84, s83, 4
    v_add_u32 v5, s84, v5
    v_cmp_ne_u32 vcc, 0, v5
    v_mov_b32 v255, 0x140
    s_nop 0
    v_cndmask_b32 v12, v255, v5, vcc
    v_add_u32 v13, 1, v5
    v_add_u32 v14, 2, v5
    v_add_u32 v15, 3, v5
    v_mul_u32_u24 v12, v12, v8
    v_cvt_f32_u32 v12, v12
    v_mul_f32 v12, s77, v12
    v_fract_f32 v12, v12
    v_cos_f32 v16, v12
    v_sin_f32 v17, -v12
    v_mul_u32_u24 v13, v13, v8
    v_cvt_f32_u32 v13, v13
    v_mul_f32 v13, s77, v13
    v_fract_f32 v13, v13
    v_cos_f32 v18, v13
    v_sin_f32 v19, -v13
    v_mul_u32_u24 v14, v14, v8
    v_cvt_f32_u32 v14, v14
    v_mul_f32 v14, s77, v14
    v_fract_f32 v14, v14
    v_cos_f32 v20, v14
    v_sin_f32 v21, -v14
    v_mul_u32_u24 v15, v15, v8
    v_cvt_f32_u32 v15, v15
    v_mul_f32 v15, s77, v15
    v_fract_f32 v15, v15
    v_cos_f32 v22, v15
    v_sin_f32 v23, -v15
    v_mul_f32 v5, 0x3f3504f3, v16
    v_cndmask_b32 v16, v5, v16, vcc
    v_mov_b32 v255, 0x3f3504f3
    v_cndmask_b32 v17, v255, v17, vcc
    v_cvt_pk_bf16_f32 v24, v16, v17
    v_cvt_pk_bf16_f32 v25, v18, v19
    v_cvt_pk_bf16_f32 v26, v20, v21
    v_cvt_pk_bf16_f32 v27, v22, v23
    s_lshl_b32 s84, s80, 10
    s_add_u32 s85, s84, 17727488
    s_add_u32 s84, s84, 18546688
    buffer_store_dwordx4 v[24:27], v4, s[20:23], s85 offen sc1
    s_waitcnt vmcnt(1)
    v_lshl_or_b32 v28, v33, 16, v32
    v_lshl_or_b32 v29, v35, 16, v34
    v_lshl_or_b32 v30, v37, 16, v36
    v_lshl_or_b32 v31, v39, 16, v38
    buffer_store_dwordx4 v[28:31], v4, s[20:23], s84 offen sc1
    s_add_u32 s80, s80, 768
    s_cmp_lt_u32 s80, 800
    s_waitcnt vmcnt(0)
    s_cbranch_scc1 Lc_80
    s_add_u32 s72, s32, 327680
    s_barrier
    s_cmp_lg_u32 s3, 0
    s_cbranch_scc1 Lsg_81
    v_lshlrev_b32 v5, 11, v1
    v_mov_b32 v6, 1
    s_bfm_b64 exec, 16, 0
    buffer_atomic_add v6, v5, s[20:23], s72 offen sc1
    s_mov_b64 exec, -1
Lsg_81:
Lm_45:
    v_mov_b32 v19, 0
Lm_43:
    s_cmp_eq_u32 s69, 0
    s_cbranch_scc1 Lm_46
    s_cmp_eq_u32 s58, 0
    s_cselect_b32 s89, 16, 6
    s_cselect_b32 s72, 0, 65536
    s_add_u32 s72, s72, 262144
    s_add_u32 s72, s72, s33
    s_lshl_b32 s73, s68, 9
    s_add_u32 s72, s72, s73
    s_waitcnt vmcnt(2)
    s_mov_b64 exec, 15
    v_cmp_gt_u32 vcc, s89, v19
    s_mov_b64 exec, -1
    s_nop 3
    s_cbranch_vccz Lm_46
    v_lshlrev_b32 v5, 7, v1
    s_mov_b32 s88, 65536
    s_mov_b64 exec, 0xf
Lp_82:
    v_mov_b32 v6, 0
    buffer_atomic_add v6, v5, s[20:23], s72 offen sc0 sc1
    s_sub_u32 s88, s88, 1
    s_cbranch_scc1 Ld_83
    s_waitcnt vmcnt(0)
    v_cmpx_gt_u32 vcc, s89, v6
    s_nop 4
    s_cbranch_execnz Lp_82
Ld_83:
    s_waitcnt vmcnt(0)
    s_mov_b64 exec, -1
Lm_46:
    s_mov_b32 s14, 0
    s_cmp_lt_u32 s53, 20
    s_waitcnt lgkmcnt(0)
    s_cbranch_scc1 Lqkv
    s_barrier
Lqkv:
    s_cmp_lg_u32 s69, 0
    s_cbranch_scc1 Lm_47
    s_mul_i32 s72, s69, 10240
    s_add_u32 s72, s72, 102400
    v_add_u32 v25, s72, v4
    v_and_b32 v5, 31, v1
    v_lshrrev_b32 v6, 5, v1
    v_cmp_ne_u32 vcc, 20, v5
    v_mul_u32_u24 v6, 20, v6
    v_add_lshl_u32 v5, v5, v6, 4
    s_add_u32 s72, s72, 1024
    v_add_u32 v27, s72, v5
    v_mov_b32 v6, 0
    v_mov_b32 v255, 0x3f803f80
    v_cndmask_b32 v124, v255, v6, vcc
    v_mov_b32 v125, v124
    v_mov_b32 v126, v124
    v_mov_b32 v127, v124
    v_mov_b32 v128, v124
    v_mov_b32 v129, v124
    v_mov_b32 v130, v124
    v_mov_b32 v131, v124
    v_mov_b32 v132, v124
    v_mov_b32 v133, v124
    v_mov_b32 v134, v124
    v_mov_b32 v135, v124
    v_mov_b32 v136, v124
    v_mov_b32 v137, v124
    v_mov_b32 v138, v124
    v_mov_b32 v139, v124
    s_mov_b32 s4, 0xfffff
    s_mov_b32 s5, 0xfffff
    s_add_u32 s72, s72, 8192
    v_lshl_add_u32 v26, v1, 3, s72
    v_mov_b32 v24, 0xdddd
    s_mul_i32 s85, s3, 2560
    s_mul_i32 s86, s55, 163840
    s_add_u32 s86, s86, s63
    s_add_u32 s86, s86, s85
    s_add_u32 s85, s85, 102400
    v_mov_b32 v18, 0
    v_mov_b32 v19, 0
    v_mov_b32 v20, 0
    v_mov_b32 v21, 0
    v_mov_b32 v28, 0
    v_mov_b32 v29, 0
    v_mov_b32 v30, 0
    v_mov_b32 v31, 0
    v_mov_b32 v32, 0
    v_mov_b32 v33, 0
    v_mov_b32 v34, 0
    v_mov_b32 v35, 0
    v_mov_b32 v36, 0
    v_mov_b32 v37, 0
    v_mov_b32 v38, 0
    v_mov_b32 v39, 0
    v_mov_b32 v40, 0
    v_mov_b32 v41, 0
    v_mov_b32 v42, 0
    v_mov_b32 v43, 0
    v_mov_b32 v44, 0
    v_mov_b32 v45, 0
    v_mov_b32 v46, 0
    v_mov_b32 v47, 0
    v_mov_b32 v48, 0
    v_mov_b32 v49, 0
    v_mov_b32 v50, 0
    v_mov_b32 v51, 0
    v_mov_b32 v52, 0
    v_mov_b32 v53, 0
    v_mov_b32 v54, 0
    v_mov_b32 v55, 0
    v_mov_b32 v56, 0
    v_mov_b32 v57, 0
    v_mov_b32 v58, 0
    v_mov_b32 v59, 0
    s_mul_i32 s72, s68, 3072
    s_add_u32 s72, s72, 102400
    s_mul_i32 s73, s69, 20480
    s_add_u32 s74, s72, s73
    v_add_u32 v248, s74, v4
    s_sub_u32 s74, s72, s73
    s_add_u32 s74, s74, 20480
    v_add_u32 v249, s74, v4
    s_lshl_b32 s72, s94, 1
    s_lshr_b32 s73, s68, 1
    s_add_u32 s72, s72, s73
    s_lshl_b32 s72, s72, 5
    s_add_u32 s72, s72, s55
    s_and_b32 s73, s68, 1
    s_lshl_b32 s73, s73, 1
    s_add_u32 s73, s73, 1
    s_sub_u32 s73, s73, s69
    s_lshl_b32 s18, s72, 12
    s_lshl_b32 s74, s73, 9
    s_add_u32 s18, s18, s74
    s_add_u32 s18, s18, s64
    s_lshl_b32 s19, s72, 10
    s_lshl_b32 s74, s73, 8
    s_add_u32 s19, s19, s74
    s_add_u32 s19, s19, s64
    s_add_u32 s19, s19, 2097152
    v_lshrrev_b32 v5, 5, v1
    v_mul_u32_u24 v5, 1536, v5
    v_add_u32 v250, v5, v4
    v_lshlrev_b32 v251, 3, v1
    s_mul_i32 s0, s54, 163840
    s_mul_i32 s72, s57, 20480
    s_add_u32 s0, s0, s72
    s_lshl_b32 s72, s56, 7
    s_add_u32 s0, s0, s72
    s_add_u32 s0, s0, 6291456
    s_mul_i32 s1, s3, 327680
    s_mul_i32 s72, s52, 20
    s_add_u32 s72, s72, s53
    s_lshl_b32 s72, s72, 10
    s_add_u32 s1, s1, s72
    s_add_u32 s1, s1, 8912896
    s_cmp_ge_u32 s53, 20
    s_cselect_b32 s1, s22, s1
    s_lshr_b32 s72, s68, 1
    s_and_b32 s73, s68, 1
    v_mov_b32 v192, v4
    v_add_u32 v193, 0xa000, v4
    v_bfe_u32 v5, v1, 2, 2
    v_lshrrev_b32 v6, 5, v1
    v_lshl_add_u32 v6, v6, 3, v5
    v_mul_u32_u24 v207, 48, v6
    v_lshlrev_b32 v6, 8, v6
    v_and_b32 v7, 3, v1
    v_lshl_add_u32 v6, v7, 3, v6
    s_lshl_b32 s74, s73, 1
    v_xor_b32 v7, s74, v5
    v_lshl_add_u32 v6, v7, 6, v6
    v_and_b32 v7, 1, v3
    v_lshl_add_u32 v6, v7, 5, v6
    s_lshl_b32 s74, s72, 13
    v_add_u32 v194, s74, v6
    v_xor_b32 v195, 32, v194
    v_xor_b32 v196, 64, v194
    v_xor_b32 v197, 96, v194
    v_add_u32 v198, 81920, v194
    v_add_u32 v199, 81920, v195
    v_add_u32 v200, 81920, v196
    v_add_u32 v201, 81920, v197
    v_add_u32 v202, 131072, v194
    v_add_u32 v203, 131072, v195
    v_add_u32 v204, 131072, v196
    v_add_u32 v205, 131072, v197
    s_mul_i32 s75, s68, 3072
    s_add_u32 s75, s75, 143360
    v_and_b32 v5, 3, v1
    v_lshl_add_u32 v5, v7, 2, v5
    v_min_u32 v5, 4, v5
    v_and_b32 v6, 1, v5
    v_mul_u32_u24 v6, 24, v6
    v_lshrrev_b32 v5, 1, v5
    v_lshl_add_u32 v5, v5, 3, v6
    v_add3_u32 v207, v207, v5, s75
    v_and_b32 v5, 31, v1
    v_lshrrev_b32 v6, 5, v1
    v_lshl_add_u32 v7, v5, 1, v6
    v_mul_u32_u24 v7, 24, v7
    v_add_u32 v206, s75, v7
    v_mul_u32_u24 v6, 20, v6
    v_add_lshl_u32 v208, v6, v5, 4
    s_lshl_b32 s75, s73, 8
    s_lshl_b32 s76, s72, 10
    s_add_u32 s75, s75, s76
    s_add_u32 s75, s75, 32768
    v_lshl_add_u32 v209, v5, 2, s75
    s_mul_i32 s76, s72, 10240
    s_mul_i32 s77, s73, 4608
    s_add_u32 s77, s77, s76
    s_lshl_b32 s75, s73, 9
    s_add_u32 s76, s76, s75
    s_add_u32 s76, s76, 9216
    s_add_u32 s75, s77, 122880
    v_add_u32 v210, s75, v4
    v_add_u32 v211, s75, v208
    v_lshlrev_b32 v212, 3, v1
    s_add_u32 s75, s76, 122880
    v_add_u32 v213, s75, v212
    s_lshl_b32 s75, s55, 3
    s_add_u32 s75, s75, s94
    s_mul_i32 s75, s75, 20480
    s_add_u32 s75, s75, s63
    s_add_u32 s76, s76, s75
    s_add_u32 s77, s77, s75
    s_mul_i32 s75, s68, 2560
    s_add_u32 s75, s75, 102400
    v_add_u32 v214, s75, v4
    v_add_u32 v215, s75, v212
    s_mov_b32 s78, 0x3acccccd
    v_mov_b32 v216, 0x3727c5ac
    s_lshl_b32 s75, s68, 5
    s_add_u32 s75, s75, 112640
    v_lshl_add_u32 v217, v3, 3, s75
    v_lshlrev_b32 v5, 3, v2
    v_add_u32 v218, 112640, v5
    v_lshlrev_b32 v219, 2, v3
    s_lshl_b32 s79, s55, 3
    s_add_u32 s79, s79, s94
    s_lshl_b32 s79, s79, 7
    s_lshl_b32 s75, s68, 4
    s_add_u32 s79, s79, s75
    s_lshl_b32 s75, s58, 15
    s_add_u32 s79, s79, s75
    s_add_u32 s79, s79, 360448
    s_and_b32 s81, s55, 15
    s_or_b32 s74, s81, s68
    s_cselect_b32 s74, 99, 1
    v_cmp_ne_u32 s[6:7], s74, v3
    s_mul_i32 s16, s68, 3
    s_min_u32 s16, s16, 7
    s_mul_i32 s74, s81, 10
    s_add_u32 s16, s16, s74
    s_lshl_b32 s16, s16, 10
    s_mul_i32 s74, s54, 163840
    s_add_u32 s16, s16, s74
    s_add_u32 s16, s16, s62
    s_mov_b32 s17, 0xffff0000
    v_lshlrev_b32 v5, 5, v2
    v_lshl_add_u32 v5, v3, 3, v5
    s_lshl_b32 s74, s68, 9
    v_add_u32 v240, s74, v5
    s_cmp_eq_u32 s68, 2
    s_cselect_b64 s[74:75], 0, -1
    s_barrier
    s_waitcnt vmcnt(0)
    s_barrier
    ds_read_b128 v[144:147], v192 offset:0
    ds_read_b64_tr_b16 v[152:153], v198 offset:0
    ds_read_b64_tr_b16 v[154:155], v198 offset:1024
    ds_read_b128 v[148:151], v192 offset:1024
    ds_read_b64_tr_b16 v[156:157], v200 offset:0
    ds_read_b64_tr_b16 v[158:159], v200 offset:1024
    ds_read_b128 v[160:163], v192 offset:2048
    ds_read_b64_tr_b16 v[168:169], v199 offset:4096
    ds_read_b64_tr_b16 v[170:171], v199 offset:5120
    ds_read_b128 v[164:167], v192 offset:3072
    ds_read_b64_tr_b16 v[172:173], v201 offset:4096
    ds_read_b64_tr_b16 v[174:175], v201 offset:5120
    buffer_load_dwordx4 v[220:223], v4, s[20:23], s16 offen offset:0 sc1
    buffer_load_dwordx4 v[224:227], v4, s[20:23], s16 offen offset:1024 sc1
    buffer_load_dwordx4 v[228:231], v4, s[20:23], s16 offen offset:2048 sc1
    s_waitcnt lgkmcnt(6)
    v_mfma_f32_32x32x16_bf16 v[60:75], v[144:147], v[152:155], 0
    s_barrier
    ds_read_b128 v[176:179], v192 offset:4096
    ds_read_b64_tr_b16 v[184:185], v198 offset:16384
    v_mfma_f32_32x32x16_bf16 v[76:91], v[148:151], v[152:155], 0
    ds_read_b64_tr_b16 v[186:187], v198 offset:17408
    ds_read_b128 v[180:183], v192 offset:5120
    v_mfma_f32_32x32x16_bf16 v[108:123], v[148:151], v[156:159], 0
    ds_read_b64_tr_b16 v[188:189], v200 offset:16384
    v_mfma_f32_32x32x16_bf16 v[92:107], v[144:147], v[156:159], 0
    ds_read_b64_tr_b16 v[190:191], v200 offset:17408
    s_waitcnt lgkmcnt(6)
    v_mfma_f32_32x32x16_bf16 v[60:75], v[160:163], v[168:171], v[60:75]
    ds_read_b128 v[144:147], v192 offset:6144
    ds_read_b64_tr_b16 v[152:153], v199 offset:20480
    v_mfma_f32_32x32x16_bf16 v[76:91], v[164:167], v[168:171], v[76:91]
    ds_read_b64_tr_b16 v[154:155], v199 offset:21504
    ds_read_b128 v[148:151], v192 offset:7168
    v_mfma_f32_32x32x16_bf16 v[108:123], v[164:167], v[172:175], v[108:123]
    ds_read_b64_tr_b16 v[156:157], v201 offset:20480
    v_mfma_f32_32x32x16_bf16 v[92:107], v[160:163], v[172:175], v[92:107]
    ds_read_b64_tr_b16 v[158:159], v201 offset:21504
    s_waitcnt lgkmcnt(6)
    v_mfma_f32_32x32x16_bf16 v[60:75], v[176:179], v[184:187], v[60:75]
    s_barrier
    ds_read_b128 v[160:163], v192 offset:8192
    ds_read_b64_tr_b16 v[168:169], v198 offset:32768
    v_mfma_f32_32x32x16_bf16 v[76:91], v[180:183], v[184:187], v[76:91]
    ds_read_b64_tr_b16 v[170:171], v198 offset:33792
    ds_read_b128 v[164:167], v192 offset:9216
    v_mfma_f32_32x32x16_bf16 v[108:123], v[180:183], v[188:191], v[108:123]
    ds_read_b64_tr_b16 v[172:173], v200 offset:32768
    v_mfma_f32_32x32x16_bf16 v[92:107], v[176:179], v[188:191], v[92:107]
    ds_read_b64_tr_b16 v[174:175], v200 offset:33792
    s_waitcnt lgkmcnt(6)
    v_mfma_f32_32x32x16_bf16 v[60:75], v[144:147], v[152:155], v[60:75]
    ds_read_b128 v[176:179], v192 offset:10240
    ds_read_b64_tr_b16 v[184:185], v199 offset:36864
    v_mfma_f32_32x32x16_bf16 v[76:91], v[148:151], v[152:155], v[76:91]
    ds_read_b64_tr_b16 v[186:187], v199 offset:37888
    ds_read_b128 v[180:183], v192 offset:11264
    v_mfma_f32_32x32x16_bf16 v[108:123], v[148:151], v[156:159], v[108:123]
    ds_read_b64_tr_b16 v[188:189], v201 offset:36864
    v_mfma_f32_32x32x16_bf16 v[92:107], v[144:147], v[156:159], v[92:107]
    ds_read_b64_tr_b16 v[190:191], v201 offset:37888
    s_waitcnt lgkmcnt(6)
    v_mfma_f32_32x32x16_bf16 v[60:75], v[160:163], v[168:171], v[60:75]
    s_barrier
    ds_read_b128 v[144:147], v192 offset:12288
    ds_read_b64_tr_b16 v[152:153], v202 offset:0
    v_mfma_f32_32x32x16_bf16 v[76:91], v[164:167], v[168:171], v[76:91]
    ds_read_b64_tr_b16 v[154:155], v202 offset:1024
    ds_read_b128 v[148:151], v192 offset:13312
    v_mfma_f32_32x32x16_bf16 v[108:123], v[164:167], v[172:175], v[108:123]
    ds_read_b64_tr_b16 v[156:157], v204 offset:0
    v_mfma_f32_32x32x16_bf16 v[92:107], v[160:163], v[172:175], v[92:107]
    ds_read_b64_tr_b16 v[158:159], v204 offset:1024
    s_waitcnt lgkmcnt(6)
    v_mfma_f32_32x32x16_bf16 v[60:75], v[176:179], v[184:187], v[60:75]
    ds_read_b128 v[160:163], v192 offset:14336
    ds_read_b64_tr_b16 v[168:169], v203 offset:4096
    v_mfma_f32_32x32x16_bf16 v[76:91], v[180:183], v[184:187], v[76:91]
    ds_read_b64_tr_b16 v[170:171], v203 offset:5120
    ds_read_b128 v[164:167], v192 offset:15360
    v_mfma_f32_32x32x16_bf16 v[108:123], v[180:183], v[188:191], v[108:123]
    ds_read_b64_tr_b16 v[172:173], v205 offset:4096
    v_mfma_f32_32x32x16_bf16 v[92:107], v[176:179], v[188:191], v[92:107]
    ds_read_b64_tr_b16 v[174:175], v205 offset:5120
    s_waitcnt lgkmcnt(6)
    v_mfma_f32_32x32x16_bf16 v[60:75], v[144:147], v[152:155], v[60:75]
    s_barrier
    ds_read_b128 v[176:179], v192 offset:16384
    ds_read_b64_tr_b16 v[184:185], v202 offset:16384
    s_waitcnt vmcnt(0)
    v_max3_u32 v5, v220, v221, v222
    v_max3_u32 v5, v5, v223, v224
    v_mfma_f32_32x32x16_bf16 v[76:91], v[148:151], v[152:155], v[76:91]
    ds_read_b64_tr_b16 v[186:187], v202 offset:17408
    ds_read_b128 v[180:183], v192 offset:17408
    v_max3_u32 v5, v5, v225, v226
    v_max3_u32 v5, v5, v227, v228
    v_mfma_f32_32x32x16_bf16 v[108:123], v[148:151], v[156:159], v[108:123]
    ds_read_b64_tr_b16 v[188:189], v204 offset:16384
    v_max3_u32 v5, v5, v229, v230
    v_max_u32 v5, v5, v231
    v_cmp_eq_u32 vcc, -1, v5
    v_mfma_f32_32x32x16_bf16 v[92:107], v[144:147], v[156:159], v[92:107]
    ds_read_b64_tr_b16 v[190:191], v204 offset:17408
    s_nop 2
    s_cbranch_vccnz Lbad_84
Lok_85:
    s_waitcnt lgkmcnt(6)
    v_mfma_f32_32x32x16_bf16 v[60:75], v[160:163], v[168:171], v[60:75]
    ds_read_b128 v[144:147], v192 offset:18432
    ds_read_b64_tr_b16 v[152:153], v203 offset:20480
    v_cndmask_b32 v220, 0, v220, s[6:7]
    v_cndmask_b32 v221, 0, v221, s[6:7]
    v_cndmask_b32 v222, 0, v222, s[6:7]
    v_cndmask_b32 v223, 0, v223, s[6:7]
    v_mfma_f32_32x32x16_bf16 v[76:91], v[164:167], v[168:171], v[76:91]
    ds_read_b64_tr_b16 v[154:155], v203 offset:21504
    ds_read_b128 v[148:151], v192 offset:19456
    v_cndmask_b32 v224, 0, v224, s[74:75]
    v_cndmask_b32 v225, 0, v225, s[74:75]
    v_cndmask_b32 v226, 0, v226, s[74:75]
    v_cndmask_b32 v227, 0, v227, s[74:75]
    v_mfma_f32_32x32x16_bf16 v[108:123], v[164:167], v[172:175], v[108:123]
    ds_read_b64_tr_b16 v[156:157], v205 offset:20480
    v_cndmask_b32 v228, 0, v228, s[74:75]
    v_cndmask_b32 v229, 0, v229, s[74:75]
    v_cndmask_b32 v230, 0, v230, s[74:75]
    v_cndmask_b32 v231, 0, v231, s[74:75]
    v_lshlrev_b32 v8, 16, v220
    v_mfma_f32_32x32x16_bf16 v[92:107], v[160:163], v[172:175], v[92:107]
    ds_read_b64_tr_b16 v[158:159], v205 offset:21504
    v_and_b32 v9, s17, v220
    v_lshlrev_b32 v10, 16, v221
    v_and_b32 v11, s17, v221
    v_lshlrev_b32 v12, 16, v222
    v_and_b32 v13, s17, v222
    s_waitcnt lgkmcnt(6)
    v_mfma_f32_32x32x16_bf16 v[60:75], v[176:179], v[184:187], v[60:75]
    s_barrier
    ds_read_b128 v[160:163], v192 offset:20480
    ds_read_b64_tr_b16 v[168:169], v198 offset:0
    v_lshlrev_b32 v14, 16, v223
    v_and_b32 v15, s17, v223
    v_mul_f32 v232, v8, v8
    v_mul_f32 v233, v9, v9
    v_mfma_f32_32x32x16_bf16 v[76:91], v[180:183], v[184:187], v[76:91]
    ds_read_b64_tr_b16 v[170:171], v198 offset:1024
    ds_read_b128 v[164:167], v192 offset:21504
    v_mul_f32 v234, v10, v10
    v_mul_f32 v235, v11, v11
    v_mul_f32 v236, v12, v12
    v_mul_f32 v237, v13, v13
    v_mfma_f32_32x32x16_bf16 v[108:123], v[180:183], v[188:191], v[108:123]
    ds_read_b64_tr_b16 v[172:173], v200 offset:0
    v_mul_f32 v238, v14, v14
    v_mul_f32 v239, v15, v15
    v_lshlrev_b32 v8, 16, v224
    v_and_b32 v9, s17, v224
    v_lshlrev_b32 v10, 16, v225
    v_mfma_f32_32x32x16_bf16 v[92:107], v[176:179], v[188:191], v[92:107]
    ds_read_b64_tr_b16 v[174:175], v200 offset:1024
    v_and_b32 v11, s17, v225
    v_lshlrev_b32 v12, 16, v226
    v_and_b32 v13, s17, v226
    v_lshlrev_b32 v14, 16, v227
    v_and_b32 v15, s17, v227
    s_waitcnt lgkmcnt(6)
    v_mfma_f32_32x32x16_bf16 v[60:75], v[144:147], v[152:155], v[60:75]
    ds_read_b128 v[176:179], v192 offset:22528
    ds_read_b64_tr_b16 v[184:185], v199 offset:4096
    v_fmac_f32 v232, v8, v8
    v_fmac_f32 v233, v9, v9
    v_fmac_f32 v234, v10, v10
    v_fmac_f32 v235, v11, v11
    v_mfma_f32_32x32x16_bf16 v[76:91], v[148:151], v[152:155], v[76:91]
    ds_read_b64_tr_b16 v[186:187], v199 offset:5120
    ds_read_b128 v[180:183], v192 offset:23552
    v_fmac_f32 v236, v12, v12
    v_fmac_f32 v237, v13, v13
    v_fmac_f32 v238, v14, v14
    v_fmac_f32 v239, v15, v15
    v_mfma_f32_32x32x16_bf16 v[108:123], v[148:151], v[156:159], v[108:123]
    ds_read_b64_tr_b16 v[188:189], v201 offset:4096
    v_lshlrev_b32 v8, 16, v228
    v_and_b32 v9, s17, v228
    v_lshlrev_b32 v10, 16, v229
    v_and_b32 v11, s17, v229
    v_lshlrev_b32 v12, 16, v230
    v_mfma_f32_32x32x16_bf16 v[92:107], v[144:147], v[156:159], v[92:107]
    ds_read_b64_tr_b16 v[190:191], v201 offset:5120
    v_and_b32 v13, s17, v230
    v_lshlrev_b32 v14, 16, v231
    v_and_b32 v15, s17, v231
    v_fmac_f32 v232, v8, v8
    v_fmac_f32 v233, v9, v9
    s_waitcnt lgkmcnt(6)
    v_mfma_f32_32x32x16_bf16 v[60:75], v[160:163], v[168:171], v[60:75]
    s_barrier
    ds_read_b128 v[144:147], v192 offset:24576
    ds_read_b64_tr_b16 v[152:153], v198 offset:16384
    v_fmac_f32 v234, v10, v10
    v_fmac_f32 v235, v11, v11
    v_fmac_f32 v236, v12, v12
    v_fmac_f32 v237, v13, v13
    v_mfma_f32_32x32x16_bf16 v[76:91], v[164:167], v[168:171], v[76:91]
    ds_read_b64_tr_b16 v[154:155], v198 offset:17408
    ds_read_b128 v[148:151], v192 offset:25600
    v_fmac_f32 v238, v14, v14
    v_fmac_f32 v239, v15, v15
    v_permlane32_swap_b32 v232, v236
    v_permlane32_swap_b32 v233, v237
    v_mfma_f32_32x32x16_bf16 v[108:123], v[164:167], v[172:175], v[108:123]
    ds_read_b64_tr_b16 v[156:157], v200 offset:16384
    v_permlane32_swap_b32 v234, v238
    v_permlane32_swap_b32 v235, v239
    v_add_f32 v232, v232, v236
    v_add_f32 v233, v233, v237
    v_add_f32 v234, v234, v238
    v_mfma_f32_32x32x16_bf16 v[92:107], v[160:163], v[172:175], v[92:107]
    ds_read_b64_tr_b16 v[158:159], v200 offset:17408
    v_add_f32 v235, v235, v239
    v_permlane16_swap_b32 v232, v234
    s_nop 0
    v_permlane16_swap_b32 v233, v235
    v_add_f32 v232, v232, v234
    v_add_f32 v233, v233, v235
    s_waitcnt lgkmcnt(6)
    v_mfma_f32_32x32x16_bf16 v[60:75], v[176:179], v[184:187], v[60:75]
    ds_read_b128 v[160:163], v192 offset:26624
    ds_read_b64_tr_b16 v[168:169], v199 offset:20480
    v_mfma_f32_32x32x16_bf16 v[76:91], v[180:183], v[184:187], v[76:91]
    ds_read_b64_tr_b16 v[170:171], v199 offset:21504
    ds_read_b128 v[164:167], v192 offset:27648
    v_mfma_f32_32x32x16_bf16 v[108:123], v[180:183], v[188:191], v[108:123]
    ds_read_b64_tr_b16 v[172:173], v201 offset:20480
    v_mfma_f32_32x32x16_bf16 v[92:107], v[176:179], v[188:191], v[92:107]
    ds_read_b64_tr_b16 v[174:175], v201 offset:21504
    s_waitcnt lgkmcnt(6)
    v_mfma_f32_32x32x16_bf16 v[60:75], v[144:147], v[152:155], v[60:75]
    s_barrier
    ds_write_b64 v240, v[232:233] offset:16384
    ds_read_b128 v[176:179], v192 offset:28672
    ds_read_b64_tr_b16 v[184:185], v198 offset:32768
    v_mfma_f32_32x32x16_bf16 v[76:91], v[148:151], v[152:155], v[76:91]
    ds_read_b64_tr_b16 v[186:187], v198 offset:33792
    ds_read_b128 v[180:183], v192 offset:29696
    v_mfma_f32_32x32x16_bf16 v[108:123], v[148:151], v[156:159], v[108:123]
    ds_read_b64_tr_b16 v[188:189], v200 offset:32768
    v_mfma_f32_32x32x16_bf16 v[92:107], v[144:147], v[156:159], v[92:107]
    ds_read_b64_tr_b16 v[190:191], v200 offset:33792
    s_waitcnt lgkmcnt(6)
    v_mfma_f32_32x32x16_bf16 v[60:75], v[160:163], v[168:171], v[60:75]
    ds_read_b128 v[144:147], v192 offset:30720
    ds_read_b64_tr_b16 v[152:153], v199 offset:36864
    v_mfma_f32_32x32x16_bf16 v[76:91], v[164:167], v[168:171], v[76:91]
    ds_read_b64_tr_b16 v[154:155], v199 offset:37888
    ds_read_b128 v[148:151], v192 offset:31744
    v_mfma_f32_32x32x16_bf16 v[108:123], v[164:167], v[172:175], v[108:123]
    ds_read_b64_tr_b16 v[156:157], v201 offset:36864
    v_mfma_f32_32x32x16_bf16 v[92:107], v[160:163], v[172:175], v[92:107]
    ds_read_b64_tr_b16 v[158:159], v201 offset:37888
    s_waitcnt lgkmcnt(6)
    v_mfma_f32_32x32x16_bf16 v[60:75], v[176:179], v[184:187], v[60:75]
    s_barrier
    ds_read_b128 v[160:163], v192 offset:32768
    ds_read_b64_tr_b16 v[168:169], v202 offset:0
    v_mfma_f32_32x32x16_bf16 v[76:91], v[180:183], v[184:187], v[76:91]
    ds_read_b64_tr_b16 v[170:171], v202 offset:1024
    ds_read_b128 v[164:167], v192 offset:33792
    v_mfma_f32_32x32x16_bf16 v[108:123], v[180:183], v[188:191], v[108:123]
    ds_read_b64_tr_b16 v[172:173], v204 offset:0
    v_mfma_f32_32x32x16_bf16 v[92:107], v[176:179], v[188:191], v[92:107]
    ds_read_b64_tr_b16 v[174:175], v204 offset:1024
    s_waitcnt lgkmcnt(6)
    v_mfma_f32_32x32x16_bf16 v[60:75], v[144:147], v[152:155], v[60:75]
    ds_read_b128 v[176:179], v192 offset:34816
    ds_read_b64_tr_b16 v[184:185], v203 offset:4096
    v_mfma_f32_32x32x16_bf16 v[76:91], v[148:151], v[152:155], v[76:91]
    ds_read_b64_tr_b16 v[186:187], v203 offset:5120
    ds_read_b128 v[180:183], v192 offset:35840
    v_mfma_f32_32x32x16_bf16 v[108:123], v[148:151], v[156:159], v[108:123]
    ds_read_b64_tr_b16 v[188:189], v205 offset:4096
    v_mfma_f32_32x32x16_bf16 v[92:107], v[144:147], v[156:159], v[92:107]
    ds_read_b64_tr_b16 v[190:191], v205 offset:5120
    s_waitcnt lgkmcnt(6)
    v_mfma_f32_32x32x16_bf16 v[60:75], v[160:163], v[168:171], v[60:75]
    s_barrier
    ds_read_b128 v[144:147], v192 offset:36864
    ds_read_b64_tr_b16 v[152:153], v202 offset:16384
    v_mfma_f32_32x32x16_bf16 v[76:91], v[164:167], v[168:171], v[76:91]
    ds_read_b64_tr_b16 v[154:155], v202 offset:17408
    ds_read_b128 v[148:151], v192 offset:37888
    v_mfma_f32_32x32x16_bf16 v[108:123], v[164:167], v[172:175], v[108:123]
    ds_read_b64_tr_b16 v[156:157], v204 offset:16384
    v_mfma_f32_32x32x16_bf16 v[92:107], v[160:163], v[172:175], v[92:107]
    ds_read_b64_tr_b16 v[158:159], v204 offset:17408
    s_waitcnt lgkmcnt(6)
    v_mfma_f32_32x32x16_bf16 v[60:75], v[176:179], v[184:187], v[60:75]
    ds_read_b128 v[160:163], v192 offset:38912
    ds_read_b64_tr_b16 v[168:169], v203 offset:20480
    v_mfma_f32_32x32x16_bf16 v[76:91], v[180:183], v[184:187], v[76:91]
    ds_read_b64_tr_b16 v[170:171], v203 offset:21504
    ds_read_b128 v[164:167], v192 offset:39936
    v_mfma_f32_32x32x16_bf16 v[108:123], v[180:183], v[188:191], v[108:123]
    ds_read_b64_tr_b16 v[172:173], v205 offset:20480
    v_mfma_f32_32x32x16_bf16 v[92:107], v[176:179], v[188:191], v[92:107]
    ds_read_b64_tr_b16 v[174:175], v205 offset:21504
    s_waitcnt lgkmcnt(6)
    v_mfma_f32_32x32x16_bf16 v[60:75], v[144:147], v[152:155], v[60:75]
    s_barrier
    ds_read_b128 v[176:179], v193 offset:0
    ds_read_b64_tr_b16 v[184:185], v198 offset:0
    v_mfma_f32_32x32x16_bf16 v[76:91], v[148:151], v[152:155], v[76:91]
    ds_read_b64_tr_b16 v[186:187], v198 offset:1024
    ds_read_b128 v[180:183], v193 offset:1024
    v_mfma_f32_32x32x16_bf16 v[108:123], v[148:151], v[156:159], v[108:123]
    ds_read_b64_tr_b16 v[188:189], v200 offset:0
    v_mfma_f32_32x32x16_bf16 v[92:107], v[144:147], v[156:159], v[92:107]
    ds_read_b64_tr_b16 v[190:191], v200 offset:1024
    s_waitcnt lgkmcnt(6)
    v_mfma_f32_32x32x16_bf16 v[60:75], v[160:163], v[168:171], v[60:75]
    ds_read_b128 v[144:147], v193 offset:2048
    ds_read_b64_tr_b16 v[152:153], v199 offset:4096
    v_mfma_f32_32x32x16_bf16 v[76:91], v[164:167], v[168:171], v[76:91]
    ds_read_b64_tr_b16 v[154:155], v199 offset:5120
    ds_read_b128 v[148:151], v193 offset:3072
    v_mfma_f32_32x32x16_bf16 v[108:123], v[164:167], v[172:175], v[108:123]
    ds_read_b64_tr_b16 v[156:157], v201 offset:4096
    v_mfma_f32_32x32x16_bf16 v[92:107], v[160:163], v[172:175], v[92:107]
    ds_read_b64_tr_b16 v[158:159], v201 offset:5120
    s_waitcnt lgkmcnt(6)
    v_mfma_f32_32x32x16_bf16 v[60:75], v[176:179], v[184:187], v[60:75]
    s_barrier
    ds_read_b128 v[160:163], v193 offset:4096
    ds_read_b64_tr_b16 v[168:169], v198 offset:16384
    v_mfma_f32_32x32x16_bf16 v[76:91], v[180:183], v[184:187], v[76:91]
    ds_read_b64_tr_b16 v[170:171], v198 offset:17408
    ds_read_b128 v[164:167], v193 offset:5120
    v_mfma_f32_32x32x16_bf16 v[108:123], v[180:183], v[188:191], v[108:123]
    ds_read_b64_tr_b16 v[172:173], v200 offset:16384
    v_mfma_f32_32x32x16_bf16 v[92:107], v[176:179], v[188:191], v[92:107]
    ds_read_b64_tr_b16 v[174:175], v200 offset:17408
    s_waitcnt lgkmcnt(6)
    v_mfma_f32_32x32x16_bf16 v[60:75], v[144:147], v[152:155], v[60:75]
    ds_read_b128 v[176:179], v193 offset:6144
    ds_read_b64_tr_b16 v[184:185], v199 offset:20480
    v_mfma_f32_32x32x16_bf16 v[76:91], v[148:151], v[152:155], v[76:91]
    ds_read_b64_tr_b16 v[186:187], v199 offset:21504
    ds_read_b128 v[180:183], v193 offset:7168
    v_mfma_f32_32x32x16_bf16 v[108:123], v[148:151], v[156:159], v[108:123]
    ds_read_b64_tr_b16 v[188:189], v201 offset:20480
    v_mfma_f32_32x32x16_bf16 v[92:107], v[144:147], v[156:159], v[92:107]
    ds_read_b64_tr_b16 v[190:191], v201 offset:21504
    s_waitcnt lgkmcnt(6)
    v_mfma_f32_32x32x16_bf16 v[60:75], v[160:163], v[168:171], v[60:75]
    s_barrier
    ds_read_b128 v[144:147], v193 offset:8192
    ds_read_b64_tr_b16 v[152:153], v198 offset:32768
    v_mfma_f32_32x32x16_bf16 v[76:91], v[164:167], v[168:171], v[76:91]
    ds_read_b64_tr_b16 v[154:155], v198 offset:33792
    ds_read_b128 v[148:151], v193 offset:9216
    v_mfma_f32_32x32x16_bf16 v[108:123], v[164:167], v[172:175], v[108:123]
    ds_read_b64_tr_b16 v[156:157], v200 offset:32768
    v_mfma_f32_32x32x16_bf16 v[92:107], v[160:163], v[172:175], v[92:107]
    ds_read_b64_tr_b16 v[158:159], v200 offset:33792
    s_waitcnt lgkmcnt(6)
    v_mfma_f32_32x32x16_bf16 v[60:75], v[176:179], v[184:187], v[60:75]
    ds_read_b128 v[160:163], v193 offset:10240
    ds_read_b64_tr_b16 v[168:169], v199 offset:36864
    v_mfma_f32_32x32x16_bf16 v[76:91], v[180:183], v[184:187], v[76:91]
    ds_read_b64_tr_b16 v[170:171], v199 offset:37888
    ds_read_b128 v[164:167], v193 offset:11264
    v_mfma_f32_32x32x16_bf16 v[108:123], v[180:183], v[188:191], v[108:123]
    ds_read_b64_tr_b16 v[172:173], v201 offset:36864
    v_mfma_f32_32x32x16_bf16 v[92:107], v[176:179], v[188:191], v[92:107]
    ds_read_b64_tr_b16 v[174:175], v201 offset:37888
    s_waitcnt lgkmcnt(6)
    v_mfma_f32_32x32x16_bf16 v[60:75], v[144:147], v[152:155], v[60:75]
    s_barrier
    ds_read_b128 v[176:179], v193 offset:12288
    ds_read_b64_tr_b16 v[184:185], v202 offset:0
    v_mfma_f32_32x32x16_bf16 v[76:91], v[148:151], v[152:155], v[76:91]
    ds_read_b64_tr_b16 v[186:187], v202 offset:1024
    ds_read_b128 v[180:183], v193 offset:13312
    v_mfma_f32_32x32x16_bf16 v[108:123], v[148:151], v[156:159], v[108:123]
    ds_read_b64_tr_b16 v[188:189], v204 offset:0
    v_mfma_f32_32x32x16_bf16 v[92:107], v[144:147], v[156:159], v[92:107]
    ds_read_b64_tr_b16 v[190:191], v204 offset:1024
    s_waitcnt lgkmcnt(6)
    v_mfma_f32_32x32x16_bf16 v[60:75], v[160:163], v[168:171], v[60:75]
    ds_read_b128 v[144:147], v193 offset:14336
    ds_read_b64_tr_b16 v[152:153], v203 offset:4096
    v_mfma_f32_32x32x16_bf16 v[76:91], v[164:167], v[168:171], v[76:91]
    ds_read_b64_tr_b16 v[154:155], v203 offset:5120
    ds_read_b128 v[148:151], v193 offset:15360
    v_mfma_f32_32x32x16_bf16 v[108:123], v[164:167], v[172:175], v[108:123]
    ds_read_b64_tr_b16 v[156:157], v205 offset:4096
    v_mfma_f32_32x32x16_bf16 v[92:107], v[160:163], v[172:175], v[92:107]
    ds_read_b64_tr_b16 v[158:159], v205 offset:5120
    s_waitcnt lgkmcnt(6)
    v_mfma_f32_32x32x16_bf16 v[60:75], v[176:179], v[184:187], v[60:75]
    s_barrier
    ds_read_b128 v[160:163], v193 offset:16384
    ds_read_b64_tr_b16 v[168:169], v202 offset:16384
    v_mfma_f32_32x32x16_bf16 v[76:91], v[180:183], v[184:187], v[76:91]
    ds_read_b64_tr_b16 v[170:171], v202 offset:17408
    ds_read_b128 v[164:167], v193 offset:17408
    v_mfma_f32_32x32x16_bf16 v[108:123], v[180:183], v[188:191], v[108:123]
    ds_read_b64_tr_b16 v[172:173], v204 offset:16384
    v_mfma_f32_32x32x16_bf16 v[92:107], v[176:179], v[188:191], v[92:107]
    ds_read_b64_tr_b16 v[174:175], v204 offset:17408
    s_waitcnt lgkmcnt(6)
    v_mfma_f32_32x32x16_bf16 v[60:75], v[144:147], v[152:155], v[60:75]
    ds_read_b128 v[176:179], v193 offset:18432
    ds_read_b64_tr_b16 v[184:185], v203 offset:20480
    v_mfma_f32_32x32x16_bf16 v[76:91], v[148:151], v[152:155], v[76:91]
    ds_read_b64_tr_b16 v[186:187], v203 offset:21504
    ds_read_b128 v[180:183], v193 offset:19456
    v_mfma_f32_32x32x16_bf16 v[108:123], v[148:151], v[156:159], v[108:123]
    ds_read_b64_tr_b16 v[188:189], v205 offset:20480
    v_mfma_f32_32x32x16_bf16 v[92:107], v[144:147], v[156:159], v[92:107]
    ds_read_b64_tr_b16 v[190:191], v205 offset:21504
    s_waitcnt lgkmcnt(6)
    v_mfma_f32_32x32x16_bf16 v[60:75], v[160:163], v[168:171], v[60:75]
    s_barrier
    ds_read_b128 v[144:147], v193 offset:20480
    ds_read_b64_tr_b16 v[152:153], v198 offset:0
    v_mfma_f32_32x32x16_bf16 v[76:91], v[164:167], v[168:171], v[76:91]
    ds_read_b64_tr_b16 v[154:155], v198 offset:1024
    ds_read_b128 v[148:151], v193 offset:21504
    v_mfma_f32_32x32x16_bf16 v[108:123], v[164:167], v[172:175], v[108:123]
    ds_read_b64_tr_b16 v[156:157], v200 offset:0
    v_mfma_f32_32x32x16_bf16 v[92:107], v[160:163], v[172:175], v[92:107]
    ds_read_b64_tr_b16 v[158:159], v200 offset:1024
    s_waitcnt lgkmcnt(6)
    v_mfma_f32_32x32x16_bf16 v[60:75], v[176:179], v[184:187], v[60:75]
    ds_read_b128 v[160:163], v193 offset:22528
    ds_read_b64_tr_b16 v[168:169], v199 offset:4096
    v_mfma_f32_32x32x16_bf16 v[76:91], v[180:183], v[184:187], v[76:91]
    ds_read_b64_tr_b16 v[170:171], v199 offset:5120
    ds_read_b128 v[164:167], v193 offset:23552
    v_mfma_f32_32x32x16_bf16 v[108:123], v[180:183], v[188:191], v[108:123]
    ds_read_b64_tr_b16 v[172:173], v201 offset:4096
    v_mfma_f32_32x32x16_bf16 v[92:107], v[176:179], v[188:191], v[92:107]
    ds_read_b64_tr_b16 v[174:175], v201 offset:5120
    s_waitcnt lgkmcnt(6)
    v_mfma_f32_32x32x16_bf16 v[60:75], v[144:147], v[152:155], v[60:75]
    s_barrier
    ds_read_b128 v[176:179], v193 offset:24576
    ds_read_b64_tr_b16 v[184:185], v198 offset:16384
    v_mfma_f32_32x32x16_bf16 v[76:91], v[148:151], v[152:155], v[76:91]
    ds_read_b64_tr_b16 v[186:187], v198 offset:17408
    ds_read_b128 v[180:183], v193 offset:25600
    v_mfma_f32_32x32x16_bf16 v[108:123], v[148:151], v[156:159], v[108:123]
    ds_read_b64_tr_b16 v[188:189], v200 offset:16384
    v_mfma_f32_32x32x16_bf16 v[92:107], v[144:147], v[156:159], v[92:107]
    ds_read_b64_tr_b16 v[190:191], v200 offset:17408
    s_waitcnt lgkmcnt(6)
    v_mfma_f32_32x32x16_bf16 v[60:75], v[160:163], v[168:171], v[60:75]
    ds_read_b128 v[144:147], v193 offset:26624
    ds_read_b64_tr_b16 v[152:153], v199 offset:20480
    v_mfma_f32_32x32x16_bf16 v[76:91], v[164:167], v[168:171], v[76:91]
    ds_read_b64_tr_b16 v[154:155], v199 offset:21504
    ds_read_b128 v[148:151], v193 offset:27648
    v_mfma_f32_32x32x16_bf16 v[108:123], v[164:167], v[172:175], v[108:123]
    ds_read_b64_tr_b16 v[156:157], v201 offset:20480
    v_mfma_f32_32x32x16_bf16 v[92:107], v[160:163], v[172:175], v[92:107]
    ds_read_b64_tr_b16 v[158:159], v201 offset:21504
    s_waitcnt lgkmcnt(6)
    v_mfma_f32_32x32x16_bf16 v[60:75], v[176:179], v[184:187], v[60:75]
    s_barrier
    ds_read_b128 v[160:163], v193 offset:28672
    ds_read_b64_tr_b16 v[168:169], v198 offset:32768
    v_mfma_f32_32x32x16_bf16 v[76:91], v[180:183], v[184:187], v[76:91]
    ds_read_b64_tr_b16 v[170:171], v198 offset:33792
    ds_read_b128 v[164:167], v193 offset:29696
    v_mfma_f32_32x32x16_bf16 v[108:123], v[180:183], v[188:191], v[108:123]
    ds_read_b64_tr_b16 v[172:173], v200 offset:32768
    v_mfma_f32_32x32x16_bf16 v[92:107], v[176:179], v[188:191], v[92:107]
    ds_read_b64_tr_b16 v[174:175], v200 offset:33792
    s_waitcnt lgkmcnt(6)
    v_mfma_f32_32x32x16_bf16 v[60:75], v[144:147], v[152:155], v[60:75]
    ds_read_b128 v[176:179], v193 offset:30720
    ds_read_b64_tr_b16 v[184:185], v199 offset:36864
    v_mfma_f32_32x32x16_bf16 v[76:91], v[148:151], v[152:155], v[76:91]
    ds_read_b64_tr_b16 v[186:187], v199 offset:37888
    ds_read_b128 v[180:183], v193 offset:31744
    v_mfma_f32_32x32x16_bf16 v[108:123], v[148:151], v[156:159], v[108:123]
    ds_read_b64_tr_b16 v[188:189], v201 offset:36864
    v_mfma_f32_32x32x16_bf16 v[92:107], v[144:147], v[156:159], v[92:107]
    ds_read_b64_tr_b16 v[190:191], v201 offset:37888
    s_waitcnt lgkmcnt(6)
    v_mfma_f32_32x32x16_bf16 v[60:75], v[160:163], v[168:171], v[60:75]
    s_barrier
    ds_read_b128 v[144:147], v193 offset:32768
    ds_read_b64_tr_b16 v[152:153], v202 offset:0
    v_mfma_f32_32x32x16_bf16 v[76:91], v[164:167], v[168:171], v[76:91]
    ds_read_b64_tr_b16 v[154:155], v202 offset:1024
    ds_read_b128 v[148:151], v193 offset:33792
    v_mfma_f32_32x32x16_bf16 v[108:123], v[164:167], v[172:175], v[108:123]
    ds_read_b64_tr_b16 v[156:157], v204 offset:0
    v_mfma_f32_32x32x16_bf16 v[92:107], v[160:163], v[172:175], v[92:107]
    ds_read_b64_tr_b16 v[158:159], v204 offset:1024
    s_waitcnt lgkmcnt(6)
    v_mfma_f32_32x32x16_bf16 v[60:75], v[176:179], v[184:187], v[60:75]
    ds_read_b128 v[160:163], v193 offset:34816
    ds_read_b64_tr_b16 v[168:169], v203 offset:4096
    v_mfma_f32_32x32x16_bf16 v[76:91], v[180:183], v[184:187], v[76:91]
    ds_read_b64_tr_b16 v[170:171], v203 offset:5120
    ds_read_b128 v[164:167], v193 offset:35840
    v_mfma_f32_32x32x16_bf16 v[108:123], v[180:183], v[188:191], v[108:123]
    ds_read_b64_tr_b16 v[172:173], v205 offset:4096
    v_mfma_f32_32x32x16_bf16 v[92:107], v[176:179], v[188:191], v[92:107]
    ds_read_b64_tr_b16 v[174:175], v205 offset:5120
    s_waitcnt lgkmcnt(6)
    v_mfma_f32_32x32x16_bf16 v[60:75], v[144:147], v[152:155], v[60:75]
    s_barrier
    ds_read_b128 v[176:179], v193 offset:36864
    ds_read_b64_tr_b16 v[184:185], v202 offset:16384
    v_mfma_f32_32x32x16_bf16 v[76:91], v[148:151], v[152:155], v[76:91]
    ds_read_b64_tr_b16 v[186:187], v202 offset:17408
    ds_read_b128 v[180:183], v193 offset:37888
    v_mfma_f32_32x32x16_bf16 v[108:123], v[148:151], v[156:159], v[108:123]
    ds_read_b64_tr_b16 v[188:189], v204 offset:16384
    v_mfma_f32_32x32x16_bf16 v[92:107], v[144:147], v[156:159], v[92:107]
    ds_read_b64_tr_b16 v[190:191], v204 offset:17408
    s_waitcnt lgkmcnt(6)
    v_mfma_f32_32x32x16_bf16 v[60:75], v[160:163], v[168:171], v[60:75]
    ds_read_b128 v[144:147], v193 offset:38912
    ds_read_b64_tr_b16 v[152:153], v203 offset:20480
    v_mfma_f32_32x32x16_bf16 v[76:91], v[164:167], v[168:171], v[76:91]
    ds_read_b64_tr_b16 v[154:155], v203 offset:21504
    ds_read_b128 v[148:151], v193 offset:39936
    v_mfma_f32_32x32x16_bf16 v[108:123], v[164:167], v[172:175], v[108:123]
    ds_read_b64_tr_b16 v[156:157], v205 offset:20480
    v_mfma_f32_32x32x16_bf16 v[92:107], v[160:163], v[172:175], v[92:107]
    ds_read_b64_tr_b16 v[158:159], v205 offset:21504
    s_waitcnt lgkmcnt(6)
    v_mfma_f32_32x32x16_bf16 v[60:75], v[176:179], v[184:187], v[60:75]
    ds_read_b32 v8, v209 offset:0
    ds_read_b32 v9, v209 offset:512
    v_mfma_f32_32x32x16_bf16 v[76:91], v[180:183], v[184:187], v[76:91]
    ds_read_b32 v10, v209 offset:128
    ds_read_b32 v11, v209 offset:640
    v_mfma_f32_32x32x16_bf16 v[108:123], v[180:183], v[188:191], v[108:123]
    v_mfma_f32_32x32x16_bf16 v[92:107], v[176:179], v[188:191], v[92:107]
    s_waitcnt lgkmcnt(0)
    v_mfma_f32_32x32x16_bf16 v[76:91], v[148:151], v[152:155], v[76:91]
    s_barrier
    v_add_f32 v8, v8, v9
    v_add_f32 v10, v10, v11
    v_mfma_f32_32x32x16_bf16 v[108:123], v[148:151], v[156:159], v[108:123]
    v_fma_f32 v220, v8, s78, v216
    v_fma_f32 v222, v10, s78, v216
    v_mfma_f32_32x32x16_bf16 v[60:75], v[144:147], v[152:155], v[60:75]
    v_rsq_f32 v220, v220
    v_rsq_f32 v222, v222
    v_mfma_f32_32x32x16_bf16 v[92:107], v[144:147], v[156:159], v[92:107]
    s_nop 1
    v_pk_mul_f32 v[80:81], v[80:81], v[220:221] op_sel_hi:[1,0]
    v_pk_mul_f32 v[82:83], v[82:83], v[220:221] op_sel_hi:[1,0]
    v_pk_mul_f32 v[84:85], v[84:85], v[220:221] op_sel_hi:[1,0]
    v_pk_mul_f32 v[86:87], v[86:87], v[220:221] op_sel_hi:[1,0]
    v_pk_mul_f32 v[88:89], v[88:89], v[220:221] op_sel_hi:[1,0]
    v_pk_mul_f32 v[90:91], v[90:91], v[220:221] op_sel_hi:[1,0]
    v_cvt_pk_bf16_f32 v154, v80, v81
    v_cvt_pk_bf16_f32 v155, v82, v83
    v_cvt_pk_bf16_f32 v156, v84, v85
    v_cvt_pk_bf16_f32 v157, v86, v87
    v_cvt_pk_bf16_f32 v158, v88, v89
    v_cvt_pk_bf16_f32 v159, v90, v91
    ds_write_b64 v206, v[154:155] offset:0
    ds_write_b64 v206, v[156:157] offset:8
    ds_write_b64 v206, v[158:159] offset:16
    ds_read_b64_tr_b16 v[168:169], v207 offset:0
    ds_read_b64_tr_b16 v[170:171], v207 offset:192
    ds_read_b64_tr_b16 v[172:173], v207 offset:768
    ds_read_b64_tr_b16 v[174:175], v207 offset:960
    v_pk_mul_f32 v[112:113], v[112:113], v[222:223] op_sel_hi:[1,0]
    v_pk_mul_f32 v[114:115], v[114:115], v[222:223] op_sel_hi:[1,0]
    v_pk_mul_f32 v[116:117], v[116:117], v[222:223] op_sel_hi:[1,0]
    v_pk_mul_f32 v[118:119], v[118:119], v[222:223] op_sel_hi:[1,0]
    v_pk_mul_f32 v[120:121], v[120:121], v[222:223] op_sel_hi:[1,0]
    v_pk_mul_f32 v[122:123], v[122:123], v[222:223] op_sel_hi:[1,0]
    v_cvt_pk_bf16_f32 v160, v112, v113
    v_cvt_pk_bf16_f32 v161, v114, v115
    v_cvt_pk_bf16_f32 v162, v116, v117
    v_cvt_pk_bf16_f32 v163, v118, v119
    v_cvt_pk_bf16_f32 v164, v120, v121
    v_cvt_pk_bf16_f32 v165, v122, v123
    ds_write_b64 v206, v[160:161] offset:1536
    ds_write_b64 v206, v[162:163] offset:1544
    ds_write_b64 v206, v[164:165] offset:1552
    ds_read_b64_tr_b16 v[176:177], v207 offset:1536
    ds_read_b64_tr_b16 v[178:179], v207 offset:1728
    ds_read_b64_tr_b16 v[180:181], v207 offset:2304
    ds_read_b64_tr_b16 v[182:183], v207 offset:2496
    v_pk_mul_f32 v[68:69], v[68:69], v[220:221] op_sel_hi:[1,0]
    v_pk_mul_f32 v[70:71], v[70:71], v[220:221] op_sel_hi:[1,0]
    v_pk_mul_f32 v[72:73], v[72:73], v[220:221] op_sel_hi:[1,0]
    v_pk_mul_f32 v[74:75], v[74:75], v[220:221] op_sel_hi:[1,0]
    v_cvt_pk_bf16_f32 v144, v68, v69
    v_cvt_pk_bf16_f32 v145, v70, v71
    v_cvt_pk_bf16_f32 v146, v72, v73
    v_cvt_pk_bf16_f32 v147, v74, v75
    buffer_store_dwordx4 v[144:147], v4, s[20:23], s77 offen offset:0 sc1
    v_pk_mul_f32 v[76:77], v[76:77], v[220:221] op_sel_hi:[1,0]
    v_pk_mul_f32 v[78:79], v[78:79], v[220:221] op_sel_hi:[1,0]
    v_cvt_pk_bf16_f32 v166, v76, v77
    v_cvt_pk_bf16_f32 v167, v78, v79
    v_pk_mul_f32 v[100:101], v[100:101], v[222:223] op_sel_hi:[1,0]
    v_pk_mul_f32 v[102:103], v[102:103], v[222:223] op_sel_hi:[1,0]
    v_pk_mul_f32 v[104:105], v[104:105], v[222:223] op_sel_hi:[1,0]
    v_pk_mul_f32 v[106:107], v[106:107], v[222:223] op_sel_hi:[1,0]
    v_cvt_pk_bf16_f32 v148, v100, v101
    v_cvt_pk_bf16_f32 v149, v102, v103
    v_cvt_pk_bf16_f32 v150, v104, v105
    v_cvt_pk_bf16_f32 v151, v106, v107
    buffer_store_dwordx4 v[148:151], v4, s[20:23], s77 offen offset:2304 sc1
    v_pk_mul_f32 v[108:109], v[108:109], v[222:223] op_sel_hi:[1,0]
    v_pk_mul_f32 v[110:111], v[110:111], v[222:223] op_sel_hi:[1,0]
    v_cvt_pk_bf16_f32 v152, v108, v109
    v_cvt_pk_bf16_f32 v153, v110, v111
    s_nop 0
    v_permlane32_swap_b32 v166, v152
    v_permlane32_swap_b32 v167, v153
    buffer_store_dwordx2 v[152:153], v212, s[20:23], s76 offen sc1
    s_mov_b64 exec, s[4:5]
    s_waitcnt lgkmcnt(0)
    buffer_store_dwordx4 v[168:171], v208, s[20:23], s77 offen offset:1024 sc1
    buffer_store_dwordx4 v[172:175], v208, s[20:23], s77 offen offset:1664 sc1
    buffer_store_dwordx4 v[176:179], v208, s[20:23], s77 offen offset:3328 sc1
    buffer_store_dwordx4 v[180:183], v208, s[20:23], s77 offen offset:3968 sc1
    ds_write_b128 v211, v[168:171] offset:1024
    ds_write_b128 v211, v[172:175] offset:1664
    ds_write_b128 v211, v[176:179] offset:3328
    ds_write_b128 v211, v[180:183] offset:3968
    s_mov_b64 exec, -1
    v_pk_mul_f32 v[60:61], v[60:61], v[220:221] op_sel_hi:[1,0]
    v_pk_mul_f32 v[62:63], v[62:63], v[220:221] op_sel_hi:[1,0]
    v_pk_mul_f32 v[64:65], v[64:65], v[220:221] op_sel_hi:[1,0]
    v_pk_mul_f32 v[66:67], v[66:67], v[220:221] op_sel_hi:[1,0]
    v_cvt_pk_bf16_f32 v8, v60, v61
    v_cvt_pk_bf16_f32 v9, v62, v63
    v_cvt_pk_bf16_f32 v10, v64, v65
    v_cvt_pk_bf16_f32 v11, v66, v67
    ds_write_b128 v210, v[144:147] offset:0
    ds_write_b128 v214, v[8:11] offset:0
    v_pk_mul_f32 v[92:93], v[92:93], v[222:223] op_sel_hi:[1,0]
    v_pk_mul_f32 v[94:95], v[94:95], v[222:223] op_sel_hi:[1,0]
    v_pk_mul_f32 v[96:97], v[96:97], v[222:223] op_sel_hi:[1,0]
    v_pk_mul_f32 v[98:99], v[98:99], v[222:223] op_sel_hi:[1,0]
    v_cvt_pk_bf16_f32 v12, v92, v93
    v_cvt_pk_bf16_f32 v13, v94, v95
    v_cvt_pk_bf16_f32 v14, v96, v97
    v_cvt_pk_bf16_f32 v15, v98, v99
    ds_write_b128 v210, v[148:151] offset:2304
    ds_write_b128 v214, v[12:15] offset:1024
    ds_write_b64 v213, v[152:153]
    ds_write_b64 v215, v[166:167] offset:2048
    v_pk_mul_f32 v[224:225], v[60:61], v[60:61]
    v_pk_fma_f32 v[224:225], v[62:63], v[62:63], v[224:225]
    v_pk_fma_f32 v[224:225], v[64:65], v[64:65], v[224:225]
    v_pk_fma_f32 v[224:225], v[66:67], v[66:67], v[224:225]
    v_pk_mul_f32 v[226:227], v[68:69], v[68:69]
    v_pk_fma_f32 v[226:227], v[70:71], v[70:71], v[226:227]
    v_pk_fma_f32 v[226:227], v[72:73], v[72:73], v[226:227]
    v_pk_fma_f32 v[226:227], v[74:75], v[74:75], v[226:227]
    v_pk_mul_f32 v[228:229], v[92:93], v[92:93]
    v_pk_fma_f32 v[228:229], v[94:95], v[94:95], v[228:229]
    v_pk_fma_f32 v[228:229], v[96:97], v[96:97], v[228:229]
    v_pk_fma_f32 v[228:229], v[98:99], v[98:99], v[228:229]
    v_pk_mul_f32 v[230:231], v[100:101], v[100:101]
    v_pk_fma_f32 v[230:231], v[102:103], v[102:103], v[230:231]
    v_pk_fma_f32 v[230:231], v[104:105], v[104:105], v[230:231]
    v_pk_fma_f32 v[230:231], v[106:107], v[106:107], v[230:231]
    s_mov_b32 exec_hi, 0
    v_pk_fma_f32 v[224:225], v[76:77], v[76:77], v[224:225]
    v_pk_fma_f32 v[224:225], v[78:79], v[78:79], v[224:225]
    v_pk_fma_f32 v[228:229], v[108:109], v[108:109], v[228:229]
    v_pk_fma_f32 v[228:229], v[110:111], v[110:111], v[228:229]
    s_mov_b32 exec_hi, -1
    s_mov_b32 exec_lo, 0
    v_pk_fma_f32 v[226:227], v[76:77], v[76:77], v[226:227]
    v_pk_fma_f32 v[226:227], v[78:79], v[78:79], v[226:227]
    v_pk_fma_f32 v[230:231], v[108:109], v[108:109], v[230:231]
    v_pk_fma_f32 v[230:231], v[110:111], v[110:111], v[230:231]
    s_mov_b32 exec_lo, -1
    v_add_f32 v244, v224, v225
    v_add_f32 v245, v226, v227
    v_add_f32 v246, v228, v229
    v_add_f32 v247, v230, v231
    v_max3_f32 v224, abs(v80), abs(v81), abs(v112)
    v_max3_f32 v224, v224, abs(v113), abs(v82)
    v_max3_f32 v224, v224, abs(v83), abs(v84)
    v_max3_f32 v224, v224, abs(v85), abs(v86)
    v_max3_f32 v224, v224, abs(v87), abs(v114)
    v_max3_f32 v224, v224, abs(v115), abs(v116)
    v_max3_f32 v224, v224, abs(v117), abs(v118)
    v_max3_f32 v224, v224, abs(v119), abs(v119)
    v_permlane32_swap_b32 v244, v246
    v_permlane32_swap_b32 v245, v247
    s_mov_b32 exec_hi, 0
    v_max3_f32 v224, v224, abs(v88), abs(v89)
    v_max3_f32 v224, v224, abs(v90), abs(v91)
    v_max3_f32 v224, v224, abs(v120), abs(v121)
    v_max3_f32 v224, v224, abs(v122), abs(v123)
    s_mov_b32 exec_hi, -1
    v_pk_add_f32 v[244:245], v[244:245], v[246:247]
    v_cmp_gt_f32 vcc, 0x58800000, v224
    v_mov_b32 v255, 0x7f800000
    s_nop 0
    v_cndmask_b32 v245, v255, v245, vcc
    v_mov_b32 v16, v166
    v_max_u32 v244, v244, v244 row_ror:8 row_mask:0xf bank_mask:0xf
    v_max_u32 v245, v245, v245 row_ror:8 row_mask:0xf bank_mask:0xf
    v_mov_b32 v17, v167
    v_max_u32 v244, v244, v244 row_ror:4 row_mask:0xf bank_mask:0xf
    v_max_u32 v245, v245, v245 row_ror:4 row_mask:0xf bank_mask:0xf
    v_mov_b32 v22, v166
    v_max_u32 v244, v244, v244 row_ror:2 row_mask:0xf bank_mask:0xf
    v_max_u32 v245, v245, v245 row_ror:2 row_mask:0xf bank_mask:0xf
    v_mov_b32 v23, v167
    v_max_u32 v244, v244, v244 row_ror:1 row_mask:0xf bank_mask:0xf
    v_max_u32 v245, v245, v245 row_ror:1 row_mask:0xf bank_mask:0xf
    v_or_b32 v245, 1, v245
    s_mov_b32 exec_lo, 0x10001
    s_mov_b32 exec_hi, 0x10001
    ds_write_b64 v217, v[244:245]
    buffer_store_dword v245, v219, s[20:23], s79 offen sc1
    s_mov_b64 exec, -1
    v_permlane32_swap_b32 v16, v20
    v_permlane32_swap_b32 v17, v21
    v_permlane32_swap_b32 v18, v22
    v_permlane32_swap_b32 v19, v23
    s_waitcnt lgkmcnt(0)
    s_barrier
    ds_read_b64 v[244:245], v218
    s_branch Lm_48
Lm_47:
    s_cmp_eq_u32 s35, 1
    s_cbranch_scc1 Lh_87
    s_lshl_b32 s78, s68, 12
    s_mul_i32 s79, s55, 81920
    s_add_u32 s79, s79, 14286848
    s_add_u32 s79, s79, s78
    s_add_u32 m0, s78, 0
    s_add_u32 s72, s79, 0
    buffer_load_dwordx4 v4, s[20:23], s72 offen offset:0 sc1 lds
    buffer_load_dwordx4 v4, s[20:23], s72 offen offset:1024 sc1 lds
    buffer_load_dwordx4 v4, s[20:23], s72 offen offset:2048 sc1 lds
    buffer_load_dwordx4 v4, s[20:23], s72 offen offset:3072 sc1 lds
    s_add_u32 m0, s78, 16384
    s_add_u32 s72, s79, 16384
    buffer_load_dwordx4 v4, s[20:23], s72 offen offset:0 sc1 lds
    buffer_load_dwordx4 v4, s[20:23], s72 offen offset:1024 sc1 lds
    buffer_load_dwordx4 v4, s[20:23], s72 offen offset:2048 sc1 lds
    buffer_load_dwordx4 v4, s[20:23], s72 offen offset:3072 sc1 lds
    s_add_u32 m0, s78, 32768
    s_add_u32 s72, s79, 32768
    buffer_load_dwordx4 v4, s[20:23], s72 offen offset:0 sc1 lds
    buffer_load_dwordx4 v4, s[20:23], s72 offen offset:1024 sc1 lds
    buffer_load_dwordx4 v4, s[20:23], s72 offen offset:2048 sc1 lds
    buffer_load_dwordx4 v4, s[20:23], s72 offen offset:3072 sc1 lds
    s_add_u32 m0, s78, 49152
    s_add_u32 s72, s79, 49152
    buffer_load_dwordx4 v4, s[20:23], s72 offen offset:0 sc1 lds
    buffer_load_dwordx4 v4, s[20:23], s72 offen offset:1024 sc1 lds
    buffer_load_dwordx4 v4, s[20:23], s72 offen offset:2048 sc1 lds
    buffer_load_dwordx4 v4, s[20:23], s72 offen offset:3072 sc1 lds
    s_add_u32 m0, s78, 65536
    s_add_u32 s72, s79, 65536
    buffer_load_dwordx4 v4, s[20:23], s72 offen offset:0 sc1 lds
    buffer_load_dwordx4 v4, s[20:23], s72 offen offset:1024 sc1 lds
    buffer_load_dwordx4 v4, s[20:23], s72 offen offset:2048 sc1 lds
    buffer_load_dwordx4 v4, s[20:23], s72 offen offset:3072 sc1 lds
Lh_87:
    s_mov_b32 s35, 0
    s_setprio 3
    s_lshl_b32 s75, s68, 9
    s_add_u32 s75, s75, s33
    s_add_u32 s75, s75, s66
    s_add_u32 s75, s75, 32768
    s_lshl_b32 s80, s94, 1
    s_lshr_b32 s74, s68, 1
    s_add_u32 s80, s80, s74
    s_lshl_b32 s13, s80, 13
    s_mul_i32 s80, s80, 163840
    s_add_u32 s80, s80, s62
    s_and_b32 s74, s68, 1
    s_lshl_b32 s74, s74, 12
    s_add_u32 s80, s80, s74
    s_add_u32 s13, s13, s74
    s_mul_i32 s82, s57, 102400
    s_add_u32 s82, s82, 17727488
    s_add_u32 s82, s82, s78
    s_and_b32 s74, s68, 1
    s_lshl_b32 s74, s74, 1
    v_lshlrev_b32 v5, 2, v3
    v_xor_b32 v5, s74, v5
    v_xor_b32 v5, v5, v1
    v_lshlrev_b32 v8, 4, v5
    v_lshlrev_b32 v5, 7, v1
    s_mov_b32 s88, 65536
    s_mov_b64 exec, 0xf
Lp_89:
    v_mov_b32 v6, 0
    buffer_atomic_add v6, v5, s[20:23], s75 offen sc0 sc1
    s_sub_u32 s88, s88, 1
    s_cbranch_scc1 Ld_90
    s_waitcnt vmcnt(0)
    v_cmpx_gt_u32 vcc, 10, v6
    s_nop 4
    s_cbranch_execnz Lp_89
Ld_90:
    s_waitcnt vmcnt(0)
    s_mov_b64 exec, -1
    s_barrier
    s_setprio 0
    s_add_u32 m0, s78, 81920
    s_add_u32 s83, s80, 0
    buffer_load_dwordx4 v8, s[20:23], s83 offen offset:0 sc1 lds
    buffer_load_dwordx4 v8, s[20:23], s83 offen offset:1024 sc1 lds
    buffer_load_dwordx4 v8, s[20:23], s83 offen offset:2048 sc1 lds
    buffer_load_dwordx4 v8, s[20:23], s83 offen offset:3072 sc1 lds
    s_add_u32 m0, s78, 98304
    s_add_u32 s83, s80, 8192
    buffer_load_dwordx4 v8, s[20:23], s83 offen offset:0 sc1 lds
    buffer_load_dwordx4 v8, s[20:23], s83 offen offset:1024 sc1 lds
    buffer_load_dwordx4 v8, s[20:23], s83 offen offset:2048 sc1 lds
    buffer_load_dwordx4 v8, s[20:23], s83 offen offset:3072 sc1 lds
    s_add_u32 m0, s78, 114688
    s_add_u32 s83, s80, 16384
    buffer_load_dwordx4 v8, s[20:23], s83 offen offset:0 sc1 lds
    buffer_load_dwordx4 v8, s[20:23], s83 offen offset:1024 sc1 lds
    buffer_load_dwordx4 v8, s[20:23], s83 offen offset:2048 sc1 lds
    buffer_load_dwordx4 v8, s[20:23], s83 offen offset:3072 sc1 lds
    v_bfe_u32 v5, v1, 2, 2
    v_and_b32 v7, 1, v3
    v_lshrrev_b32 v6, 1, v3
    v_lshl_add_u32 v6, v6, 3, v5
    v_lshlrev_b32 v6, 8, v6
    v_lshl_add_u32 v6, v7, 12, v6
    s_lshl_b32 s74, s56, 2
    s_add_u32 s74, s74, s68
    v_lshlrev_b32 v5, 1, v5
    v_xor_b32 v5, v5, v7
    v_xor_b32 v5, s74, v5
    v_lshl_add_u32 v6, v5, 5, v6
    v_and_b32 v7, 3, v1
    v_lshl_add_u32 v6, v7, 3, v6
    s_and_b32 s74, s54, 1
    s_lshl_b32 s74, s74, 13
    v_add_u32 v13, s74, v6
    v_add_u32 v14, 81920, v13
    v_add_u32 v15, 131072, v13
    s_and_b32 s81, s55, 15
    s_lshl_b32 s15, s58, 17
    s_add_u32 s15, s15, 786432
    s_add_u32 s13, s13, s15
    s_lshl_b32 s74, s54, 13
    s_add_u32 s15, s15, s74
    s_lshl_b32 s74, s81, 9
    s_add_u32 s15, s15, s74
    v_lshlrev_b32 v9, 5, v2
    v_lshl_add_u32 v9, v3, 3, v9
    s_lshl_b32 s74, s68, 9
    v_and_b32 v5, 31, v1
    v_lshrrev_b32 v6, 5, v1
    v_lshl_add_u32 v5, v5, 1, v6
    v_lshl_add_u32 v12, v5, 3, s74
    s_waitcnt vmcnt(8) lgkmcnt(0)
    s_barrier
    s_cmp_lt_u32 s53, 20
    s_cbranch_scc1 Lh_91
    s_or_b32 s72, s58, s14
    s_cbranch_scc1 Lh_91
    s_add_u32 s72, s32, 294912
    s_cmp_lg_u32 s3, 7
    s_cbranch_scc1 Lsg_92
    v_lshlrev_b32 v5, 11, v1
    v_mov_b32 v6, 1
    s_bfm_b64 exec, 16, 0
    buffer_atomic_add v6, v5, s[20:23], s72 offen sc1
    s_mov_b64 exec, -1
Lsg_92:
Lh_91:
    s_add_u32 m0, s78, 131072
    s_add_u32 s83, s80, 24576
    buffer_load_dwordx4 v8, s[20:23], s83 offen offset:0 sc1 lds
    buffer_load_dwordx4 v8, s[20:23], s83 offen offset:1024 sc1 lds
    buffer_load_dwordx4 v8, s[20:23], s83 offen offset:2048 sc1 lds
    buffer_load_dwordx4 v8, s[20:23], s83 offen offset:3072 sc1 lds
    s_add_u32 m0, s78, 147456
    s_add_u32 s83, s80, 32768
    buffer_load_dwordx4 v8, s[20:23], s83 offen offset:0 sc1 lds
    buffer_load_dwordx4 v8, s[20:23], s83 offen offset:1024 sc1 lds
    buffer_load_dwordx4 v8, s[20:23], s83 offen offset:2048 sc1 lds
    buffer_load_dwordx4 v8, s[20:23], s83 offen offset:3072 sc1 lds
    s_cmp_eq_u32 s58, 0
    s_cbranch_scc1 Lh_93
    ds_read_b64_tr_b16 v[164:165], v14 offset:0
    ds_read_b64_tr_b16 v[166:167], v14 offset:1024
Lh_93:
    s_waitcnt vmcnt(12) lgkmcnt(0)
    s_barrier
    s_cmp_eq_u32 s58, 0
    s_cbranch_scc1 Lh_94
    ds_read_b64_tr_b16 v[168:169], v14 offset:16384
    ds_read_b64_tr_b16 v[170:171], v14 offset:17408
Lh_94:
    s_waitcnt vmcnt(8) lgkmcnt(0)
    s_barrier
    s_add_u32 m0, s78, 81920
    s_add_u32 s83, s80, 40960
    buffer_load_dwordx4 v8, s[20:23], s83 offen offset:0 sc1 lds
    buffer_load_dwordx4 v8, s[20:23], s83 offen offset:1024 sc1 lds
    buffer_load_dwordx4 v8, s[20:23], s83 offen offset:2048 sc1 lds
    buffer_load_dwordx4 v8, s[20:23], s83 offen offset:3072 sc1 lds
    s_cmp_eq_u32 s58, 0
    s_cbranch_scc1 Lh_95
    ds_read_b64_tr_b16 v[172:173], v14 offset:32768
    ds_read_b64_tr_b16 v[174:175], v14 offset:33792
Lh_95:
    s_waitcnt vmcnt(8) lgkmcnt(0)
    s_barrier
    s_add_u32 m0, s78, 98304
    s_add_u32 s83, s80, 49152
    buffer_load_dwordx4 v8, s[20:23], s83 offen offset:0 sc1 lds
    buffer_load_dwordx4 v8, s[20:23], s83 offen offset:1024 sc1 lds
    buffer_load_dwordx4 v8, s[20:23], s83 offen offset:2048 sc1 lds
    buffer_load_dwordx4 v8, s[20:23], s83 offen offset:3072 sc1 lds
    s_cmp_eq_u32 s58, 0
    s_cbranch_scc1 Lh_96
    ds_read_b64_tr_b16 v[176:177], v15 offset:0
    ds_read_b64_tr_b16 v[178:179], v15 offset:1024
Lh_96:
    s_waitcnt vmcnt(8) lgkmcnt(0)
    s_barrier
    s_add_u32 m0, s78, 114688
    s_add_u32 s83, s80, 57344
    buffer_load_dwordx4 v8, s[20:23], s83 offen offset:0 sc1 lds
    buffer_load_dwordx4 v8, s[20:23], s83 offen offset:1024 sc1 lds
    buffer_load_dwordx4 v8, s[20:23], s83 offen offset:2048 sc1 lds
    buffer_load_dwordx4 v8, s[20:23], s83 offen offset:3072 sc1 lds
    s_cmp_eq_u32 s58, 0
    s_cbranch_scc1 Lh_97
    ds_read_b64_tr_b16 v[180:181], v15 offset:16384
    ds_read_b64_tr_b16 v[182:183], v15 offset:17408
Lh_97:
    s_waitcnt vmcnt(8) lgkmcnt(0)
    s_barrier
    s_add_u32 m0, s78, 131072
    s_add_u32 s83, s80, 65536
    buffer_load_dwordx4 v8, s[20:23], s83 offen offset:0 sc1 lds
    buffer_load_dwordx4 v8, s[20:23], s83 offen offset:1024 sc1 lds
    buffer_load_dwordx4 v8, s[20:23], s83 offen offset:2048 sc1 lds
    buffer_load_dwordx4 v8, s[20:23], s83 offen offset:3072 sc1 lds
    s_cmp_eq_u32 s58, 0
    s_cbranch_scc1 Lh_98
    ds_read_b64_tr_b16 v[184:185], v14 offset:0
    ds_read_b64_tr_b16 v[186:187], v14 offset:1024
Lh_98:
    s_waitcnt vmcnt(8) lgkmcnt(0)
    s_barrier
    s_add_u32 m0, s78, 147456
    s_add_u32 s83, s80, 73728
    buffer_load_dwordx4 v8, s[20:23], s83 offen offset:0 sc1 lds
    buffer_load_dwordx4 v8, s[20:23], s83 offen offset:1024 sc1 lds
    buffer_load_dwordx4 v8, s[20:23], s83 offen offset:2048 sc1 lds
    buffer_load_dwordx4 v8, s[20:23], s83 offen offset:3072 sc1 lds
    s_cmp_eq_u32 s58, 0
    s_cbranch_scc1 Lh_99
    ds_read_b64_tr_b16 v[188:189], v14 offset:16384
    ds_read_b64_tr_b16 v[190:191], v14 offset:17408
Lh_99:
    s_waitcnt vmcnt(8) lgkmcnt(0)
    s_barrier
    s_add_u32 m0, s78, 81920
    s_add_u32 s83, s80, 81920
    buffer_load_dwordx4 v8, s[20:23], s83 offen offset:0 sc1 lds
    buffer_load_dwordx4 v8, s[20:23], s83 offen offset:1024 sc1 lds
    buffer_load_dwordx4 v8, s[20:23], s83 offen offset:2048 sc1 lds
    buffer_load_dwordx4 v8, s[20:23], s83 offen offset:3072 sc1 lds
    s_cmp_eq_u32 s58, 0
    s_cbranch_scc1 Lh_100
    ds_read_b64_tr_b16 v[192:193], v14 offset:32768
    ds_read_b64_tr_b16 v[194:195], v14 offset:33792
Lh_100:
    s_waitcnt vmcnt(8) lgkmcnt(0)
    s_barrier
    ds_read_b64 v[140:141], v9 offset:16384
    ds_read_b64 v[142:143], v9 offset:16896
    ds_read_b64 v[144:145], v9 offset:17408
    ds_read_b64 v[146:147], v9 offset:17920
    s_add_u32 m0, s78, 98304
    s_add_u32 s83, s80, 90112
    buffer_load_dwordx4 v8, s[20:23], s83 offen offset:0 sc1 lds
    buffer_load_dwordx4 v8, s[20:23], s83 offen offset:1024 sc1 lds
    buffer_load_dwordx4 v8, s[20:23], s83 offen offset:2048 sc1 lds
    buffer_load_dwordx4 v8, s[20:23], s83 offen offset:3072 sc1 lds
    s_cmp_lg_u32 s68, 0
    s_waitcnt lgkmcnt(0)
    s_cbranch_scc1 Lh_101
    v_add_f32 v140, v140, v142
    v_add_f32 v144, v144, v146
    v_add_f32 v141, v141, v143
    v_add_f32 v145, v145, v147
    v_add_f32 v140, v140, v144
    v_add_f32 v141, v141, v145
    v_or_b32 v140, 1, v140
    v_or_b32 v141, 1, v141
    buffer_store_dwordx2 v[140:141], v9, s[20:23], s15 offen sc1
Lh_101:
    s_cmp_eq_u32 s58, 0
    s_cbranch_scc1 Lh_102
    ds_read_b64_tr_b16 v[196:197], v15 offset:0
    ds_read_b64_tr_b16 v[198:199], v15 offset:1024
Lh_102:
    s_waitcnt vmcnt(8) lgkmcnt(0)
    s_barrier
    s_add_u32 m0, s78, 114688
    s_add_u32 s83, s80, 98304
    buffer_load_dwordx4 v8, s[20:23], s83 offen offset:0 sc1 lds
    buffer_load_dwordx4 v8, s[20:23], s83 offen offset:1024 sc1 lds
    buffer_load_dwordx4 v8, s[20:23], s83 offen offset:2048 sc1 lds
    buffer_load_dwordx4 v8, s[20:23], s83 offen offset:3072 sc1 lds
    s_cmp_eq_u32 s58, 0
    s_cbranch_scc1 Lh_103
    ds_read_b64_tr_b16 v[200:201], v15 offset:16384
    ds_read_b64_tr_b16 v[202:203], v15 offset:17408
Lh_103:
    s_waitcnt vmcnt(8) lgkmcnt(0)
    s_barrier
    s_add_u32 m0, s78, 131072
    s_add_u32 s83, s80, 106496
    buffer_load_dwordx4 v8, s[20:23], s83 offen offset:0 sc1 lds
    buffer_load_dwordx4 v8, s[20:23], s83 offen offset:1024 sc1 lds
    buffer_load_dwordx4 v8, s[20:23], s83 offen offset:2048 sc1 lds
    buffer_load_dwordx4 v8, s[20:23], s83 offen offset:3072 sc1 lds
    s_cmp_eq_u32 s58, 0
    s_cbranch_scc1 Lh_104
    ds_read_b64_tr_b16 v[204:205], v14 offset:0
    ds_read_b64_tr_b16 v[206:207], v14 offset:1024
Lh_104:
    s_waitcnt vmcnt(8) lgkmcnt(0)
    s_barrier
    s_add_u32 m0, s78, 147456
    s_add_u32 s83, s80, 114688
    buffer_load_dwordx4 v8, s[20:23], s83 offen offset:0 sc1 lds
    buffer_load_dwordx4 v8, s[20:23], s83 offen offset:1024 sc1 lds
    buffer_load_dwordx4 v8, s[20:23], s83 offen offset:2048 sc1 lds
    buffer_load_dwordx4 v8, s[20:23], s83 offen offset:3072 sc1 lds
    s_cmp_eq_u32 s58, 0
    s_cbranch_scc1 Lh_105
    ds_read_b64_tr_b16 v[208:209], v14 offset:16384
    ds_read_b64_tr_b16 v[210:211], v14 offset:17408
Lh_105:
    s_waitcnt vmcnt(8) lgkmcnt(0)
    s_barrier
    s_add_u32 m0, s78, 81920
    s_add_u32 s83, s80, 122880
    buffer_load_dwordx4 v8, s[20:23], s83 offen offset:0 sc1 lds
    buffer_load_dwordx4 v8, s[20:23], s83 offen offset:1024 sc1 lds
    buffer_load_dwordx4 v8, s[20:23], s83 offen offset:2048 sc1 lds
    buffer_load_dwordx4 v8, s[20:23], s83 offen offset:3072 sc1 lds
    s_cmp_eq_u32 s58, 0
    s_cbranch_scc1 Lh_106
    ds_read_b64_tr_b16 v[212:213], v14 offset:32768
    ds_read_b64_tr_b16 v[214:215], v14 offset:33792
Lh_106:
    s_waitcnt vmcnt(8) lgkmcnt(0)
    s_barrier
    s_add_u32 m0, s78, 98304
    s_add_u32 s83, s80, 131072
    buffer_load_dwordx4 v8, s[20:23], s83 offen offset:0 sc1 lds
    buffer_load_dwordx4 v8, s[20:23], s83 offen offset:1024 sc1 lds
    buffer_load_dwordx4 v8, s[20:23], s83 offen offset:2048 sc1 lds
    buffer_load_dwordx4 v8, s[20:23], s83 offen offset:3072 sc1 lds
    s_cmp_eq_u32 s58, 0
    s_cbranch_scc1 Lh_107
    ds_read_b64_tr_b16 v[216:217], v15 offset:0
    ds_read_b64_tr_b16 v[218:219], v15 offset:1024
Lh_107:
    s_waitcnt vmcnt(8) lgkmcnt(0)
    s_barrier
    s_add_u32 m0, s78, 114688
    s_add_u32 s83, s80, 139264
    buffer_load_dwordx4 v8, s[20:23], s83 offen offset:0 sc1 lds
    buffer_load_dwordx4 v8, s[20:23], s83 offen offset:1024 sc1 lds
    buffer_load_dwordx4 v8, s[20:23], s83 offen offset:2048 sc1 lds
    buffer_load_dwordx4 v8, s[20:23], s83 offen offset:3072 sc1 lds
    s_cmp_eq_u32 s58, 0
    s_cbranch_scc1 Lh_108
    ds_read_b64_tr_b16 v[220:221], v15 offset:16384
    ds_read_b64_tr_b16 v[222:223], v15 offset:17408
Lh_108:
    s_waitcnt vmcnt(8) lgkmcnt(0)
    s_barrier
    s_add_u32 m0, s78, 131072
    s_add_u32 s83, s80, 147456
    buffer_load_dwordx4 v8, s[20:23], s83 offen offset:0 sc1 lds
    buffer_load_dwordx4 v8, s[20:23], s83 offen offset:1024 sc1 lds
    buffer_load_dwordx4 v8, s[20:23], s83 offen offset:2048 sc1 lds
    buffer_load_dwordx4 v8, s[20:23], s83 offen offset:3072 sc1 lds
    buffer_load_dwordx4 v[60:63], v4, s[20:23], s13 offen offset:0 sc1
    buffer_load_dwordx4 v[64:67], v4, s[20:23], s13 offen offset:1024 sc1
    buffer_load_dwordx4 v[68:71], v4, s[20:23], s13 offen offset:2048 sc1
    buffer_load_dwordx4 v[72:75], v4, s[20:23], s13 offen offset:3072 sc1
    s_cmp_eq_u32 s58, 0
    s_cbranch_scc1 Lh_109
    ds_read_b64_tr_b16 v[224:225], v14 offset:0
    ds_read_b64_tr_b16 v[226:227], v14 offset:1024
Lh_109:
    s_waitcnt vmcnt(12) lgkmcnt(0)
    s_barrier
    s_add_u32 m0, s78, 147456
    s_add_u32 s83, s80, 155648
    buffer_load_dwordx4 v8, s[20:23], s83 offen offset:0 sc1 lds
    buffer_load_dwordx4 v8, s[20:23], s83 offen offset:1024 sc1 lds
    buffer_load_dwordx4 v8, s[20:23], s83 offen offset:2048 sc1 lds
    buffer_load_dwordx4 v8, s[20:23], s83 offen offset:3072 sc1 lds
    s_cmp_eq_u32 s58, 0
    s_cbranch_scc1 Lh_110
    ds_read_b64_tr_b16 v[228:229], v14 offset:16384
    ds_read_b64_tr_b16 v[230:231], v14 offset:17408
Lh_110:
    s_waitcnt vmcnt(12) lgkmcnt(0)
    s_barrier
    s_cmp_eq_u32 s58, 0
    s_cbranch_scc1 Lh_111
    ds_read_b64_tr_b16 v[232:233], v14 offset:32768
    ds_read_b64_tr_b16 v[234:235], v14 offset:33792
    s_add_u32 m0, s78, 0
    s_add_u32 s83, s82, 0
    buffer_load_dwordx4 v4, s[20:23], s83 offen offset:0 sc1 lds
    buffer_load_dwordx4 v4, s[20:23], s83 offen offset:1024 sc1 lds
    buffer_load_dwordx4 v4, s[20:23], s83 offen offset:2048 sc1 lds
    buffer_load_dwordx4 v4, s[20:23], s83 offen offset:3072 sc1 lds
Lh_111:
    s_cmp_lg_u32 s58, 0
    s_cbranch_scc1 Lh_112
    s_waitcnt vmcnt(4)
Lh_112:
    s_waitcnt vmcnt(8) lgkmcnt(0)
    s_barrier
    v_min3_u32 v5, v60, v61, v62
    v_min3_u32 v5, v5, v63, v64
    v_min3_u32 v5, v5, v65, v66
    v_min3_u32 v5, v5, v67, v68
    v_min3_u32 v5, v5, v69, v70
    v_min3_u32 v5, v5, v71, v72
    v_min3_u32 v5, v5, v73, v74
    v_min_u32 v5, v5, v75
    v_cmp_eq_u32 vcc, 0, v5
    s_nop 4
    s_cbranch_vccnz Lbad_113
Lok_114:
    v_add_f32 v60, v60, v68
    v_add_f32 v61, v61, v69
    v_add_f32 v62, v62, v70
    v_add_f32 v63, v63, v71
    v_add_f32 v64, v64, v72
    v_add_f32 v65, v65, v73
    v_add_f32 v66, v66, v74
    v_add_f32 v67, v67, v75
    v_add_f32 v60, v60, v64
    v_add_f32 v61, v61, v65
    v_add_f32 v62, v62, v66
    v_add_f32 v63, v63, v67
    s_nop 0
    v_permlane32_swap_b32 v60, v62
    v_permlane32_swap_b32 v61, v63
    v_add_f32 v60, v60, v62
    v_add_f32 v61, v61, v63
    ds_write_b64 v12, v[60:61] offset:32768
    s_cmp_eq_u32 s58, 0
    s_cbranch_scc1 Lh_116
    ds_read_b64_tr_b16 v[236:237], v15 offset:0
    ds_read_b64_tr_b16 v[238:239], v15 offset:1024
    s_add_u32 m0, s78, 16384
    s_add_u32 s83, s82, 16384
    buffer_load_dwordx4 v4, s[20:23], s83 offen offset:0 sc1 lds
    buffer_load_dwordx4 v4, s[20:23], s83 offen offset:1024 sc1 lds
    buffer_load_dwordx4 v4, s[20:23], s83 offen offset:2048 sc1 lds
    buffer_load_dwordx4 v4, s[20:23], s83 offen offset:3072 sc1 lds
Lh_116:
    s_cmp_lg_u32 s58, 0
    s_cbranch_scc1 Lh_117
    s_waitcnt vmcnt(0)
Lh_117:
    s_waitcnt vmcnt(8) lgkmcnt(0)
    s_barrier
    s_cmp_eq_u32 s58, 0
    s_cbranch_scc1 Lh_118
    ds_read_b64_tr_b16 v[240:241], v15 offset:16384
    ds_read_b64_tr_b16 v[242:243], v15 offset:17408
    s_add_u32 m0, s78, 49152
    s_add_u32 s83, s82, 49152
    buffer_load_dwordx4 v4, s[20:23], s83 offen offset:0 sc1 lds
    buffer_load_dwordx4 v4, s[20:23], s83 offen offset:1024 sc1 lds
    buffer_load_dwordx4 v4, s[20:23], s83 offen offset:2048 sc1 lds
    buffer_load_dwordx4 v4, s[20:23], s83 offen offset:3072 sc1 lds
Lh_118:
    s_waitcnt lgkmcnt(0)
    s_barrier
    s_mul_i32 s72, s69, 10240
    s_add_u32 s72, s72, 102400
    v_add_u32 v25, s72, v4
    v_and_b32 v5, 31, v1
    v_lshrrev_b32 v6, 5, v1
    v_cmp_ne_u32 vcc, 20, v5
    v_mul_u32_u24 v6, 20, v6
    v_add_lshl_u32 v5, v5, v6, 4
    s_add_u32 s72, s72, 1024
    v_add_u32 v27, s72, v5
    v_mov_b32 v6, 0
    v_mov_b32 v255, 0x3f803f80
    v_cndmask_b32 v124, v255, v6, vcc
    v_mov_b32 v125, v124
    v_mov_b32 v126, v124
    v_mov_b32 v127, v124
    v_mov_b32 v128, v124
    v_mov_b32 v129, v124
    v_mov_b32 v130, v124
    v_mov_b32 v131, v124
    v_mov_b32 v132, v124
    v_mov_b32 v133, v124
    v_mov_b32 v134, v124
    v_mov_b32 v135, v124
    v_mov_b32 v136, v124
    v_mov_b32 v137, v124
    v_mov_b32 v138, v124
    v_mov_b32 v139, v124
    s_mov_b32 s4, 0xfffff
    s_mov_b32 s5, 0xfffff
    s_add_u32 s72, s72, 8192
    v_lshl_add_u32 v26, v1, 3, s72
    v_mov_b32 v24, 0xdddd
    s_mul_i32 s85, s3, 2560
    s_mul_i32 s86, s55, 163840
    s_add_u32 s86, s86, s63
    s_add_u32 s86, s86, s85
    s_add_u32 s85, s85, 102400
    v_mov_b32 v18, 0
    v_mov_b32 v19, 0
    v_mov_b32 v20, 0
    v_mov_b32 v21, 0
    v_mov_b32 v28, 0
    v_mov_b32 v29, 0
    v_mov_b32 v30, 0
    v_mov_b32 v31, 0
    v_mov_b32 v32, 0
    v_mov_b32 v33, 0
    v_mov_b32 v34, 0
    v_mov_b32 v35, 0
    v_mov_b32 v36, 0
    v_mov_b32 v37, 0
    v_mov_b32 v38, 0
    v_mov_b32 v39, 0
    v_mov_b32 v40, 0
    v_mov_b32 v41, 0
    v_mov_b32 v42, 0
    v_mov_b32 v43, 0
    v_mov_b32 v44, 0
    v_mov_b32 v45, 0
    v_mov_b32 v46, 0
    v_mov_b32 v47, 0
    v_mov_b32 v48, 0
    v_mov_b32 v49, 0
    v_mov_b32 v50, 0
    v_mov_b32 v51, 0
    v_mov_b32 v52, 0
    v_mov_b32 v53, 0
    v_mov_b32 v54, 0
    v_mov_b32 v55, 0
    v_mov_b32 v56, 0
    v_mov_b32 v57, 0
    v_mov_b32 v58, 0
    v_mov_b32 v59, 0
    s_mul_i32 s72, s68, 3072
    s_add_u32 s72, s72, 102400
    s_mul_i32 s73, s69, 20480
    s_add_u32 s74, s72, s73
    v_add_u32 v248, s74, v4
    s_sub_u32 s74, s72, s73
    s_add_u32 s74, s74, 20480
    v_add_u32 v249, s74, v4
    s_lshl_b32 s72, s94, 1
    s_lshr_b32 s73, s68, 1
    s_add_u32 s72, s72, s73
    s_lshl_b32 s72, s72, 5
    s_add_u32 s72, s72, s55
    s_and_b32 s73, s68, 1
    s_lshl_b32 s73, s73, 1
    s_add_u32 s73, s73, 1
    s_sub_u32 s73, s73, s69
    s_lshl_b32 s18, s72, 12
    s_lshl_b32 s74, s73, 9
    s_add_u32 s18, s18, s74
    s_add_u32 s18, s18, s64
    s_lshl_b32 s19, s72, 10
    s_lshl_b32 s74, s73, 8
    s_add_u32 s19, s19, s74
    s_add_u32 s19, s19, s64
    s_add_u32 s19, s19, 2097152
    v_lshrrev_b32 v5, 5, v1
    v_mul_u32_u24 v5, 1536, v5
    v_add_u32 v250, v5, v4
    v_lshlrev_b32 v251, 3, v1
    s_mul_i32 s0, s54, 163840
    s_mul_i32 s72, s57, 20480
    s_add_u32 s0, s0, s72
    s_lshl_b32 s72, s56, 7
    s_add_u32 s0, s0, s72
    s_add_u32 s0, s0, 6291456
    s_mul_i32 s1, s3, 327680
    s_mul_i32 s72, s52, 20
    s_add_u32 s72, s72, s53
    s_lshl_b32 s72, s72, 10
    s_add_u32 s1, s1, s72
    s_add_u32 s1, s1, 8912896
    s_cmp_ge_u32 s53, 20
    s_cselect_b32 s1, s22, s1
    s_mul_i32 s72, s68, 2560
    s_add_u32 s72, s72, 102400
    v_add_u32 v5, s72, v4
    v_xor_b32 v6, 32, v1
    v_lshl_add_u32 v6, v6, 3, s72
    s_barrier
    ds_read_b128 v[8:11], v5 offset:1024
    ds_read_b128 v[12:15], v5
    ds_read_b64 v[6:7], v6 offset:2048
    v_lshlrev_b32 v5, 3, v2
    v_add_u32 v5, 112640, v5
    ds_read_b64 v[244:245], v5
    s_waitcnt lgkmcnt(1)
    v_mov_b32 v16, v6
    v_mov_b32 v17, v7
    v_mov_b32 v22, v6
    v_mov_b32 v23, v7
    v_permlane32_swap_b32 v16, v20
    v_permlane32_swap_b32 v17, v21
    v_permlane32_swap_b32 v18, v22
    v_permlane32_swap_b32 v19, v23
Lm_48:
    s_lshl_b32 s11, s55, 10
    s_add_u32 s11, s11, s66
    s_add_u32 s11, s11, 65536
    s_lshl_b32 s12, s94, 7
    s_add_u32 s12, s12, s11
    s_mul_i32 s8, s3, 12800
    s_mov_b32 s9, 18546688
    s_cmp_eq_u32 s58, 0
    s_cselect_b32 s9, 16908288, s9
    s_mul_i32 s72, s57, 102400
    s_add_u32 s9, s9, s72
    s_add_u32 s9, s9, s8
    ds_read_b128 v[108:111], v25 offset:20480
    ds_read_b64 v[116:117], v26 offset:20480
    s_mov_b64 exec, s[4:5]
    ds_read_b128 v[124:127], v27 offset:20480
    ds_read_b128 v[128:131], v27 offset:21120
    s_mov_b64 exec, -1
    s_waitcnt lgkmcnt(2)
    v_mfma_f32_32x32x16_bf16 v[60:75], v[108:111], v[8:11], 0
    v_mfma_f32_32x32x8_bf16 v[60:75], v[116:117], v[16:17], v[60:75]
    s_waitcnt lgkmcnt(0)
    v_cmp_lt_u32 vcc, 0x7f800000, v244
    s_nop 4
    s_cbranch_vccnz Lredo_130
Lredo_131:
    v_mfma_f32_32x32x16_bf16 v[76:91], v[108:111], v[12:15], 0
    s_nop 2
    v_exp_f32 v60, v60
    v_exp_f32 v61, v61
    v_exp_f32 v62, v62
    v_exp_f32 v63, v63
    v_mfma_f32_32x32x8_bf16 v[76:91], v[116:117], v[20:21], v[76:91]
    ds_read_b128 v[112:115], v25 offset:22784
    v_exp_f32 v64, v64
    v_exp_f32 v65, v65
    v_exp_f32 v66, v66
    v_exp_f32 v67, v67
    s_mov_b64 exec, s[4:5]
    ds_read_b128 v[132:135], v27 offset:22784
    ds_read_b128 v[136:139], v27 offset:23424
    s_mov_b64 exec, -1
    v_exp_f32 v68, v68
    v_exp_f32 v69, v69
    v_exp_f32 v70, v70
    v_exp_f32 v71, v71
    v_smfmac_f32_32x32x32_bf16 v[28:43], v[124:127], v[60:67], v24
    s_waitcnt lgkmcnt(2)
    v_exp_f32 v72, v72
    v_exp_f32 v73, v73
    v_exp_f32 v74, v74
    v_exp_f32 v75, v75
    v_mfma_f32_32x32x16_bf16 v[92:107], v[112:115], v[8:11], 0
    s_cmp_lg_u32 s69, 0
    s_cbranch_scc1 La_134
    s_waitcnt vmcnt(1)
    s_cmp_eq_u32 s14, 0
    s_cbranch_scc1 La_134
    s_waitcnt vmcnt(0)
La_134:
    s_barrier
    s_cmp_lg_u32 s3, 4
    s_cbranch_scc1 Lsg_135
    v_lshlrev_b32 v5, 7, v1
    v_mov_b32 v6, 1
    s_bfm_b64 exec, 8, 0
    buffer_atomic_add v6, v5, s[20:23], s11 offen sc1
    s_mov_b64 exec, -1
Lsg_135:
    s_cmp_eq_u32 s69, 0
    s_cbranch_scc1 La_136
    s_cmp_lg_u32 s58, 0
    s_cbranch_scc1 La_137
    s_lshl_b32 s76, s68, 9
    s_add_u32 s76, s76, s33
    s_add_u32 s76, s76, 294912
    v_lshlrev_b32 v5, 7, v1
    v_mov_b32 v143, 0
    s_mov_b64 exec, 15
    buffer_atomic_add v143, v5, s[20:23], s76 offen sc0 sc1
    s_mov_b64 exec, -1
    s_branch La_136
La_137:
    s_add_u32 m0, s78, 32768
    s_add_u32 s83, s82, 32768
    buffer_load_dwordx4 v4, s[20:23], s83 offen offset:0 sc1 lds
    buffer_load_dwordx4 v4, s[20:23], s83 offen offset:1024 sc1 lds
    buffer_load_dwordx4 v4, s[20:23], s83 offen offset:2048 sc1 lds
    buffer_load_dwordx4 v4, s[20:23], s83 offen offset:3072 sc1 lds
    s_add_u32 m0, s78, 65536
    s_add_u32 s83, s82, 65536
    buffer_load_dwordx4 v4, s[20:23], s83 offen offset:0 sc1 lds
    buffer_load_dwordx4 v4, s[20:23], s83 offen offset:1024 sc1 lds
    buffer_load_dwordx4 v4, s[20:23], s83 offen offset:2048 sc1 lds
    buffer_load_dwordx4 v4, s[20:23], s83 offen offset:3072 sc1 lds
    s_add_u32 m0, s78, 81920
    s_add_u32 s83, s82, 81920
    buffer_load_dwordx4 v4, s[20:23], s83 offen offset:0 sc1 lds
    buffer_load_dwordx4 v4, s[20:23], s83 offen offset:1024 sc1 lds
    buffer_load_dwordx4 v4, s[20:23], s83 offen offset:2048 sc1 lds
    buffer_load_dwordx4 v4, s[20:23], s83 offen offset:3072 sc1 lds
    s_lshl_b32 s74, s68, 10
    s_add_u32 m0, s74, 98304
    s_sub_u32 s83, s82, s78
    s_add_u32 s83, s83, m0
    buffer_load_dwordx4 v4, s[20:23], s83 offen sc1 lds
La_136:
    v_exp_f32 v76, v76
    v_exp_f32 v77, v77
    v_exp_f32 v78, v78
    v_exp_f32 v79, v79
    v_mfma_f32_32x32x8_bf16 v[92:107], v[116:117], v[18:19], v[92:107]
    v_exp_f32 v80, v80
    v_exp_f32 v81, v81
    v_exp_f32 v82, v82
    v_exp_f32 v83, v83
    v_smfmac_f32_32x32x32_bf16 v[28:43], v[128:131], v[68:75], v24
    v_exp_f32 v84, v84
    v_exp_f32 v85, v85
    v_exp_f32 v86, v86
    v_exp_f32 v87, v87
    v_smfmac_f32_32x32x32_bf16 v[44:59], v[124:127], v[76:83], v24
    s_waitcnt lgkmcnt(0)
    v_exp_f32 v88, v88
    v_exp_f32 v89, v89
    v_exp_f32 v90, v90
    v_exp_f32 v91, v91
    v_mfma_f32_32x32x16_bf16 v[60:75], v[112:115], v[12:15], 0
    v_exp_f32 v92, v92
    v_exp_f32 v93, v93
    v_exp_f32 v94, v94
    v_exp_f32 v95, v95
    v_mfma_f32_32x32x8_bf16 v[60:75], v[116:117], v[22:23], v[60:75]
    ds_read_b128 v[108:111], v25 offset:25088
    ds_read_b64 v[118:119], v26 offset:20992
    v_exp_f32 v96, v96
    v_exp_f32 v97, v97
    v_exp_f32 v98, v98
    v_exp_f32 v99, v99
    v_smfmac_f32_32x32x32_bf16 v[44:59], v[128:131], v[84:91], v24
    s_mov_b64 exec, s[4:5]
    ds_read_b128 v[124:127], v27 offset:25088
    ds_read_b128 v[128:131], v27 offset:25728
    s_mov_b64 exec, -1
    v_exp_f32 v100, v100
    v_exp_f32 v101, v101
    v_exp_f32 v102, v102
    v_exp_f32 v103, v103
    v_smfmac_f32_32x32x32_bf16 v[28:43], v[132:135], v[92:99], v24
    s_waitcnt lgkmcnt(2)
    v_exp_f32 v104, v104
    v_exp_f32 v105, v105
    v_exp_f32 v106, v106
    v_exp_f32 v107, v107
    v_mfma_f32_32x32x16_bf16 v[76:91], v[108:111], v[8:11], 0
    v_exp_f32 v60, v60
    v_exp_f32 v61, v61
    v_exp_f32 v62, v62
    v_exp_f32 v63, v63
    v_mfma_f32_32x32x8_bf16 v[76:91], v[118:119], v[16:17], v[76:91]
    v_exp_f32 v64, v64
    v_exp_f32 v65, v65
    v_exp_f32 v66, v66
    v_exp_f32 v67, v67
    v_smfmac_f32_32x32x32_bf16 v[28:43], v[136:139], v[100:107], v24
    v_exp_f32 v68, v68
    v_exp_f32 v69, v69
    v_exp_f32 v70, v70
    v_exp_f32 v71, v71
    v_smfmac_f32_32x32x32_bf16 v[44:59], v[132:135], v[60:67], v24
    s_waitcnt lgkmcnt(0)
    v_exp_f32 v72, v72
    v_exp_f32 v73, v73
    v_exp_f32 v74, v74
    v_exp_f32 v75, v75
    v_mfma_f32_32x32x16_bf16 v[92:107], v[108:111], v[12:15], 0
    v_exp_f32 v76, v76
    v_exp_f32 v77, v77
    v_exp_f32 v78, v78
    v_exp_f32 v79, v79
    v_mfma_f32_32x32x8_bf16 v[92:107], v[118:119], v[20:21], v[92:107]
    ds_read_b128 v[112:115], v25 offset:27392
    v_exp_f32 v80, v80
    v_exp_f32 v81, v81
    v_exp_f32 v82, v82
    v_exp_f32 v83, v83
    v_smfmac_f32_32x32x32_bf16 v[44:59], v[136:139], v[68:75], v24
    s_mov_b64 exec, s[4:5]
    ds_read_b128 v[132:135], v27 offset:27392
    ds_read_b128 v[136:139], v27 offset:28032
    s_mov_b64 exec, -1
    v_exp_f32 v84, v84
    v_exp_f32 v85, v85
    v_exp_f32 v86, v86
    v_exp_f32 v87, v87
    v_smfmac_f32_32x32x32_bf16 v[28:43], v[124:127], v[76:83], v24
    s_waitcnt lgkmcnt(2)
    v_exp_f32 v88, v88
    v_exp_f32 v89, v89
    v_exp_f32 v90, v90
    v_exp_f32 v91, v91
    v_mfma_f32_32x32x16_bf16 v[60:75], v[112:115], v[8:11], 0
    s_or_b32 s72, s69, s58
    s_cbranch_scc1 La_138
    v_bfe_u32 v5, v1, 2, 3
    v_and_b32 v6, 3, v1
    v_lshlrev_b32 v6, 4, v6
    v_lshl_add_u32 v245, v5, 7, v6
    s_lshl_b32 s76, s55, 10
    s_lshl_b32 s75, s58, 15
    s_add_u32 s76, s76, s75
    s_add_u32 s76, s76, 360448
    s_mul_i32 s72, s68, 2560
    s_add_u32 s73, s85, s72
    s_add_u32 s74, s86, s72
    s_movk_i32 s75, 2560
    s_or_b32 s80, s94, 1
    s_add_u32 s80, s80, 1
    s_and_b32 s80, s80, 7
    s_mul_i32 s81, s80, 20480
    s_add_u32 s77, s81, s74
    s_or_b32 s80, s94, 1
    s_add_u32 s80, s80, 2
    s_and_b32 s80, s80, 7
    s_mul_i32 s81, s80, 20480
    s_add_u32 s78, s81, s74
    s_add_u32 m0, s73, 40960
    v_lshlrev_b32 v5, 7, v1
    s_mov_b32 s88, 65536
    s_mov_b64 exec, 0x1
Lp_140:
    v_mov_b32 v6, 0
    buffer_atomic_add v6, v5, s[20:23], s12 offen sc0 sc1
    s_sub_u32 s88, s88, 1
    s_cbranch_scc1 Ld_141
    s_waitcnt vmcnt(0)
    v_cmpx_gt_u32 vcc, 8, v6
    s_nop 4
    s_cbranch_execnz Lp_140
Ld_141:
    s_waitcnt vmcnt(0)
    s_mov_b64 exec, -1
    s_cmp_lg_u32 s3, 0
    s_cbranch_scc1 La_139
    buffer_load_dwordx4 v[140:143], v245, s[20:23], s76 offen sc1
La_139:
    buffer_load_dwordx4 v4, s[20:23], s77 offen offset:0 sc1 lds
    buffer_load_dwordx4 v4, s[20:23], s77 offen offset:1024 sc1 lds
    buffer_load_dwordx4 v4, s[20:23], s77 offen offset:2048 sc1 lds
    buffer_load_dwordx4 v4, s[20:23], s77 offen offset:3072 sc1 lds
    s_add_u32 m0, m0, 4096
    s_add_u32 s81, s77, 4096
    buffer_load_dwordx4 v4, s[20:23], s81 offen sc1 lds
    s_add_u32 m0, s73, 0
    s_nop 0
    buffer_load_dwordx4 v4, s[20:23], s78 offen offset:0 sc1 lds
    buffer_load_dwordx4 v4, s[20:23], s78 offen offset:1024 sc1 lds
    buffer_load_dwordx4 v4, s[20:23], s78 offen offset:2048 sc1 lds
    buffer_load_dwordx4 v4, s[20:23], s78 offen offset:3072 sc1 lds
    s_add_u32 m0, m0, 4096
    s_add_u32 s81, s78, 4096
    buffer_load_dwordx4 v4, s[20:23], s81 offen sc1 lds
La_138:
    v_exp_f32 v92, v92
    v_exp_f32 v93, v93
    v_exp_f32 v94, v94
    v_exp_f32 v95, v95
    v_mfma_f32_32x32x8_bf16 v[60:75], v[118:119], v[18:19], v[60:75]
    v_exp_f32 v96, v96
    v_exp_f32 v97, v97
    v_exp_f32 v98, v98
    v_exp_f32 v99, v99
    v_smfmac_f32_32x32x32_bf16 v[28:43], v[128:131], v[84:91], v24
    v_exp_f32 v100, v100
    v_exp_f32 v101, v101
    v_exp_f32 v102, v102
    v_exp_f32 v103, v103
    v_smfmac_f32_32x32x32_bf16 v[44:59], v[124:127], v[92:99], v24
    s_waitcnt lgkmcnt(0)
    v_exp_f32 v104, v104
    v_exp_f32 v105, v105
    v_exp_f32 v106, v106
    v_exp_f32 v107, v107
    v_mfma_f32_32x32x16_bf16 v[76:91], v[112:115], v[12:15], 0
    s_cmp_eq_u32 s58, 0
    s_cbranch_scc1 La_143
    s_cmp_eq_u32 s69, 0
    s_cbranch_scc1 La_142
    s_waitcnt vmcnt(0)
    s_barrier
    s_branch La_143
La_142:
    s_barrier
    v_bfe_u32 v5, v1, 2, 3
    v_and_b32 v6, 3, v1
    v_lshlrev_b32 v6, 4, v6
    v_lshl_add_u32 v245, v5, 7, v6
    s_lshl_b32 s76, s55, 10
    s_lshl_b32 s75, s58, 15
    s_add_u32 s76, s76, s75
    s_add_u32 s76, s76, 360448
    s_mul_i32 s72, s68, 2560
    s_add_u32 s73, s85, s72
    s_add_u32 s74, s86, s72
    s_movk_i32 s75, 2560
    s_or_b32 s80, s94, 1
    s_add_u32 s80, s80, 1
    s_and_b32 s80, s80, 7
    s_mul_i32 s81, s80, 20480
    s_add_u32 s77, s81, s74
    s_or_b32 s80, s94, 1
    s_add_u32 s80, s80, 2
    s_and_b32 s80, s80, 7
    s_mul_i32 s81, s80, 20480
    s_add_u32 s78, s81, s74
    s_add_u32 m0, s73, 40960
    v_lshlrev_b32 v5, 7, v1
    s_mov_b32 s88, 65536
    s_mov_b64 exec, 0x1
Lp_145:
    v_mov_b32 v6, 0
    buffer_atomic_add v6, v5, s[20:23], s12 offen sc0 sc1
    s_sub_u32 s88, s88, 1
    s_cbranch_scc1 Ld_146
    s_waitcnt vmcnt(0)
    v_cmpx_gt_u32 vcc, 8, v6
    s_nop 4
    s_cbranch_execnz Lp_145
Ld_146:
    s_waitcnt vmcnt(0)
    s_mov_b64 exec, -1
    s_cmp_lg_u32 s3, 0
    s_cbranch_scc1 La_144
    buffer_load_dwordx4 v[140:143], v245, s[20:23], s76 offen sc1
La_144:
    buffer_load_dwordx4 v4, s[20:23], s77 offen offset:0 sc1 lds
    buffer_load_dwordx4 v4, s[20:23], s77 offen offset:1024 sc1 lds
    buffer_load_dwordx4 v4, s[20:23], s77 offen offset:2048 sc1 lds
    buffer_load_dwordx4 v4, s[20:23], s77 offen offset:3072 sc1 lds
    s_add_u32 m0, m0, 4096
    s_add_u32 s81, s77, 4096
    buffer_load_dwordx4 v4, s[20:23], s81 offen sc1 lds
    s_add_u32 m0, s73, 0
    s_nop 0
    buffer_load_dwordx4 v4, s[20:23], s78 offen offset:0 sc1 lds
    buffer_load_dwordx4 v4, s[20:23], s78 offen offset:1024 sc1 lds
    buffer_load_dwordx4 v4, s[20:23], s78 offen offset:2048 sc1 lds
    buffer_load_dwordx4 v4, s[20:23], s78 offen offset:3072 sc1 lds
    s_add_u32 m0, m0, 4096
    s_add_u32 s81, s78, 4096
    buffer_load_dwordx4 v4, s[20:23], s81 offen sc1 lds
La_143:
    v_exp_f32 v60, v60
    v_exp_f32 v61, v61
    v_exp_f32 v62, v62
    v_exp_f32 v63, v63
    v_mfma_f32_32x32x8_bf16 v[76:91], v[118:119], v[22:23], v[76:91]
    v_exp_f32 v64, v64
    v_exp_f32 v65, v65
    v_exp_f32 v66, v66
    v_exp_f32 v67, v67
    v_smfmac_f32_32x32x32_bf16 v[44:59], v[128:131], v[100:107], v24
    v_exp_f32 v68, v68
    v_exp_f32 v69, v69
    v_exp_f32 v70, v70
    v_exp_f32 v71, v71
    v_smfmac_f32_32x32x32_bf16 v[28:43], v[132:135], v[60:67], v24
    v_exp_f32 v72, v72
    v_exp_f32 v73, v73
    v_exp_f32 v74, v74
    v_exp_f32 v75, v75
    v_exp_f32 v76, v76
    v_exp_f32 v77, v77
    v_exp_f32 v78, v78
    v_exp_f32 v79, v79
    v_exp_f32 v80, v80
    v_exp_f32 v81, v81
    v_exp_f32 v82, v82
    v_exp_f32 v83, v83
    v_smfmac_f32_32x32x32_bf16 v[28:43], v[136:139], v[68:75], v24
    v_exp_f32 v84, v84
    v_exp_f32 v85, v85
    v_exp_f32 v86, v86
    v_exp_f32 v87, v87
    v_smfmac_f32_32x32x32_bf16 v[44:59], v[132:135], v[76:83], v24
    v_exp_f32 v88, v88
    v_exp_f32 v89, v89
    v_exp_f32 v90, v90
    v_exp_f32 v91, v91
    s_nop 1
    v_smfmac_f32_32x32x32_bf16 v[44:59], v[136:139], v[84:91], v24
    s_cmp_lg_u32 s69, 0
    s_cbranch_scc1 La_122
    s_cmp_lg_u32 s58, 0
    s_cbranch_scc1 La_121
    s_barrier
La_121:
    v_max_u32 v244, v244, v244 row_ror:8 row_mask:0xf bank_mask:0xf
    s_nop 1
    v_max_u32 v244, v244, v244 row_ror:4 row_mask:0xf bank_mask:0xf
    s_nop 1
    v_max_u32 v244, v244, v244 row_ror:2 row_mask:0xf bank_mask:0xf
    s_nop 1
    v_max_u32 v244, v244, v244 row_ror:1 row_mask:0xf bank_mask:0xf
    s_mov_b32 s88, 65536
    s_cmp_lg_u32 s3, 0
    s_cbranch_scc1 La_126
    s_waitcnt vmcnt(10)
    v_min3_u32 v7, v140, v141, v142
    v_min_u32 v7, v7, v143
    v_cmp_eq_u32 vcc, 0, v7
    s_nop 4
    s_cbranch_vccnz Lbad_147
Lok_148:
    v_max3_u32 v7, v140, v141, v142
    v_max_u32 v7, v7, v143
    v_mul_f32 v7, v7, v244
    v_cmp_nge_f32 vcc, 0x45610000, v7
    s_nop 0
    s_or_b32 s72, vcc_lo, vcc_hi
    v_mov_b32 v5, 122880
    v_mov_b32 v6, s72
    v_mad_u32_u24 v5, v1, s75, v5
    s_mov_b64 exec, 0xff
    ds_write_b32 v5, v6
    s_mov_b64 exec, -1
La_126:
    s_waitcnt vmcnt(5)
    s_branch La_124
La_122:
    s_cmp_lg_u32 s58, 0
    s_waitcnt vmcnt(0)
    s_cbranch_scc1 La_125
    s_mov_b64 exec, 15
    v_cmp_gt_u32 vcc, 6, v143
    s_mov_b64 exec, -1
    s_nop 3
    s_cbranch_vccz La_149
    v_lshlrev_b32 v5, 7, v1
    s_mov_b32 s88, 65536
    s_mov_b64 exec, 0xf
Lp_150:
    v_mov_b32 v6, 0
    buffer_atomic_add v6, v5, s[20:23], s76 offen sc0 sc1
    s_sub_u32 s88, s88, 1
    s_cbranch_scc1 Ld_151
    s_waitcnt vmcnt(0)
    v_cmpx_gt_u32 vcc, 6, v6
    s_nop 4
    s_cbranch_execnz Lp_150
Ld_151:
    s_waitcnt vmcnt(0)
    s_mov_b64 exec, -1
La_149:
    s_barrier
    s_branch La_124
La_125:
    v_add_u32 v6, 0, v4
    v_add_u32 v7, 61440, v4
    ds_read_b128 v[60:63], v6 offset:0
    ds_read_b128 v[64:67], v6 offset:1024
    ds_read_b128 v[68:71], v6 offset:2048
    ds_read_b128 v[72:75], v6 offset:3072
    ds_read_b128 v[76:79], v6 offset:4096
    ds_read_b128 v[80:83], v6 offset:5120
    ds_read_b128 v[84:87], v6 offset:6144
    ds_read_b128 v[88:91], v6 offset:7168
    ds_read_b128 v[92:95], v6 offset:8192
    ds_read_b128 v[96:99], v6 offset:9216
    s_waitcnt lgkmcnt(5)
    v_mfma_f32_16x16x32_bf16 v[144:147], v[60:63], v[164:167], 0
    ds_read_b128 v[100:103], v6 offset:10240
    v_mfma_f32_16x16x32_bf16 v[148:151], v[64:67], v[164:167], 0
    ds_read_b128 v[104:107], v6 offset:11264
    v_mfma_f32_16x16x32_bf16 v[152:155], v[68:71], v[164:167], 0
    ds_read_b128 v[108:111], v6 offset:12288
    v_mfma_f32_16x16x32_bf16 v[156:159], v[72:75], v[164:167], 0
    ds_read_b128 v[112:115], v6 offset:13312
    v_mfma_f32_16x16x32_bf16 v[160:163], v[76:79], v[164:167], 0
    ds_read_b128 v[116:119], v6 offset:14336
    s_waitcnt lgkmcnt(5)
    v_mfma_f32_16x16x32_bf16 v[144:147], v[80:83], v[168:171], v[144:147]
    ds_read_b128 v[60:63], v6 offset:15360
    v_mfma_f32_16x16x32_bf16 v[148:151], v[84:87], v[168:171], v[148:151]
    ds_read_b128 v[64:67], v6 offset:16384
    v_mfma_f32_16x16x32_bf16 v[152:155], v[88:91], v[168:171], v[152:155]
    ds_read_b128 v[68:71], v6 offset:17408
    v_mfma_f32_16x16x32_bf16 v[156:159], v[92:95], v[168:171], v[156:159]
    ds_read_b128 v[72:75], v6 offset:18432
    v_mfma_f32_16x16x32_bf16 v[160:163], v[96:99], v[168:171], v[160:163]
    ds_read_b128 v[76:79], v6 offset:19456
    s_waitcnt lgkmcnt(5)
    v_mfma_f32_16x16x32_bf16 v[144:147], v[100:103], v[172:175], v[144:147]
    ds_read_b128 v[80:83], v6 offset:20480
    v_mfma_f32_16x16x32_bf16 v[148:151], v[104:107], v[172:175], v[148:151]
    ds_read_b128 v[84:87], v6 offset:21504
    v_mfma_f32_16x16x32_bf16 v[152:155], v[108:111], v[172:175], v[152:155]
    ds_read_b128 v[88:91], v6 offset:22528
    v_mfma_f32_16x16x32_bf16 v[156:159], v[112:115], v[172:175], v[156:159]
    ds_read_b128 v[92:95], v6 offset:23552
    v_mfma_f32_16x16x32_bf16 v[160:163], v[116:119], v[172:175], v[160:163]
    ds_read_b128 v[96:99], v6 offset:24576
    s_waitcnt lgkmcnt(5)
    v_mfma_f32_16x16x32_bf16 v[144:147], v[60:63], v[176:179], v[144:147]
    ds_read_b128 v[100:103], v6 offset:25600
    v_mfma_f32_16x16x32_bf16 v[148:151], v[64:67], v[176:179], v[148:151]
    ds_read_b128 v[104:107], v6 offset:26624
    v_mfma_f32_16x16x32_bf16 v[152:155], v[68:71], v[176:179], v[152:155]
    ds_read_b128 v[108:111], v6 offset:27648
    v_mfma_f32_16x16x32_bf16 v[156:159], v[72:75], v[176:179], v[156:159]
    ds_read_b128 v[112:115], v6 offset:28672
    v_mfma_f32_16x16x32_bf16 v[160:163], v[76:79], v[176:179], v[160:163]
    ds_read_b128 v[116:119], v6 offset:29696
    s_waitcnt lgkmcnt(5)
    v_mfma_f32_16x16x32_bf16 v[144:147], v[80:83], v[180:183], v[144:147]
    ds_read_b128 v[60:63], v6 offset:30720
    v_mfma_f32_16x16x32_bf16 v[148:151], v[84:87], v[180:183], v[148:151]
    ds_read_b128 v[64:67], v6 offset:31744
    v_mfma_f32_16x16x32_bf16 v[152:155], v[88:91], v[180:183], v[152:155]
    ds_read_b128 v[68:71], v6 offset:32768
    v_mfma_f32_16x16x32_bf16 v[156:159], v[92:95], v[180:183], v[156:159]
    ds_read_b128 v[72:75], v6 offset:33792
    v_mfma_f32_16x16x32_bf16 v[160:163], v[96:99], v[180:183], v[160:163]
    ds_read_b128 v[76:79], v6 offset:34816
    s_waitcnt lgkmcnt(5)
    v_mfma_f32_16x16x32_bf16 v[144:147], v[100:103], v[184:187], v[144:147]
    ds_read_b128 v[80:83], v6 offset:35840
    v_mfma_f32_16x16x32_bf16 v[148:151], v[104:107], v[184:187], v[148:151]
    ds_read_b128 v[84:87], v6 offset:36864
    v_mfma_f32_16x16x32_bf16 v[152:155], v[108:111], v[184:187], v[152:155]
    ds_read_b128 v[88:91], v6 offset:37888
    v_mfma_f32_16x16x32_bf16 v[156:159], v[112:115], v[184:187], v[156:159]
    ds_read_b128 v[92:95], v6 offset:38912
    v_mfma_f32_16x16x32_bf16 v[160:163], v[116:119], v[184:187], v[160:163]
    ds_read_b128 v[96:99], v6 offset:39936
    s_waitcnt lgkmcnt(5)
    v_mfma_f32_16x16x32_bf16 v[144:147], v[60:63], v[188:191], v[144:147]
    ds_read_b128 v[100:103], v6 offset:40960
    v_mfma_f32_16x16x32_bf16 v[148:151], v[64:67], v[188:191], v[148:151]
    ds_read_b128 v[104:107], v6 offset:41984
    v_mfma_f32_16x16x32_bf16 v[152:155], v[68:71], v[188:191], v[152:155]
    ds_read_b128 v[108:111], v6 offset:43008
    v_mfma_f32_16x16x32_bf16 v[156:159], v[72:75], v[188:191], v[156:159]
    ds_read_b128 v[112:115], v6 offset:44032
    v_mfma_f32_16x16x32_bf16 v[160:163], v[76:79], v[188:191], v[160:163]
    ds_read_b128 v[116:119], v6 offset:45056
    s_waitcnt lgkmcnt(5)
    v_mfma_f32_16x16x32_bf16 v[144:147], v[80:83], v[192:195], v[144:147]
    ds_read_b128 v[60:63], v6 offset:46080
    v_mfma_f32_16x16x32_bf16 v[148:151], v[84:87], v[192:195], v[148:151]
    ds_read_b128 v[64:67], v6 offset:47104
    v_mfma_f32_16x16x32_bf16 v[152:155], v[88:91], v[192:195], v[152:155]
    ds_read_b128 v[68:71], v6 offset:48128
    v_mfma_f32_16x16x32_bf16 v[156:159], v[92:95], v[192:195], v[156:159]
    ds_read_b128 v[72:75], v6 offset:49152
    v_mfma_f32_16x16x32_bf16 v[160:163], v[96:99], v[192:195], v[160:163]
    ds_read_b128 v[76:79], v6 offset:50176
    s_waitcnt lgkmcnt(5)
    v_mfma_f32_16x16x32_bf16 v[144:147], v[100:103], v[196:199], v[144:147]
    ds_read_b128 v[80:83], v6 offset:51200
    v_mfma_f32_16x16x32_bf16 v[148:151], v[104:107], v[196:199], v[148:151]
    ds_read_b128 v[84:87], v6 offset:52224
    v_mfma_f32_16x16x32_bf16 v[152:155], v[108:111], v[196:199], v[152:155]
    ds_read_b128 v[88:91], v6 offset:53248
    v_mfma_f32_16x16x32_bf16 v[156:159], v[112:115], v[196:199], v[156:159]
    ds_read_b128 v[92:95], v6 offset:54272
    v_mfma_f32_16x16x32_bf16 v[160:163], v[116:119], v[196:199], v[160:163]
    ds_read_b128 v[96:99], v6 offset:55296
    s_waitcnt lgkmcnt(5)
    v_mfma_f32_16x16x32_bf16 v[144:147], v[60:63], v[200:203], v[144:147]
    ds_read_b128 v[100:103], v6 offset:56320
    v_mfma_f32_16x16x32_bf16 v[148:151], v[64:67], v[200:203], v[148:151]
    ds_read_b128 v[104:107], v6 offset:57344
    v_mfma_f32_16x16x32_bf16 v[152:155], v[68:71], v[200:203], v[152:155]
    ds_read_b128 v[108:111], v6 offset:58368
    v_mfma_f32_16x16x32_bf16 v[156:159], v[72:75], v[200:203], v[156:159]
    ds_read_b128 v[112:115], v6 offset:59392
    v_mfma_f32_16x16x32_bf16 v[160:163], v[76:79], v[200:203], v[160:163]
    ds_read_b128 v[116:119], v6 offset:60416
    s_waitcnt lgkmcnt(5)
    v_mfma_f32_16x16x32_bf16 v[144:147], v[80:83], v[204:207], v[144:147]
    ds_read_b128 v[60:63], v7 offset:0
    v_mfma_f32_16x16x32_bf16 v[148:151], v[84:87], v[204:207], v[148:151]
    ds_read_b128 v[64:67], v7 offset:1024
    v_mfma_f32_16x16x32_bf16 v[152:155], v[88:91], v[204:207], v[152:155]
    ds_read_b128 v[68:71], v7 offset:2048
    v_mfma_f32_16x16x32_bf16 v[156:159], v[92:95], v[204:207], v[156:159]
    ds_read_b128 v[72:75], v7 offset:3072
    v_mfma_f32_16x16x32_bf16 v[160:163], v[96:99], v[204:207], v[160:163]
    ds_read_b128 v[76:79], v7 offset:4096
    s_waitcnt lgkmcnt(5)
    v_mfma_f32_16x16x32_bf16 v[144:147], v[100:103], v[208:211], v[144:147]
    ds_read_b128 v[80:83], v7 offset:5120
    v_mfma_f32_16x16x32_bf16 v[148:151], v[104:107], v[208:211], v[148:151]
    ds_read_b128 v[84:87], v7 offset:6144
    v_mfma_f32_16x16x32_bf16 v[152:155], v[108:111], v[208:211], v[152:155]
    ds_read_b128 v[88:91], v7 offset:7168
    v_mfma_f32_16x16x32_bf16 v[156:159], v[112:115], v[208:211], v[156:159]
    ds_read_b128 v[92:95], v7 offset:8192
    v_mfma_f32_16x16x32_bf16 v[160:163], v[116:119], v[208:211], v[160:163]
    ds_read_b128 v[96:99], v7 offset:9216
    s_waitcnt lgkmcnt(5)
    v_mfma_f32_16x16x32_bf16 v[144:147], v[60:63], v[212:215], v[144:147]
    ds_read_b128 v[100:103], v7 offset:10240
    v_mfma_f32_16x16x32_bf16 v[148:151], v[64:67], v[212:215], v[148:151]
    ds_read_b128 v[104:107], v7 offset:11264
    v_mfma_f32_16x16x32_bf16 v[152:155], v[68:71], v[212:215], v[152:155]
    ds_read_b128 v[108:111], v7 offset:12288
    v_mfma_f32_16x16x32_bf16 v[156:159], v[72:75], v[212:215], v[156:159]
    ds_read_b128 v[112:115], v7 offset:13312
    v_mfma_f32_16x16x32_bf16 v[160:163], v[76:79], v[212:215], v[160:163]
    ds_read_b128 v[116:119], v7 offset:14336
    s_waitcnt lgkmcnt(5)
    v_mfma_f32_16x16x32_bf16 v[144:147], v[80:83], v[216:219], v[144:147]
    ds_read_b128 v[60:63], v7 offset:15360
    v_mfma_f32_16x16x32_bf16 v[148:151], v[84:87], v[216:219], v[148:151]
    ds_read_b128 v[64:67], v7 offset:16384
    v_mfma_f32_16x16x32_bf16 v[152:155], v[88:91], v[216:219], v[152:155]
    ds_read_b128 v[68:71], v7 offset:17408
    v_mfma_f32_16x16x32_bf16 v[156:159], v[92:95], v[216:219], v[156:159]
    ds_read_b128 v[72:75], v7 offset:18432
    v_mfma_f32_16x16x32_bf16 v[160:163], v[96:99], v[216:219], v[160:163]
    ds_read_b128 v[76:79], v7 offset:19456
    s_waitcnt lgkmcnt(5)
    v_mfma_f32_16x16x32_bf16 v[144:147], v[100:103], v[220:223], v[144:147]
    ds_read_b128 v[80:83], v7 offset:20480
    v_mfma_f32_16x16x32_bf16 v[148:151], v[104:107], v[220:223], v[148:151]
    ds_read_b128 v[84:87], v7 offset:21504
    v_mfma_f32_16x16x32_bf16 v[152:155], v[108:111], v[220:223], v[152:155]
    ds_read_b128 v[88:91], v7 offset:22528
    v_mfma_f32_16x16x32_bf16 v[156:159], v[112:115], v[220:223], v[156:159]
    ds_read_b128 v[92:95], v7 offset:23552
    v_mfma_f32_16x16x32_bf16 v[160:163], v[116:119], v[220:223], v[160:163]
    ds_read_b128 v[96:99], v7 offset:24576
    s_waitcnt lgkmcnt(5)
    v_mfma_f32_16x16x32_bf16 v[144:147], v[60:63], v[224:227], v[144:147]
    ds_read_b128 v[100:103], v7 offset:25600
    v_mfma_f32_16x16x32_bf16 v[148:151], v[64:67], v[224:227], v[148:151]
    ds_read_b128 v[104:107], v7 offset:26624
    v_mfma_f32_16x16x32_bf16 v[152:155], v[68:71], v[224:227], v[152:155]
    ds_read_b128 v[108:111], v7 offset:27648
    v_mfma_f32_16x16x32_bf16 v[156:159], v[72:75], v[224:227], v[156:159]
    ds_read_b128 v[112:115], v7 offset:28672
    v_mfma_f32_16x16x32_bf16 v[160:163], v[76:79], v[224:227], v[160:163]
    ds_read_b128 v[116:119], v7 offset:29696
    s_waitcnt lgkmcnt(5)
    v_mfma_f32_16x16x32_bf16 v[144:147], v[80:83], v[228:231], v[144:147]
    ds_read_b128 v[60:63], v7 offset:30720
    v_mfma_f32_16x16x32_bf16 v[148:151], v[84:87], v[228:231], v[148:151]
    ds_read_b128 v[64:67], v7 offset:31744
    v_mfma_f32_16x16x32_bf16 v[152:155], v[88:91], v[228:231], v[152:155]
    ds_read_b128 v[68:71], v7 offset:32768
    v_mfma_f32_16x16x32_bf16 v[156:159], v[92:95], v[228:231], v[156:159]
    ds_read_b128 v[72:75], v7 offset:33792
    v_mfma_f32_16x16x32_bf16 v[160:163], v[96:99], v[228:231], v[160:163]
    ds_read_b128 v[76:79], v7 offset:34816
    s_waitcnt lgkmcnt(5)
    v_mfma_f32_16x16x32_bf16 v[144:147], v[100:103], v[232:235], v[144:147]
    ds_read_b128 v[80:83], v7 offset:35840
    v_mfma_f32_16x16x32_bf16 v[148:151], v[104:107], v[232:235], v[148:151]
    ds_read_b128 v[84:87], v7 offset:36864
    v_mfma_f32_16x16x32_bf16 v[152:155], v[108:111], v[232:235], v[152:155]
    ds_read_b128 v[88:91], v7 offset:37888
    v_mfma_f32_16x16x32_bf16 v[156:159], v[112:115], v[232:235], v[156:159]
    ds_read_b128 v[92:95], v7 offset:38912
    v_mfma_f32_16x16x32_bf16 v[160:163], v[116:119], v[232:235], v[160:163]
    ds_read_b128 v[96:99], v7 offset:39936
    s_waitcnt lgkmcnt(5)
    v_mfma_f32_16x16x32_bf16 v[144:147], v[60:63], v[236:239], v[144:147]
    v_mfma_f32_16x16x32_bf16 v[148:151], v[64:67], v[236:239], v[148:151]
    v_mfma_f32_16x16x32_bf16 v[152:155], v[68:71], v[236:239], v[152:155]
    v_mfma_f32_16x16x32_bf16 v[156:159], v[72:75], v[236:239], v[156:159]
    v_mfma_f32_16x16x32_bf16 v[160:163], v[76:79], v[236:239], v[160:163]
    s_waitcnt lgkmcnt(0)
    v_mfma_f32_16x16x32_bf16 v[144:147], v[80:83], v[240:243], v[144:147]
    v_mfma_f32_16x16x32_bf16 v[148:151], v[84:87], v[240:243], v[148:151]
    v_mfma_f32_16x16x32_bf16 v[152:155], v[88:91], v[240:243], v[152:155]
    v_mfma_f32_16x16x32_bf16 v[156:159], v[92:95], v[240:243], v[156:159]
    v_mfma_f32_16x16x32_bf16 v[160:163], v[96:99], v[240:243], v[160:163]
    v_mov_b32 v6, 0x3d64f92e
    s_nop 2
    v_pk_mul_f32 v[144:145], v[144:145], v[6:7] op_sel_hi:[1,0]
    v_pk_mul_f32 v[146:147], v[146:147], v[6:7] op_sel_hi:[1,0]
    v_pk_mul_f32 v[148:149], v[148:149], v[6:7] op_sel_hi:[1,0]
    v_pk_mul_f32 v[150:151], v[150:151], v[6:7] op_sel_hi:[1,0]
    v_pk_mul_f32 v[152:153], v[152:153], v[6:7] op_sel_hi:[1,0]
    v_pk_mul_f32 v[154:155], v[154:155], v[6:7] op_sel_hi:[1,0]
    v_pk_mul_f32 v[156:157], v[156:157], v[6:7] op_sel_hi:[1,0]
    v_pk_mul_f32 v[158:159], v[158:159], v[6:7] op_sel_hi:[1,0]
    v_pk_mul_f32 v[160:161], v[160:161], v[6:7] op_sel_hi:[1,0]
    v_pk_mul_f32 v[162:163], v[162:163], v[6:7] op_sel_hi:[1,0]
La_124:
    v_mov_b32 v5, s85
    s_or_b32 s80, s94, 1
    s_add_u32 s80, s80, 3
    s_and_b32 s80, s80, 7
    s_waitcnt lgkmcnt(0)
    s_barrier
    ds_read_b32 v6, v5 offset:20480
    ds_read_b128 v[108:111], v25 offset:40960
    ds_read_b64 v[120:121], v26 offset:40960
    s_mov_b64 exec, s[4:5]
    ds_read_b128 v[124:127], v27 offset:40960
    ds_read_b128 v[128:131], v27 offset:41600
    s_mov_b64 exec, -1
    s_waitcnt lgkmcnt(2)
    v_mfma_f32_32x32x16_bf16 v[92:107], v[108:111], v[8:11], 0
    v_mfma_f32_32x32x8_bf16 v[92:107], v[120:121], v[16:17], v[92:107]
    s_waitcnt lgkmcnt(0)
    s_mul_i32 s81, s80, 20480
    s_add_u32 m0, s85, 20480
    s_add_u32 s81, s81, s86
    buffer_load_dwordx4 v4, s[20:23], s81 offen sc1 lds
    buffer_load_dwordx4 v4, s[20:23], s81 offen offset:1024 sc1 lds
    s_mov_b32 exec_hi, 0
    buffer_load_dwordx4 v4, s[20:23], s81 offen offset:2048 sc1 lds
    s_mov_b32 exec_hi, -1
    s_add_u32 s80, s80, 1
    s_and_b32 s80, s80, 7
    v_readfirstlane_b32 s72, v6
    s_nop 0
    s_cmp_lg_u32 s72, 0
    s_cbranch_scc1 La_127
    v_mfma_f32_32x32x16_bf16 v[60:75], v[108:111], v[12:15], 0
    v_exp_f32 v92, v92
    v_exp_f32 v93, v93
    v_exp_f32 v94, v94
    v_exp_f32 v95, v95
    v_mfma_f32_32x32x8_bf16 v[60:75], v[120:121], v[20:21], v[60:75]
    ds_read_b128 v[112:115], v25 offset:43264
    v_exp_f32 v96, v96
    v_exp_f32 v97, v97
    v_exp_f32 v98, v98
    v_exp_f32 v99, v99
    s_mov_b64 exec, s[4:5]
    ds_read_b128 v[132:135], v27 offset:43264
    ds_read_b128 v[136:139], v27 offset:43904
    s_mov_b64 exec, -1
    v_exp_f32 v100, v100
    v_exp_f32 v101, v101
    v_exp_f32 v102, v102
    v_exp_f32 v103, v103
    v_smfmac_f32_32x32x32_bf16 v[28:43], v[124:127], v[92:99], v24
    s_waitcnt lgkmcnt(2)
    v_exp_f32 v104, v104
    v_exp_f32 v105, v105
    v_exp_f32 v106, v106
    v_exp_f32 v107, v107
    v_mfma_f32_32x32x16_bf16 v[76:91], v[112:115], v[8:11], 0
    v_exp_f32 v60, v60
    v_exp_f32 v61, v61
    v_exp_f32 v62, v62
    v_exp_f32 v63, v63
    v_mfma_f32_32x32x8_bf16 v[76:91], v[120:121], v[18:19], v[76:91]
    v_exp_f32 v64, v64
    v_exp_f32 v65, v65
    v_exp_f32 v66, v66
    v_exp_f32 v67, v67
    v_smfmac_f32_32x32x32_bf16 v[28:43], v[128:131], v[100:107], v24
    v_exp_f32 v68, v68
    v_exp_f32 v69, v69
    v_exp_f32 v70, v70
    v_exp_f32 v71, v71
    v_smfmac_f32_32x32x32_bf16 v[44:59], v[124:127], v[60:67], v24
    s_waitcnt lgkmcnt(0)
    v_exp_f32 v72, v72
    v_exp_f32 v73, v73
    v_exp_f32 v74, v74
    v_exp_f32 v75, v75
    v_mfma_f32_32x32x16_bf16 v[92:107], v[112:115], v[12:15], 0
    v_exp_f32 v76, v76
    v_exp_f32 v77, v77
    v_exp_f32 v78, v78
    v_exp_f32 v79, v79
    v_mfma_f32_32x32x8_bf16 v[92:107], v[120:121], v[22:23], v[92:107]
    ds_read_b128 v[108:111], v25 offset:45568
    ds_read_b64 v[116:117], v26 offset:41472
    v_exp_f32 v80, v80
    v_exp_f32 v81, v81
    v_exp_f32 v82, v82
    v_exp_f32 v83, v83
    v_smfmac_f32_32x32x32_bf16 v[44:59], v[128:131], v[68:75], v24
    s_mov_b64 exec, s[4:5]
    ds_read_b128 v[124:127], v27 offset:45568
    ds_read_b128 v[128:131], v27 offset:46208
    s_mov_b64 exec, -1
    v_exp_f32 v84, v84
    v_exp_f32 v85, v85
    v_exp_f32 v86, v86
    v_exp_f32 v87, v87
    v_smfmac_f32_32x32x32_bf16 v[28:43], v[132:135], v[76:83], v24
    s_waitcnt lgkmcnt(2)
    s_mov_b32 m0, s8
    s_add_u32 s8, s8, 1024
    buffer_load_dwordx4 v4, s[20:23], s9 offen sc1 lds
    s_add_u32 s9, s9, 1024
    v_exp_f32 v88, v88
    v_exp_f32 v89, v89
    v_exp_f32 v90, v90
    v_exp_f32 v91, v91
    v_mfma_f32_32x32x16_bf16 v[60:75], v[108:111], v[8:11], 0
    s_setprio 2
    v_exp_f32 v92, v92
    v_exp_f32 v93, v93
    v_exp_f32 v94, v94
    v_exp_f32 v95, v95
    v_mfma_f32_32x32x8_bf16 v[60:75], v[116:117], v[16:17], v[60:75]
    v_exp_f32 v96, v96
    v_exp_f32 v97, v97
    v_exp_f32 v98, v98
    v_exp_f32 v99, v99
    v_smfmac_f32_32x32x32_bf16 v[28:43], v[136:139], v[84:91], v24
    v_exp_f32 v100, v100
    v_exp_f32 v101, v101
    v_exp_f32 v102, v102
    v_exp_f32 v103, v103
    v_smfmac_f32_32x32x32_bf16 v[44:59], v[132:135], v[92:99], v24
    s_waitcnt lgkmcnt(0)
    s_mov_b32 m0, s8
    s_add_u32 s8, s8, 1024
    buffer_load_dwordx4 v4, s[20:23], s9 offen sc1 lds
    s_add_u32 s9, s9, 1024
    v_exp_f32 v104, v104
    v_exp_f32 v105, v105
    v_exp_f32 v106, v106
    v_exp_f32 v107, v107
    v_mfma_f32_32x32x16_bf16 v[76:91], v[108:111], v[12:15], 0
    v_exp_f32 v60, v60
    v_exp_f32 v61, v61
    v_exp_f32 v62, v62
    v_exp_f32 v63, v63
    v_mfma_f32_32x32x8_bf16 v[76:91], v[116:117], v[20:21], v[76:91]
    ds_read_b128 v[112:115], v25 offset:47872
    v_exp_f32 v64, v64
    v_exp_f32 v65, v65
    v_exp_f32 v66, v66
    v_exp_f32 v67, v67
    v_smfmac_f32_32x32x32_bf16 v[44:59], v[136:139], v[100:107], v24
    s_mov_b64 exec, s[4:5]
    ds_read_b128 v[132:135], v27 offset:47872
    ds_read_b128 v[136:139], v27 offset:48512
    s_mov_b64 exec, -1
    v_exp_f32 v68, v68
    v_exp_f32 v69, v69
    v_exp_f32 v70, v70
    v_exp_f32 v71, v71
    v_smfmac_f32_32x32x32_bf16 v[28:43], v[124:127], v[60:67], v24
    s_waitcnt lgkmcnt(2)
    v_exp_f32 v72, v72
    v_exp_f32 v73, v73
    v_exp_f32 v74, v74
    v_exp_f32 v75, v75
    v_mfma_f32_32x32x16_bf16 v[92:107], v[112:115], v[8:11], 0
    s_setprio 1
    v_exp_f32 v76, v76
    v_exp_f32 v77, v77
    v_exp_f32 v78, v78
    v_exp_f32 v79, v79
    v_mfma_f32_32x32x8_bf16 v[92:107], v[116:117], v[18:19], v[92:107]
    v_exp_f32 v80, v80
    v_exp_f32 v81, v81
    v_exp_f32 v82, v82
    v_exp_f32 v83, v83
    v_smfmac_f32_32x32x32_bf16 v[28:43], v[128:131], v[68:75], v24
    v_exp_f32 v84, v84
    v_exp_f32 v85, v85
    v_exp_f32 v86, v86
    v_exp_f32 v87, v87
    v_smfmac_f32_32x32x32_bf16 v[44:59], v[124:127], v[76:83], v24
    s_waitcnt lgkmcnt(0)
    s_setprio 0
    v_exp_f32 v88, v88
    v_exp_f32 v89, v89
    v_exp_f32 v90, v90
    v_exp_f32 v91, v91
    v_mfma_f32_32x32x16_bf16 v[60:75], v[112:115], v[12:15], 0
    s_waitcnt vmcnt(5) lgkmcnt(0)
    s_barrier
    s_setprio 3
    v_exp_f32 v92, v92
    v_exp_f32 v93, v93
    v_exp_f32 v94, v94
    v_exp_f32 v95, v95
    v_mfma_f32_32x32x8_bf16 v[60:75], v[116:117], v[22:23], v[60:75]
    ds_read_b128 v[108:111], v25 offset:0
    ds_read_b64 v[118:119], v26 offset:0
    v_exp_f32 v96, v96
    v_exp_f32 v97, v97
    v_exp_f32 v98, v98
    v_exp_f32 v99, v99
    v_smfmac_f32_32x32x32_bf16 v[44:59], v[128:131], v[84:91], v24
    s_mov_b64 exec, s[4:5]
    ds_read_b128 v[124:127], v27 offset:0
    ds_read_b128 v[128:131], v27 offset:640
    s_mov_b64 exec, -1
    s_mul_i32 s81, s80, 20480
    s_add_u32 m0, s85, 40960
    v_exp_f32 v100, v100
    v_exp_f32 v101, v101
    v_exp_f32 v102, v102
    v_exp_f32 v103, v103
    v_smfmac_f32_32x32x32_bf16 v[28:43], v[132:135], v[92:99], v24
    s_waitcnt lgkmcnt(2)
    s_add_u32 s81, s81, s86
    v_exp_f32 v104, v104
    v_exp_f32 v105, v105
    v_exp_f32 v106, v106
    v_exp_f32 v107, v107
    v_mfma_f32_32x32x16_bf16 v[76:91], v[108:111], v[8:11], 0
    buffer_load_dwordx4 v4, s[20:23], s81 offen sc1 lds
    v_exp_f32 v60, v60
    v_exp_f32 v61, v61
    v_exp_f32 v62, v62
    v_exp_f32 v63, v63
    v_mfma_f32_32x32x8_bf16 v[76:91], v[118:119], v[16:17], v[76:91]
    v_exp_f32 v64, v64
    v_exp_f32 v65, v65
    v_exp_f32 v66, v66
    v_exp_f32 v67, v67
    v_smfmac_f32_32x32x32_bf16 v[28:43], v[136:139], v[100:107], v24
    s_add_u32 s80, s80, 1
    s_and_b32 s80, s80, 7
    buffer_load_dwordx4 v4, s[20:23], s81 offen offset:1024 sc1 lds
    v_exp_f32 v68, v68
    v_exp_f32 v69, v69
    v_exp_f32 v70, v70
    v_exp_f32 v71, v71
    v_smfmac_f32_32x32x32_bf16 v[44:59], v[132:135], v[60:67], v24
    s_waitcnt lgkmcnt(0)
    s_mov_b32 exec_hi, 0
    buffer_load_dwordx4 v4, s[20:23], s81 offen offset:2048 sc1 lds
    s_mov_b32 exec_hi, -1
    v_exp_f32 v72, v72
    v_exp_f32 v73, v73
    v_exp_f32 v74, v74
    v_exp_f32 v75, v75
    v_mfma_f32_32x32x16_bf16 v[92:107], v[108:111], v[12:15], 0
    v_exp_f32 v76, v76
    v_exp_f32 v77, v77
    v_exp_f32 v78, v78
    v_exp_f32 v79, v79
    v_mfma_f32_32x32x8_bf16 v[92:107], v[118:119], v[20:21], v[92:107]
    ds_read_b128 v[112:115], v25 offset:2304
    v_exp_f32 v80, v80
    v_exp_f32 v81, v81
    v_exp_f32 v82, v82
    v_exp_f32 v83, v83
    v_smfmac_f32_32x32x32_bf16 v[44:59], v[136:139], v[68:75], v24
    s_mov_b64 exec, s[4:5]
    ds_read_b128 v[132:135], v27 offset:2304
    ds_read_b128 v[136:139], v27 offset:2944
    s_mov_b64 exec, -1
    s_cmp_eq_u32 s80, s94
    s_addc_u32 s80, s80, 0
    v_exp_f32 v84, v84
    v_exp_f32 v85, v85
    v_exp_f32 v86, v86
    v_exp_f32 v87, v87
    v_smfmac_f32_32x32x32_bf16 v[28:43], v[124:127], v[76:83], v24
    s_waitcnt lgkmcnt(2)
    s_lshl_b32 s73, s68, 5
    s_add_u32 s13, s0, s73
    s_sub_u32 s13, s13, 2621440
    s_cmp_gt_u32 s69, s58
    s_cselect_b32 s13, s13, s22
    v_lshlrev_b32 v7, 8, v2
    v_lshl_add_u32 v7, v3, 3, v7
    v_exp_f32 v88, v88
    v_exp_f32 v89, v89
    v_exp_f32 v90, v90
    v_exp_f32 v91, v91
    v_mfma_f32_32x32x16_bf16 v[60:75], v[112:115], v[8:11], 0
    v_exp_f32 v92, v92
    v_exp_f32 v93, v93
    v_exp_f32 v94, v94
    v_exp_f32 v95, v95
    v_mfma_f32_32x32x8_bf16 v[60:75], v[118:119], v[18:19], v[60:75]
    v_exp_f32 v96, v96
    v_exp_f32 v97, v97
    v_exp_f32 v98, v98
    v_exp_f32 v99, v99
    v_smfmac_f32_32x32x32_bf16 v[28:43], v[128:131], v[84:91], v24
    v_exp_f32 v100, v100
    v_exp_f32 v101, v101
    v_exp_f32 v102, v102
    v_exp_f32 v103, v103
    v_smfmac_f32_32x32x32_bf16 v[44:59], v[124:127], v[92:99], v24
    s_waitcnt lgkmcnt(0)
    buffer_load_dwordx2 v[164:165], v7, s[20:23], s13 offen sc1
    s_add_u32 s13, s13, 4096
    v_exp_f32 v104, v104
    v_exp_f32 v105, v105
    v_exp_f32 v106, v106
    v_exp_f32 v107, v107
    v_mfma_f32_32x32x16_bf16 v[76:91], v[112:115], v[12:15], 0
    v_exp_f32 v60, v60
    v_exp_f32 v61, v61
    v_exp_f32 v62, v62
    v_exp_f32 v63, v63
    v_mfma_f32_32x32x8_bf16 v[76:91], v[118:119], v[22:23], v[76:91]
    ds_read_b128 v[108:111], v25 offset:4608
    ds_read_b64 v[120:121], v26 offset:512
    v_exp_f32 v64, v64
    v_exp_f32 v65, v65
    v_exp_f32 v66, v66
    v_exp_f32 v67, v67
    v_smfmac_f32_32x32x32_bf16 v[44:59], v[128:131], v[100:107], v24
    s_mov_b64 exec, s[4:5]
    ds_read_b128 v[124:127], v27 offset:4608
    ds_read_b128 v[128:131], v27 offset:5248
    s_mov_b64 exec, -1
    v_exp_f32 v68, v68
    v_exp_f32 v69, v69
    v_exp_f32 v70, v70
    v_exp_f32 v71, v71
    v_smfmac_f32_32x32x32_bf16 v[28:43], v[132:135], v[60:67], v24
    s_waitcnt lgkmcnt(2)
    s_mov_b32 m0, s8
    s_add_u32 s8, s8, 1024
    buffer_load_dwordx4 v4, s[20:23], s9 offen sc1 lds
    s_add_u32 s9, s9, 1024
    v_exp_f32 v72, v72
    v_exp_f32 v73, v73
    v_exp_f32 v74, v74
    v_exp_f32 v75, v75
    v_mfma_f32_32x32x16_bf16 v[92:107], v[108:111], v[8:11], 0
    s_setprio 2
    v_exp_f32 v76, v76
    v_exp_f32 v77, v77
    v_exp_f32 v78, v78
    v_exp_f32 v79, v79
    v_mfma_f32_32x32x8_bf16 v[92:107], v[120:121], v[16:17], v[92:107]
    v_exp_f32 v80, v80
    v_exp_f32 v81, v81
    v_exp_f32 v82, v82
    v_exp_f32 v83, v83
    v_smfmac_f32_32x32x32_bf16 v[28:43], v[136:139], v[68:75], v24
    v_exp_f32 v84, v84
    v_exp_f32 v85, v85
    v_exp_f32 v86, v86
    v_exp_f32 v87, v87
    v_smfmac_f32_32x32x32_bf16 v[44:59], v[132:135], v[76:83], v24
    s_waitcnt lgkmcnt(0)
    s_mov_b32 m0, s8
    s_add_u32 s8, s8, 1024
    buffer_load_dwordx4 v4, s[20:23], s9 offen sc1 lds
    s_add_u32 s9, s9, 1024
    v_exp_f32 v88, v88
    v_exp_f32 v89, v89
    v_exp_f32 v90, v90
    v_exp_f32 v91, v91
    v_mfma_f32_32x32x16_bf16 v[60:75], v[108:111], v[12:15], 0
    v_exp_f32 v92, v92
    v_exp_f32 v93, v93
    v_exp_f32 v94, v94
    v_exp_f32 v95, v95
    v_mfma_f32_32x32x8_bf16 v[60:75], v[120:121], v[20:21], v[60:75]
    ds_read_b128 v[112:115], v25 offset:6912
    v_exp_f32 v96, v96
    v_exp_f32 v97, v97
    v_exp_f32 v98, v98
    v_exp_f32 v99, v99
    v_smfmac_f32_32x32x32_bf16 v[44:59], v[136:139], v[84:91], v24
    s_mov_b64 exec, s[4:5]
    ds_read_b128 v[132:135], v27 offset:6912
    ds_read_b128 v[136:139], v27 offset:7552
    s_mov_b64 exec, -1
    v_exp_f32 v100, v100
    v_exp_f32 v101, v101
    v_exp_f32 v102, v102
    v_exp_f32 v103, v103
    v_smfmac_f32_32x32x32_bf16 v[28:43], v[124:127], v[92:99], v24
    s_waitcnt lgkmcnt(2)
    buffer_load_dwordx2 v[166:167], v7, s[20:23], s13 offen sc1
    s_add_u32 s13, s13, 4096
    v_exp_f32 v104, v104
    v_exp_f32 v105, v105
    v_exp_f32 v106, v106
    v_exp_f32 v107, v107
    v_mfma_f32_32x32x16_bf16 v[76:91], v[112:115], v[8:11], 0
    s_setprio 1
    v_exp_f32 v60, v60
    v_exp_f32 v61, v61
    v_exp_f32 v62, v62
    v_exp_f32 v63, v63
    v_mfma_f32_32x32x8_bf16 v[76:91], v[120:121], v[18:19], v[76:91]
    v_exp_f32 v64, v64
    v_exp_f32 v65, v65
    v_exp_f32 v66, v66
    v_exp_f32 v67, v67
    v_smfmac_f32_32x32x32_bf16 v[28:43], v[128:131], v[100:107], v24
    v_exp_f32 v68, v68
    v_exp_f32 v69, v69
    v_exp_f32 v70, v70
    v_exp_f32 v71, v71
    v_smfmac_f32_32x32x32_bf16 v[44:59], v[124:127], v[60:67], v24
    s_waitcnt lgkmcnt(0)
    s_setprio 0
    v_exp_f32 v72, v72
    v_exp_f32 v73, v73
    v_exp_f32 v74, v74
    v_exp_f32 v75, v75
    v_mfma_f32_32x32x16_bf16 v[92:107], v[112:115], v[12:15], 0
    s_waitcnt vmcnt(9) lgkmcnt(0)
    s_barrier
    s_setprio 3
    v_exp_f32 v76, v76
    v_exp_f32 v77, v77
    v_exp_f32 v78, v78
    v_exp_f32 v79, v79
    v_mfma_f32_32x32x8_bf16 v[92:107], v[120:121], v[22:23], v[92:107]
    ds_read_b128 v[108:111], v25 offset:20480
    ds_read_b64 v[116:117], v26 offset:20480
    v_exp_f32 v80, v80
    v_exp_f32 v81, v81
    v_exp_f32 v82, v82
    v_exp_f32 v83, v83
    v_smfmac_f32_32x32x32_bf16 v[44:59], v[128:131], v[68:75], v24
    s_mov_b64 exec, s[4:5]
    ds_read_b128 v[124:127], v27 offset:20480
    ds_read_b128 v[128:131], v27 offset:21120
    s_mov_b64 exec, -1
    s_mul_i32 s81, s80, 20480
    s_add_u32 m0, s85, 0
    v_exp_f32 v84, v84
    v_exp_f32 v85, v85
    v_exp_f32 v86, v86
    v_exp_f32 v87, v87
    v_smfmac_f32_32x32x32_bf16 v[28:43], v[132:135], v[76:83], v24
    s_waitcnt lgkmcnt(2)
    s_add_u32 s81, s81, s86
    v_exp_f32 v88, v88
    v_exp_f32 v89, v89
    v_exp_f32 v90, v90
    v_exp_f32 v91, v91
    v_mfma_f32_32x32x16_bf16 v[60:75], v[108:111], v[8:11], 0
    buffer_load_dwordx4 v4, s[20:23], s81 offen sc1 lds
    v_exp_f32 v92, v92
    v_exp_f32 v93, v93
    v_exp_f32 v94, v94
    v_exp_f32 v95, v95
    v_mfma_f32_32x32x8_bf16 v[60:75], v[116:117], v[16:17], v[60:75]
    v_exp_f32 v96, v96
    v_exp_f32 v97, v97
    v_exp_f32 v98, v98
    v_exp_f32 v99, v99
    v_smfmac_f32_32x32x32_bf16 v[28:43], v[136:139], v[84:91], v24
    s_add_u32 s80, s80, 1
    s_and_b32 s80, s80, 7
    buffer_load_dwordx4 v4, s[20:23], s81 offen offset:1024 sc1 lds
    v_exp_f32 v100, v100
    v_exp_f32 v101, v101
    v_exp_f32 v102, v102
    v_exp_f32 v103, v103
    v_smfmac_f32_32x32x32_bf16 v[44:59], v[132:135], v[92:99], v24
    s_waitcnt lgkmcnt(0)
    s_mov_b32 exec_hi, 0
    buffer_load_dwordx4 v4, s[20:23], s81 offen offset:2048 sc1 lds
    s_mov_b32 exec_hi, -1
    v_exp_f32 v104, v104
    v_exp_f32 v105, v105
    v_exp_f32 v106, v106
    v_exp_f32 v107, v107
    v_mfma_f32_32x32x16_bf16 v[76:91], v[108:111], v[12:15], 0
    v_exp_f32 v60, v60
    v_exp_f32 v61, v61
    v_exp_f32 v62, v62
    v_exp_f32 v63, v63
    v_mfma_f32_32x32x8_bf16 v[76:91], v[116:117], v[20:21], v[76:91]
    ds_read_b128 v[112:115], v25 offset:22784
    v_exp_f32 v64, v64
    v_exp_f32 v65, v65
    v_exp_f32 v66, v66
    v_exp_f32 v67, v67
    v_smfmac_f32_32x32x32_bf16 v[44:59], v[136:139], v[100:107], v24
    s_mov_b64 exec, s[4:5]
    ds_read_b128 v[132:135], v27 offset:22784
    ds_read_b128 v[136:139], v27 offset:23424
    s_mov_b64 exec, -1
    s_cmp_eq_u32 s80, s94
    s_addc_u32 s80, s80, 0
    v_exp_f32 v68, v68
    v_exp_f32 v69, v69
    v_exp_f32 v70, v70
    v_exp_f32 v71, v71
    v_smfmac_f32_32x32x32_bf16 v[28:43], v[124:127], v[60:67], v24
    s_waitcnt lgkmcnt(2)
    buffer_load_dwordx2 v[168:169], v7, s[20:23], s13 offen sc1
    s_add_u32 s13, s13, 4096
    v_exp_f32 v72, v72
    v_exp_f32 v73, v73
    v_exp_f32 v74, v74
    v_exp_f32 v75, v75
    v_mfma_f32_32x32x16_bf16 v[92:107], v[112:115], v[8:11], 0
    v_exp_f32 v76, v76
    v_exp_f32 v77, v77
    v_exp_f32 v78, v78
    v_exp_f32 v79, v79
    v_mfma_f32_32x32x8_bf16 v[92:107], v[116:117], v[18:19], v[92:107]
    v_exp_f32 v80, v80
    v_exp_f32 v81, v81
    v_exp_f32 v82, v82
    v_exp_f32 v83, v83
    v_smfmac_f32_32x32x32_bf16 v[28:43], v[128:131], v[68:75], v24
    v_exp_f32 v84, v84
    v_exp_f32 v85, v85
    v_exp_f32 v86, v86
    v_exp_f32 v87, v87
    v_smfmac_f32_32x32x32_bf16 v[44:59], v[124:127], v[76:83], v24
    s_waitcnt lgkmcnt(0)
    buffer_load_dwordx2 v[170:171], v7, s[20:23], s13 offen sc1
    s_add_u32 s13, s13, 4096
    v_exp_f32 v88, v88
    v_exp_f32 v89, v89
    v_exp_f32 v90, v90
    v_exp_f32 v91, v91
    v_mfma_f32_32x32x16_bf16 v[60:75], v[112:115], v[12:15], 0
    v_exp_f32 v92, v92
    v_exp_f32 v93, v93
    v_exp_f32 v94, v94
    v_exp_f32 v95, v95
    v_mfma_f32_32x32x8_bf16 v[60:75], v[116:117], v[22:23], v[60:75]
    ds_read_b128 v[108:111], v25 offset:25088
    ds_read_b64 v[118:119], v26 offset:20992
    v_exp_f32 v96, v96
    v_exp_f32 v97, v97
    v_exp_f32 v98, v98
    v_exp_f32 v99, v99
    v_smfmac_f32_32x32x32_bf16 v[44:59], v[128:131], v[84:91], v24
    s_mov_b64 exec, s[4:5]
    ds_read_b128 v[124:127], v27 offset:25088
    ds_read_b128 v[128:131], v27 offset:25728
    s_mov_b64 exec, -1
    v_exp_f32 v100, v100
    v_exp_f32 v101, v101
    v_exp_f32 v102, v102
    v_exp_f32 v103, v103
    v_smfmac_f32_32x32x32_bf16 v[28:43], v[132:135], v[92:99], v24
    s_waitcnt lgkmcnt(2)
    s_mov_b32 m0, s8
    s_add_u32 s8, s8, 1024
    buffer_load_dwordx4 v4, s[20:23], s9 offen sc1 lds
    s_add_u32 s9, s9, 1024
    v_exp_f32 v104, v104
    v_exp_f32 v105, v105
    v_exp_f32 v106, v106
    v_exp_f32 v107, v107
    v_mfma_f32_32x32x16_bf16 v[76:91], v[108:111], v[8:11], 0
    s_setprio 2
    v_exp_f32 v60, v60
    v_exp_f32 v61, v61
    v_exp_f32 v62, v62
    v_exp_f32 v63, v63
    v_mfma_f32_32x32x8_bf16 v[76:91], v[118:119], v[16:17], v[76:91]
    v_exp_f32 v64, v64
    v_exp_f32 v65, v65
    v_exp_f32 v66, v66
    v_exp_f32 v67, v67
    v_smfmac_f32_32x32x32_bf16 v[28:43], v[136:139], v[100:107], v24
    v_exp_f32 v68, v68
    v_exp_f32 v69, v69
    v_exp_f32 v70, v70
    v_exp_f32 v71, v71
    v_smfmac_f32_32x32x32_bf16 v[44:59], v[132:135], v[60:67], v24
    s_waitcnt lgkmcnt(0)
    s_mov_b32 m0, s8
    s_add_u32 s8, s8, 1024
    buffer_load_dwordx4 v4, s[20:23], s9 offen sc1 lds
    s_add_u32 s9, s9, 1024
    v_exp_f32 v72, v72
    v_exp_f32 v73, v73
    v_exp_f32 v74, v74
    v_exp_f32 v75, v75
    v_mfma_f32_32x32x16_bf16 v[92:107], v[108:111], v[12:15], 0
    v_exp_f32 v76, v76
    v_exp_f32 v77, v77
    v_exp_f32 v78, v78
    v_exp_f32 v79, v79
    v_mfma_f32_32x32x8_bf16 v[92:107], v[118:119], v[20:21], v[92:107]
    ds_read_b128 v[112:115], v25 offset:27392
    v_exp_f32 v80, v80
    v_exp_f32 v81, v81
    v_exp_f32 v82, v82
    v_exp_f32 v83, v83
    v_smfmac_f32_32x32x32_bf16 v[44:59], v[136:139], v[68:75], v24
    s_mov_b64 exec, s[4:5]
    ds_read_b128 v[132:135], v27 offset:27392
    ds_read_b128 v[136:139], v27 offset:28032
    s_mov_b64 exec, -1
    v_exp_f32 v84, v84
    v_exp_f32 v85, v85
    v_exp_f32 v86, v86
    v_exp_f32 v87, v87
    v_smfmac_f32_32x32x32_bf16 v[28:43], v[124:127], v[76:83], v24
    s_waitcnt lgkmcnt(2)
    buffer_load_dwordx2 v[172:173], v7, s[20:23], s13 offen sc1
    s_add_u32 s13, s13, 4096
    v_exp_f32 v88, v88
    v_exp_f32 v89, v89
    v_exp_f32 v90, v90
    v_exp_f32 v91, v91
    v_mfma_f32_32x32x16_bf16 v[60:75], v[112:115], v[8:11], 0
    s_setprio 1
    v_exp_f32 v92, v92
    v_exp_f32 v93, v93
    v_exp_f32 v94, v94
    v_exp_f32 v95, v95
    v_mfma_f32_32x32x8_bf16 v[60:75], v[118:119], v[18:19], v[60:75]
    v_exp_f32 v96, v96
    v_exp_f32 v97, v97
    v_exp_f32 v98, v98
    v_exp_f32 v99, v99
    v_smfmac_f32_32x32x32_bf16 v[28:43], v[128:131], v[84:91], v24
    v_exp_f32 v100, v100
    v_exp_f32 v101, v101
    v_exp_f32 v102, v102
    v_exp_f32 v103, v103
    v_smfmac_f32_32x32x32_bf16 v[44:59], v[124:127], v[92:99], v24
    s_waitcnt lgkmcnt(0)
    s_setprio 0
    v_exp_f32 v104, v104
    v_exp_f32 v105, v105
    v_exp_f32 v106, v106
    v_exp_f32 v107, v107
    v_mfma_f32_32x32x16_bf16 v[76:91], v[112:115], v[12:15], 0
    s_waitcnt vmcnt(12) lgkmcnt(0)
    s_barrier
    s_setprio 3
    v_exp_f32 v60, v60
    v_exp_f32 v61, v61
    v_exp_f32 v62, v62
    v_exp_f32 v63, v63
    v_mfma_f32_32x32x8_bf16 v[76:91], v[118:119], v[22:23], v[76:91]
    ds_read_b128 v[108:111], v25 offset:40960
    ds_read_b64 v[120:121], v26 offset:40960
    v_exp_f32 v64, v64
    v_exp_f32 v65, v65
    v_exp_f32 v66, v66
    v_exp_f32 v67, v67
    v_smfmac_f32_32x32x32_bf16 v[44:59], v[128:131], v[100:107], v24
    s_mov_b64 exec, s[4:5]
    ds_read_b128 v[124:127], v27 offset:40960
    ds_read_b128 v[128:131], v27 offset:41600
    s_mov_b64 exec, -1
    s_mul_i32 s81, s80, 20480
    s_add_u32 m0, s85, 20480
    v_exp_f32 v68, v68
    v_exp_f32 v69, v69
    v_exp_f32 v70, v70
    v_exp_f32 v71, v71
    v_smfmac_f32_32x32x32_bf16 v[28:43], v[132:135], v[60:67], v24
    s_waitcnt lgkmcnt(2)
    s_add_u32 s81, s81, s86
    v_exp_f32 v72, v72
    v_exp_f32 v73, v73
    v_exp_f32 v74, v74
    v_exp_f32 v75, v75
    v_mfma_f32_32x32x16_bf16 v[92:107], v[108:111], v[8:11], 0
    buffer_load_dwordx4 v4, s[20:23], s81 offen sc1 lds
    v_exp_f32 v76, v76
    v_exp_f32 v77, v77
    v_exp_f32 v78, v78
    v_exp_f32 v79, v79
    v_mfma_f32_32x32x8_bf16 v[92:107], v[120:121], v[16:17], v[92:107]
    v_exp_f32 v80, v80
    v_exp_f32 v81, v81
    v_exp_f32 v82, v82
    v_exp_f32 v83, v83
    v_smfmac_f32_32x32x32_bf16 v[28:43], v[136:139], v[68:75], v24
    s_add_u32 s80, s80, 1
    s_and_b32 s80, s80, 7
    buffer_load_dwordx4 v4, s[20:23], s81 offen offset:1024 sc1 lds
    v_exp_f32 v84, v84
    v_exp_f32 v85, v85
    v_exp_f32 v86, v86
    v_exp_f32 v87, v87
    v_smfmac_f32_32x32x32_bf16 v[44:59], v[132:135], v[76:83], v24
    s_waitcnt lgkmcnt(0)
    s_mov_b32 exec_hi, 0
    buffer_load_dwordx4 v4, s[20:23], s81 offen offset:2048 sc1 lds
    s_mov_b32 exec_hi, -1
    v_exp_f32 v88, v88
    v_exp_f32 v89, v89
    v_exp_f32 v90, v90
    v_exp_f32 v91, v91
    v_mfma_f32_32x32x16_bf16 v[60:75], v[108:111], v[12:15], 0
    v_exp_f32 v92, v92
    v_exp_f32 v93, v93
    v_exp_f32 v94, v94
    v_exp_f32 v95, v95
    v_mfma_f32_32x32x8_bf16 v[60:75], v[120:121], v[20:21], v[60:75]
    ds_read_b128 v[112:115], v25 offset:43264
    v_exp_f32 v96, v96
    v_exp_f32 v97, v97
    v_exp_f32 v98, v98
    v_exp_f32 v99, v99
    v_smfmac_f32_32x32x32_bf16 v[44:59], v[136:139], v[84:91], v24
    s_mov_b64 exec, s[4:5]
    ds_read_b128 v[132:135], v27 offset:43264
    ds_read_b128 v[136:139], v27 offset:43904
    s_mov_b64 exec, -1
    s_cmp_eq_u32 s80, s94
    s_addc_u32 s80, s80, 0
    v_exp_f32 v100, v100
    v_exp_f32 v101, v101
    v_exp_f32 v102, v102
    v_exp_f32 v103, v103
    v_smfmac_f32_32x32x32_bf16 v[28:43], v[124:127], v[92:99], v24
    s_waitcnt lgkmcnt(2)
    v_mov_b32 v140, -1
    v_mov_b32 v141, -1
    v_mov_b32 v142, -1
    v_mov_b32 v143, -1
    v_exp_f32 v104, v104
    v_exp_f32 v105, v105
    v_exp_f32 v106, v106
    v_exp_f32 v107, v107
    v_mfma_f32_32x32x16_bf16 v[76:91], v[112:115], v[8:11], 0
    v_exp_f32 v60, v60
    v_exp_f32 v61, v61
    v_exp_f32 v62, v62
    v_exp_f32 v63, v63
    v_mfma_f32_32x32x8_bf16 v[76:91], v[120:121], v[18:19], v[76:91]
    v_exp_f32 v64, v64
    v_exp_f32 v65, v65
    v_exp_f32 v66, v66
    v_exp_f32 v67, v67
    v_smfmac_f32_32x32x32_bf16 v[28:43], v[128:131], v[100:107], v24
    v_exp_f32 v68, v68
    v_exp_f32 v69, v69
    v_exp_f32 v70, v70
    v_exp_f32 v71, v71
    v_smfmac_f32_32x32x32_bf16 v[44:59], v[124:127], v[60:67], v24
    s_waitcnt lgkmcnt(0)
    buffer_store_dwordx4 v[140:143], v250, s[20:23], s18 offen sc1
    v_exp_f32 v72, v72
    v_exp_f32 v73, v73
    v_exp_f32 v74, v74
    v_exp_f32 v75, v75
    v_mfma_f32_32x32x16_bf16 v[92:107], v[112:115], v[12:15], 0
    v_exp_f32 v76, v76
    v_exp_f32 v77, v77
    v_exp_f32 v78, v78
    v_exp_f32 v79, v79
    v_mfma_f32_32x32x8_bf16 v[92:107], v[120:121], v[22:23], v[92:107]
    ds_read_b128 v[108:111], v25 offset:45568
    ds_read_b64 v[116:117], v26 offset:41472
    v_exp_f32 v80, v80
    v_exp_f32 v81, v81
    v_exp_f32 v82, v82
    v_exp_f32 v83, v83
    v_smfmac_f32_32x32x32_bf16 v[44:59], v[128:131], v[68:75], v24
    s_mov_b64 exec, s[4:5]
    ds_read_b128 v[124:127], v27 offset:45568
    ds_read_b128 v[128:131], v27 offset:46208
    s_mov_b64 exec, -1
    v_exp_f32 v84, v84
    v_exp_f32 v85, v85
    v_exp_f32 v86, v86
    v_exp_f32 v87, v87
    v_smfmac_f32_32x32x32_bf16 v[28:43], v[132:135], v[76:83], v24
    s_waitcnt lgkmcnt(2)
    s_mov_b32 m0, s8
    s_add_u32 s8, s8, 1024
    buffer_load_dwordx4 v4, s[20:23], s9 offen sc1 lds
    s_add_u32 s9, s9, 1024
    v_exp_f32 v88, v88
    v_exp_f32 v89, v89
    v_exp_f32 v90, v90
    v_exp_f32 v91, v91
    v_mfma_f32_32x32x16_bf16 v[60:75], v[108:111], v[8:11], 0
    s_setprio 2
    v_exp_f32 v92, v92
    v_exp_f32 v93, v93
    v_exp_f32 v94, v94
    v_exp_f32 v95, v95
    v_mfma_f32_32x32x8_bf16 v[60:75], v[116:117], v[16:17], v[60:75]
    v_exp_f32 v96, v96
    v_exp_f32 v97, v97
    v_exp_f32 v98, v98
    v_exp_f32 v99, v99
    v_smfmac_f32_32x32x32_bf16 v[28:43], v[136:139], v[84:91], v24
    v_exp_f32 v100, v100
    v_exp_f32 v101, v101
    v_exp_f32 v102, v102
    v_exp_f32 v103, v103
    v_smfmac_f32_32x32x32_bf16 v[44:59], v[132:135], v[92:99], v24
    s_waitcnt lgkmcnt(0)
    s_mov_b32 m0, s8
    s_add_u32 s8, s8, 1024
    buffer_load_dwordx4 v4, s[20:23], s9 offen sc1 lds
    s_add_u32 s9, s9, 1024
    v_exp_f32 v104, v104
    v_exp_f32 v105, v105
    v_exp_f32 v106, v106
    v_exp_f32 v107, v107
    v_mfma_f32_32x32x16_bf16 v[76:91], v[108:111], v[12:15], 0
    v_exp_f32 v60, v60
    v_exp_f32 v61, v61
    v_exp_f32 v62, v62
    v_exp_f32 v63, v63
    v_mfma_f32_32x32x8_bf16 v[76:91], v[116:117], v[20:21], v[76:91]
    ds_read_b128 v[112:115], v25 offset:47872
    v_exp_f32 v64, v64
    v_exp_f32 v65, v65
    v_exp_f32 v66, v66
    v_exp_f32 v67, v67
    v_smfmac_f32_32x32x32_bf16 v[44:59], v[136:139], v[100:107], v24
    s_mov_b64 exec, s[4:5]
    ds_read_b128 v[132:135], v27 offset:47872
    ds_read_b128 v[136:139], v27 offset:48512
    s_mov_b64 exec, -1
    v_exp_f32 v68, v68
    v_exp_f32 v69, v69
    v_exp_f32 v70, v70
    v_exp_f32 v71, v71
    v_smfmac_f32_32x32x32_bf16 v[28:43], v[124:127], v[60:67], v24
    s_waitcnt lgkmcnt(2)
    s_mov_b32 exec_hi, 0
    buffer_store_dwordx2 v[140:141], v251, s[20:23], s19 offen sc1
    s_mov_b32 exec_hi, -1
    v_exp_f32 v72, v72
    v_exp_f32 v73, v73
    v_exp_f32 v74, v74
    v_exp_f32 v75, v75
    v_mfma_f32_32x32x16_bf16 v[92:107], v[112:115], v[8:11], 0
    s_setprio 1
    v_exp_f32 v76, v76
    v_exp_f32 v77, v77
    v_exp_f32 v78, v78
    v_exp_f32 v79, v79
    v_mfma_f32_32x32x8_bf16 v[92:107], v[116:117], v[18:19], v[92:107]
    v_exp_f32 v80, v80
    v_exp_f32 v81, v81
    v_exp_f32 v82, v82
    v_exp_f32 v83, v83
    v_smfmac_f32_32x32x32_bf16 v[28:43], v[128:131], v[68:75], v24
    v_exp_f32 v84, v84
    v_exp_f32 v85, v85
    v_exp_f32 v86, v86
    v_exp_f32 v87, v87
    v_smfmac_f32_32x32x32_bf16 v[44:59], v[124:127], v[76:83], v24
    s_waitcnt lgkmcnt(0)
    s_setprio 0
    v_exp_f32 v88, v88
    v_exp_f32 v89, v89
    v_exp_f32 v90, v90
    v_exp_f32 v91, v91
    v_mfma_f32_32x32x16_bf16 v[60:75], v[112:115], v[12:15], 0
    s_waitcnt vmcnt(12) lgkmcnt(0)
    s_barrier
    s_setprio 3
    v_exp_f32 v92, v92
    v_exp_f32 v93, v93
    v_exp_f32 v94, v94
    v_exp_f32 v95, v95
    v_mfma_f32_32x32x8_bf16 v[60:75], v[116:117], v[22:23], v[60:75]
    ds_read_b128 v[108:111], v25 offset:0
    ds_read_b64 v[118:119], v26 offset:0
    v_exp_f32 v96, v96
    v_exp_f32 v97, v97
    v_exp_f32 v98, v98
    v_exp_f32 v99, v99
    v_smfmac_f32_32x32x32_bf16 v[44:59], v[128:131], v[84:91], v24
    s_mov_b64 exec, s[4:5]
    ds_read_b128 v[124:127], v27 offset:0
    ds_read_b128 v[128:131], v27 offset:640
    s_mov_b64 exec, -1
    s_mul_i32 s81, s80, 20480
    s_add_u32 m0, s85, 40960
    v_exp_f32 v100, v100
    v_exp_f32 v101, v101
    v_exp_f32 v102, v102
    v_exp_f32 v103, v103
    v_smfmac_f32_32x32x32_bf16 v[28:43], v[132:135], v[92:99], v24
    s_waitcnt lgkmcnt(2)
    s_add_u32 s81, s81, s86
    v_exp_f32 v104, v104
    v_exp_f32 v105, v105
    v_exp_f32 v106, v106
    v_exp_f32 v107, v107
    v_mfma_f32_32x32x16_bf16 v[76:91], v[108:111], v[8:11], 0
    buffer_load_dwordx4 v4, s[20:23], s81 offen sc1 lds
    v_exp_f32 v60, v60
    v_exp_f32 v61, v61
    v_exp_f32 v62, v62
    v_exp_f32 v63, v63
    v_mfma_f32_32x32x8_bf16 v[76:91], v[118:119], v[16:17], v[76:91]
    v_exp_f32 v64, v64
    v_exp_f32 v65, v65
    v_exp_f32 v66, v66
    v_exp_f32 v67, v67
    v_smfmac_f32_32x32x32_bf16 v[28:43], v[136:139], v[100:107], v24
    s_add_u32 s80, s80, 1
    s_and_b32 s80, s80, 7
    buffer_load_dwordx4 v4, s[20:23], s81 offen offset:1024 sc1 lds
    v_exp_f32 v68, v68
    v_exp_f32 v69, v69
    v_exp_f32 v70, v70
    v_exp_f32 v71, v71
    v_smfmac_f32_32x32x32_bf16 v[44:59], v[132:135], v[60:67], v24
    s_waitcnt lgkmcnt(0)
    s_mov_b32 exec_hi, 0
    buffer_load_dwordx4 v4, s[20:23], s81 offen offset:2048 sc1 lds
    s_mov_b32 exec_hi, -1
    v_exp_f32 v72, v72
    v_exp_f32 v73, v73
    v_exp_f32 v74, v74
    v_exp_f32 v75, v75
    v_mfma_f32_32x32x16_bf16 v[92:107], v[108:111], v[12:15], 0
    v_exp_f32 v76, v76
    v_exp_f32 v77, v77
    v_exp_f32 v78, v78
    v_exp_f32 v79, v79
    v_mfma_f32_32x32x8_bf16 v[92:107], v[118:119], v[20:21], v[92:107]
    ds_read_b128 v[112:115], v25 offset:2304
    v_exp_f32 v80, v80
    v_exp_f32 v81, v81
    v_exp_f32 v82, v82
    v_exp_f32 v83, v83
    v_smfmac_f32_32x32x32_bf16 v[44:59], v[136:139], v[68:75], v24
    s_mov_b64 exec, s[4:5]
    ds_read_b128 v[132:135], v27 offset:2304
    ds_read_b128 v[136:139], v27 offset:2944
    s_mov_b64 exec, -1
    s_cmp_eq_u32 s80, s94
    s_addc_u32 s80, s80, 0
    v_exp_f32 v84, v84
    v_exp_f32 v85, v85
    v_exp_f32 v86, v86
    v_exp_f32 v87, v87
    v_smfmac_f32_32x32x32_bf16 v[28:43], v[124:127], v[76:83], v24
    s_waitcnt lgkmcnt(2)
    v_lshrrev_b32 v5, 3, v0
    v_lshlrev_b32 v5, 7, v5
    v_lshl_add_u32 v5, v0, 4, v5
    s_cmp_eq_u32 s58, 0
    s_cselect_b32 s15, s0, s22
    s_cselect_b32 s16, s1, s22
    v_exp_f32 v88, v88
    v_exp_f32 v89, v89
    v_exp_f32 v90, v90
    v_exp_f32 v91, v91
    v_mfma_f32_32x32x16_bf16 v[60:75], v[112:115], v[8:11], 0
    v_exp_f32 v92, v92
    v_exp_f32 v93, v93
    v_exp_f32 v94, v94
    v_exp_f32 v95, v95
    v_mfma_f32_32x32x8_bf16 v[60:75], v[118:119], v[18:19], v[60:75]
    v_exp_f32 v96, v96
    v_exp_f32 v97, v97
    v_exp_f32 v98, v98
    v_exp_f32 v99, v99
    v_smfmac_f32_32x32x32_bf16 v[28:43], v[128:131], v[84:91], v24
    v_exp_f32 v100, v100
    v_exp_f32 v101, v101
    v_exp_f32 v102, v102
    v_exp_f32 v103, v103
    v_smfmac_f32_32x32x32_bf16 v[44:59], v[124:127], v[92:99], v24
    s_waitcnt lgkmcnt(0)
    buffer_store_dwordx4 v[140:143], v5, s[20:23], s15 offen sc1
    s_add_u32 s15, s15, 16384
    s_cmp_gt_u32 s3, 1
    s_cselect_b32 s15, s22, s15
    v_exp_f32 v104, v104
    v_exp_f32 v105, v105
    v_exp_f32 v106, v106
    v_exp_f32 v107, v107
    v_mfma_f32_32x32x16_bf16 v[76:91], v[112:115], v[12:15], 0
    v_exp_f32 v60, v60
    v_exp_f32 v61, v61
    v_exp_f32 v62, v62
    v_exp_f32 v63, v63
    v_mfma_f32_32x32x8_bf16 v[76:91], v[118:119], v[22:23], v[76:91]
    ds_read_b128 v[108:111], v25 offset:4608
    ds_read_b64 v[120:121], v26 offset:512
    v_exp_f32 v64, v64
    v_exp_f32 v65, v65
    v_exp_f32 v66, v66
    v_exp_f32 v67, v67
    v_smfmac_f32_32x32x32_bf16 v[44:59], v[128:131], v[100:107], v24
    s_mov_b64 exec, s[4:5]
    ds_read_b128 v[124:127], v27 offset:4608
    ds_read_b128 v[128:131], v27 offset:5248
    s_mov_b64 exec, -1
    v_exp_f32 v68, v68
    v_exp_f32 v69, v69
    v_exp_f32 v70, v70
    v_exp_f32 v71, v71
    v_smfmac_f32_32x32x32_bf16 v[28:43], v[132:135], v[60:67], v24
    s_waitcnt lgkmcnt(2)
    s_mov_b32 m0, s8
    s_add_u32 s8, s8, 1024
    buffer_load_dwordx4 v4, s[20:23], s9 offen sc1 lds
    s_add_u32 s9, s9, 1024
    v_exp_f32 v72, v72
    v_exp_f32 v73, v73
    v_exp_f32 v74, v74
    v_exp_f32 v75, v75
    v_mfma_f32_32x32x16_bf16 v[92:107], v[108:111], v[8:11], 0
    s_setprio 2
    v_exp_f32 v76, v76
    v_exp_f32 v77, v77
    v_exp_f32 v78, v78
    v_exp_f32 v79, v79
    v_mfma_f32_32x32x8_bf16 v[92:107], v[120:121], v[16:17], v[92:107]
    v_exp_f32 v80, v80
    v_exp_f32 v81, v81
    v_exp_f32 v82, v82
    v_exp_f32 v83, v83
    v_smfmac_f32_32x32x32_bf16 v[28:43], v[136:139], v[68:75], v24
    v_exp_f32 v84, v84
    v_exp_f32 v85, v85
    v_exp_f32 v86, v86
    v_exp_f32 v87, v87
    v_smfmac_f32_32x32x32_bf16 v[44:59], v[132:135], v[76:83], v24
    s_waitcnt lgkmcnt(0)
    s_mov_b32 m0, s8
    s_add_u32 s8, s8, 1024
    buffer_load_dwordx4 v4, s[20:23], s9 offen sc1 lds
    s_add_u32 s9, s9, 1024
    v_exp_f32 v88, v88
    v_exp_f32 v89, v89
    v_exp_f32 v90, v90
    v_exp_f32 v91, v91
    v_mfma_f32_32x32x16_bf16 v[60:75], v[108:111], v[12:15], 0
    v_exp_f32 v92, v92
    v_exp_f32 v93, v93
    v_exp_f32 v94, v94
    v_exp_f32 v95, v95
    v_mfma_f32_32x32x8_bf16 v[60:75], v[120:121], v[20:21], v[60:75]
    ds_read_b128 v[112:115], v25 offset:6912
    v_exp_f32 v96, v96
    v_exp_f32 v97, v97
    v_exp_f32 v98, v98
    v_exp_f32 v99, v99
    v_smfmac_f32_32x32x32_bf16 v[44:59], v[136:139], v[84:91], v24
    s_mov_b64 exec, s[4:5]
    ds_read_b128 v[132:135], v27 offset:6912
    ds_read_b128 v[136:139], v27 offset:7552
    s_mov_b64 exec, -1
    v_exp_f32 v100, v100
    v_exp_f32 v101, v101
    v_exp_f32 v102, v102
    v_exp_f32 v103, v103
    v_smfmac_f32_32x32x32_bf16 v[28:43], v[124:127], v[92:99], v24
    s_waitcnt lgkmcnt(2)
    buffer_store_dwordx4 v[140:143], v5, s[20:23], s15 offen sc1
    v_exp_f32 v104, v104
    v_exp_f32 v105, v105
    v_exp_f32 v106, v106
    v_exp_f32 v107, v107
    v_mfma_f32_32x32x16_bf16 v[76:91], v[112:115], v[8:11], 0
    s_setprio 1
    v_exp_f32 v60, v60
    v_exp_f32 v61, v61
    v_exp_f32 v62, v62
    v_exp_f32 v63, v63
    v_mfma_f32_32x32x8_bf16 v[76:91], v[120:121], v[18:19], v[76:91]
    v_exp_f32 v64, v64
    v_exp_f32 v65, v65
    v_exp_f32 v66, v66
    v_exp_f32 v67, v67
    v_smfmac_f32_32x32x32_bf16 v[28:43], v[128:131], v[100:107], v24
    v_exp_f32 v68, v68
    v_exp_f32 v69, v69
    v_exp_f32 v70, v70
    v_exp_f32 v71, v71
    v_smfmac_f32_32x32x32_bf16 v[44:59], v[124:127], v[60:67], v24
    s_waitcnt lgkmcnt(0)
    s_setprio 0
    v_exp_f32 v72, v72
    v_exp_f32 v73, v73
    v_exp_f32 v74, v74
    v_exp_f32 v75, v75
    v_mfma_f32_32x32x16_bf16 v[92:107], v[112:115], v[12:15], 0
    s_waitcnt vmcnt(11) lgkmcnt(0)
    s_barrier
    s_setprio 3
    v_exp_f32 v76, v76
    v_exp_f32 v77, v77
    v_exp_f32 v78, v78
    v_exp_f32 v79, v79
    v_mfma_f32_32x32x8_bf16 v[92:107], v[120:121], v[22:23], v[92:107]
    ds_read_b128 v[108:111], v25 offset:20480
    ds_read_b64 v[116:117], v26 offset:20480
    v_exp_f32 v80, v80
    v_exp_f32 v81, v81
    v_exp_f32 v82, v82
    v_exp_f32 v83, v83
    v_smfmac_f32_32x32x32_bf16 v[44:59], v[128:131], v[68:75], v24
    s_mov_b64 exec, s[4:5]
    ds_read_b128 v[124:127], v27 offset:20480
    ds_read_b128 v[128:131], v27 offset:21120
    s_mov_b64 exec, -1
    v_exp_f32 v84, v84
    v_exp_f32 v85, v85
    v_exp_f32 v86, v86
    v_exp_f32 v87, v87
    v_smfmac_f32_32x32x32_bf16 v[28:43], v[132:135], v[76:83], v24
    s_waitcnt lgkmcnt(2)
    v_exp_f32 v88, v88
    v_exp_f32 v89, v89
    v_exp_f32 v90, v90
    v_exp_f32 v91, v91
    v_mfma_f32_32x32x16_bf16 v[60:75], v[108:111], v[8:11], 0
    v_exp_f32 v92, v92
    v_exp_f32 v93, v93
    v_exp_f32 v94, v94
    v_exp_f32 v95, v95
    v_mfma_f32_32x32x8_bf16 v[60:75], v[116:117], v[16:17], v[60:75]
    v_exp_f32 v96, v96
    v_exp_f32 v97, v97
    v_exp_f32 v98, v98
    v_exp_f32 v99, v99
    v_smfmac_f32_32x32x32_bf16 v[28:43], v[136:139], v[84:91], v24
    v_exp_f32 v100, v100
    v_exp_f32 v101, v101
    v_exp_f32 v102, v102
    v_exp_f32 v103, v103
    v_smfmac_f32_32x32x32_bf16 v[44:59], v[132:135], v[92:99], v24
    s_waitcnt lgkmcnt(0)
    v_exp_f32 v104, v104
    v_exp_f32 v105, v105
    v_exp_f32 v106, v106
    v_exp_f32 v107, v107
    v_mfma_f32_32x32x16_bf16 v[76:91], v[108:111], v[12:15], 0
    v_exp_f32 v60, v60
    v_exp_f32 v61, v61
    v_exp_f32 v62, v62
    v_exp_f32 v63, v63
    v_mfma_f32_32x32x8_bf16 v[76:91], v[116:117], v[20:21], v[76:91]
    ds_read_b128 v[112:115], v25 offset:22784
    v_exp_f32 v64, v64
    v_exp_f32 v65, v65
    v_exp_f32 v66, v66
    v_exp_f32 v67, v67
    v_smfmac_f32_32x32x32_bf16 v[44:59], v[136:139], v[100:107], v24
    s_mov_b64 exec, s[4:5]
    ds_read_b128 v[132:135], v27 offset:22784
    ds_read_b128 v[136:139], v27 offset:23424
    s_mov_b64 exec, -1
    v_exp_f32 v68, v68
    v_exp_f32 v69, v69
    v_exp_f32 v70, v70
    v_exp_f32 v71, v71
    v_smfmac_f32_32x32x32_bf16 v[28:43], v[124:127], v[60:67], v24
    s_waitcnt lgkmcnt(2)
    buffer_store_dwordx4 v[140:143], v4, s[20:23], s16 offen sc1
    s_add_u32 s16, s16, 163840
    v_exp_f32 v72, v72
    v_exp_f32 v73, v73
    v_exp_f32 v74, v74
    v_exp_f32 v75, v75
    v_mfma_f32_32x32x16_bf16 v[92:107], v[112:115], v[8:11], 0
    v_exp_f32 v76, v76
    v_exp_f32 v77, v77
    v_exp_f32 v78, v78
    v_exp_f32 v79, v79
    v_mfma_f32_32x32x8_bf16 v[92:107], v[116:117], v[18:19], v[92:107]
    v_exp_f32 v80, v80
    v_exp_f32 v81, v81
    v_exp_f32 v82, v82
    v_exp_f32 v83, v83
    v_smfmac_f32_32x32x32_bf16 v[28:43], v[128:131], v[68:75], v24
    v_exp_f32 v84, v84
    v_exp_f32 v85, v85
    v_exp_f32 v86, v86
    v_exp_f32 v87, v87
    v_smfmac_f32_32x32x32_bf16 v[44:59], v[124:127], v[76:83], v24
    s_waitcnt lgkmcnt(0)
    buffer_store_dwordx4 v[140:143], v4, s[20:23], s16 offen sc1
    v_exp_f32 v88, v88
    v_exp_f32 v89, v89
    v_exp_f32 v90, v90
    v_exp_f32 v91, v91
    v_mfma_f32_32x32x16_bf16 v[60:75], v[112:115], v[12:15], 0
    v_exp_f32 v92, v92
    v_exp_f32 v93, v93
    v_exp_f32 v94, v94
    v_exp_f32 v95, v95
    v_mfma_f32_32x32x8_bf16 v[60:75], v[116:117], v[22:23], v[60:75]
    ds_read_b128 v[108:111], v25 offset:25088
    ds_read_b64 v[118:119], v26 offset:20992
    v_exp_f32 v96, v96
    v_exp_f32 v97, v97
    v_exp_f32 v98, v98
    v_exp_f32 v99, v99
    v_smfmac_f32_32x32x32_bf16 v[44:59], v[128:131], v[84:91], v24
    s_mov_b64 exec, s[4:5]
    ds_read_b128 v[124:127], v27 offset:25088
    ds_read_b128 v[128:131], v27 offset:25728
    s_mov_b64 exec, -1
    v_exp_f32 v100, v100
    v_exp_f32 v101, v101
    v_exp_f32 v102, v102
    v_exp_f32 v103, v103
    v_smfmac_f32_32x32x32_bf16 v[28:43], v[132:135], v[92:99], v24
    s_waitcnt lgkmcnt(2)
    s_mov_b32 m0, s8
    s_add_u32 s8, s8, 1024
    buffer_load_dwordx4 v4, s[20:23], s9 offen sc1 lds
    s_add_u32 s9, s9, 1024
    v_exp_f32 v104, v104
    v_exp_f32 v105, v105
    v_exp_f32 v106, v106
    v_exp_f32 v107, v107
    v_mfma_f32_32x32x16_bf16 v[76:91], v[108:111], v[8:11], 0
    s_setprio 2
    v_exp_f32 v60, v60
    v_exp_f32 v61, v61
    v_exp_f32 v62, v62
    v_exp_f32 v63, v63
    v_mfma_f32_32x32x8_bf16 v[76:91], v[118:119], v[16:17], v[76:91]
    v_exp_f32 v64, v64
    v_exp_f32 v65, v65
    v_exp_f32 v66, v66
    v_exp_f32 v67, v67
    v_smfmac_f32_32x32x32_bf16 v[28:43], v[136:139], v[100:107], v24
    v_exp_f32 v68, v68
    v_exp_f32 v69, v69
    v_exp_f32 v70, v70
    v_exp_f32 v71, v71
    v_smfmac_f32_32x32x32_bf16 v[44:59], v[132:135], v[60:67], v24
    s_waitcnt lgkmcnt(0)
    s_mov_b32 m0, s8
    s_add_u32 s8, s8, 1024
    buffer_load_dwordx4 v4, s[20:23], s9 offen sc1 lds
    s_add_u32 s9, s9, 1024
    v_exp_f32 v72, v72
    v_exp_f32 v73, v73
    v_exp_f32 v74, v74
    v_exp_f32 v75, v75
    v_mfma_f32_32x32x16_bf16 v[92:107], v[108:111], v[12:15], 0
    v_exp_f32 v76, v76
    v_exp_f32 v77, v77
    v_exp_f32 v78, v78
    v_exp_f32 v79, v79
    v_mfma_f32_32x32x8_bf16 v[92:107], v[118:119], v[20:21], v[92:107]
    ds_read_b128 v[112:115], v25 offset:27392
    v_exp_f32 v80, v80
    v_exp_f32 v81, v81
    v_exp_f32 v82, v82
    v_exp_f32 v83, v83
    v_smfmac_f32_32x32x32_bf16 v[44:59], v[136:139], v[68:75], v24
    s_mov_b64 exec, s[4:5]
    ds_read_b128 v[132:135], v27 offset:27392
    ds_read_b128 v[136:139], v27 offset:28032
    s_mov_b64 exec, -1
    v_exp_f32 v84, v84
    v_exp_f32 v85, v85
    v_exp_f32 v86, v86
    v_exp_f32 v87, v87
    v_smfmac_f32_32x32x32_bf16 v[28:43], v[124:127], v[76:83], v24
    s_waitcnt lgkmcnt(2)
    v_exp_f32 v88, v88
    v_exp_f32 v89, v89
    v_exp_f32 v90, v90
    v_exp_f32 v91, v91
    v_mfma_f32_32x32x16_bf16 v[60:75], v[112:115], v[8:11], 0
    s_setprio 1
    v_exp_f32 v92, v92
    v_exp_f32 v93, v93
    v_exp_f32 v94, v94
    v_exp_f32 v95, v95
    v_mfma_f32_32x32x8_bf16 v[60:75], v[118:119], v[18:19], v[60:75]
    v_exp_f32 v96, v96
    v_exp_f32 v97, v97
    v_exp_f32 v98, v98
    v_exp_f32 v99, v99
    v_smfmac_f32_32x32x32_bf16 v[28:43], v[128:131], v[84:91], v24
    v_exp_f32 v100, v100
    v_exp_f32 v101, v101
    v_exp_f32 v102, v102
    v_exp_f32 v103, v103
    v_smfmac_f32_32x32x32_bf16 v[44:59], v[124:127], v[92:99], v24
    s_waitcnt lgkmcnt(0)
    s_setprio 0
    v_exp_f32 v104, v104
    v_exp_f32 v105, v105
    v_exp_f32 v106, v106
    v_exp_f32 v107, v107
    v_mfma_f32_32x32x16_bf16 v[76:91], v[112:115], v[12:15], 0
    s_waitcnt vmcnt(8) lgkmcnt(0)
    s_barrier
    s_setprio 3
    v_exp_f32 v60, v60
    v_exp_f32 v61, v61
    v_exp_f32 v62, v62
    v_exp_f32 v63, v63
    v_mfma_f32_32x32x8_bf16 v[76:91], v[118:119], v[22:23], v[76:91]
    ds_read_b128 v[108:111], v25 offset:40960
    ds_read_b64 v[120:121], v26 offset:40960
    v_exp_f32 v64, v64
    v_exp_f32 v65, v65
    v_exp_f32 v66, v66
    v_exp_f32 v67, v67
    v_smfmac_f32_32x32x32_bf16 v[44:59], v[128:131], v[100:107], v24
    s_mov_b64 exec, s[4:5]
    ds_read_b128 v[124:127], v27 offset:40960
    ds_read_b128 v[128:131], v27 offset:41600
    s_mov_b64 exec, -1
    v_exp_f32 v68, v68
    v_exp_f32 v69, v69
    v_exp_f32 v70, v70
    v_exp_f32 v71, v71
    v_smfmac_f32_32x32x32_bf16 v[28:43], v[132:135], v[60:67], v24
    s_waitcnt lgkmcnt(2)
    v_exp_f32 v72, v72
    v_exp_f32 v73, v73
    v_exp_f32 v74, v74
    v_exp_f32 v75, v75
    v_mfma_f32_32x32x16_bf16 v[92:107], v[108:111], v[8:11], 0
    v_exp_f32 v76, v76
    v_exp_f32 v77, v77
    v_exp_f32 v78, v78
    v_exp_f32 v79, v79
    v_mfma_f32_32x32x8_bf16 v[92:107], v[120:121], v[16:17], v[92:107]
    v_exp_f32 v80, v80
    v_exp_f32 v81, v81
    v_exp_f32 v82, v82
    v_exp_f32 v83, v83
    v_smfmac_f32_32x32x32_bf16 v[28:43], v[136:139], v[68:75], v24
    v_exp_f32 v84, v84
    v_exp_f32 v85, v85
    v_exp_f32 v86, v86
    v_exp_f32 v87, v87
    v_smfmac_f32_32x32x32_bf16 v[44:59], v[132:135], v[76:83], v24
    s_waitcnt lgkmcnt(0)
    v_exp_f32 v88, v88
    v_exp_f32 v89, v89
    v_exp_f32 v90, v90
    v_exp_f32 v91, v91
    v_mfma_f32_32x32x16_bf16 v[60:75], v[108:111], v[12:15], 0
    v_exp_f32 v92, v92
    v_exp_f32 v93, v93
    v_exp_f32 v94, v94
    v_exp_f32 v95, v95
    v_mfma_f32_32x32x8_bf16 v[60:75], v[120:121], v[20:21], v[60:75]
    ds_read_b128 v[112:115], v25 offset:43264
    v_exp_f32 v96, v96
    v_exp_f32 v97, v97
    v_exp_f32 v98, v98
    v_exp_f32 v99, v99
    v_smfmac_f32_32x32x32_bf16 v[44:59], v[136:139], v[84:91], v24
    s_mov_b64 exec, s[4:5]
    ds_read_b128 v[132:135], v27 offset:43264
    ds_read_b128 v[136:139], v27 offset:43904
    s_mov_b64 exec, -1
    v_exp_f32 v100, v100
    v_exp_f32 v101, v101
    v_exp_f32 v102, v102
    v_exp_f32 v103, v103
    v_smfmac_f32_32x32x32_bf16 v[28:43], v[124:127], v[92:99], v24
    s_waitcnt lgkmcnt(2)
    v_exp_f32 v104, v104
    v_exp_f32 v105, v105
    v_exp_f32 v106, v106
    v_exp_f32 v107, v107
    v_mfma_f32_32x32x16_bf16 v[76:91], v[112:115], v[8:11], 0
    v_exp_f32 v60, v60
    v_exp_f32 v61, v61
    v_exp_f32 v62, v62
    v_exp_f32 v63, v63
    v_mfma_f32_32x32x8_bf16 v[76:91], v[120:121], v[18:19], v[76:91]
    v_exp_f32 v64, v64
    v_exp_f32 v65, v65
    v_exp_f32 v66, v66
    v_exp_f32 v67, v67
    v_smfmac_f32_32x32x32_bf16 v[28:43], v[128:131], v[100:107], v24
    v_exp_f32 v68, v68
    v_exp_f32 v69, v69
    v_exp_f32 v70, v70
    v_exp_f32 v71, v71
    v_smfmac_f32_32x32x32_bf16 v[44:59], v[124:127], v[60:67], v24
    s_waitcnt lgkmcnt(0)
    v_exp_f32 v72, v72
    v_exp_f32 v73, v73
    v_exp_f32 v74, v74
    v_exp_f32 v75, v75
    v_mfma_f32_32x32x16_bf16 v[92:107], v[112:115], v[12:15], 0
    v_exp_f32 v76, v76
    v_exp_f32 v77, v77
    v_exp_f32 v78, v78
    v_exp_f32 v79, v79
    v_mfma_f32_32x32x8_bf16 v[92:107], v[120:121], v[22:23], v[92:107]
    ds_read_b128 v[108:111], v25 offset:45568
    ds_read_b64 v[116:117], v26 offset:41472
    v_exp_f32 v80, v80
    v_exp_f32 v81, v81
    v_exp_f32 v82, v82
    v_exp_f32 v83, v83
    v_smfmac_f32_32x32x32_bf16 v[44:59], v[128:131], v[68:75], v24
    s_mov_b64 exec, s[4:5]
    ds_read_b128 v[124:127], v27 offset:45568
    ds_read_b128 v[128:131], v27 offset:46208
    s_mov_b64 exec, -1
    v_exp_f32 v84, v84
    v_exp_f32 v85, v85
    v_exp_f32 v86, v86
    v_exp_f32 v87, v87
    v_smfmac_f32_32x32x32_bf16 v[28:43], v[132:135], v[76:83], v24
    s_waitcnt lgkmcnt(2)
    s_mov_b32 m0, s8
    s_add_u32 s8, s8, 512
    s_mov_b32 exec_hi, 0
    buffer_load_dwordx4 v4, s[20:23], s9 offen sc1 lds
    s_mov_b32 exec_hi, -1
    s_add_u32 s9, s9, 512
    v_exp_f32 v88, v88
    v_exp_f32 v89, v89
    v_exp_f32 v90, v90
    v_exp_f32 v91, v91
    v_mfma_f32_32x32x16_bf16 v[60:75], v[108:111], v[8:11], 0
    s_setprio 2
    v_exp_f32 v92, v92
    v_exp_f32 v93, v93
    v_exp_f32 v94, v94
    v_exp_f32 v95, v95
    v_mfma_f32_32x32x8_bf16 v[60:75], v[116:117], v[16:17], v[60:75]
    v_exp_f32 v96, v96
    v_exp_f32 v97, v97
    v_exp_f32 v98, v98
    v_exp_f32 v99, v99
    v_smfmac_f32_32x32x32_bf16 v[28:43], v[136:139], v[84:91], v24
    v_exp_f32 v100, v100
    v_exp_f32 v101, v101
    v_exp_f32 v102, v102
    v_exp_f32 v103, v103
    v_smfmac_f32_32x32x32_bf16 v[44:59], v[132:135], v[92:99], v24
    s_waitcnt lgkmcnt(0)
    v_exp_f32 v104, v104
    v_exp_f32 v105, v105
    v_exp_f32 v106, v106
    v_exp_f32 v107, v107
    v_mfma_f32_32x32x16_bf16 v[76:91], v[108:111], v[12:15], 0
    v_exp_f32 v60, v60
    v_exp_f32 v61, v61
    v_exp_f32 v62, v62
    v_exp_f32 v63, v63
    v_mfma_f32_32x32x8_bf16 v[76:91], v[116:117], v[20:21], v[76:91]
    ds_read_b128 v[112:115], v25 offset:47872
    v_exp_f32 v64, v64
    v_exp_f32 v65, v65
    v_exp_f32 v66, v66
    v_exp_f32 v67, v67
    v_smfmac_f32_32x32x32_bf16 v[44:59], v[136:139], v[100:107], v24
    s_mov_b64 exec, s[4:5]
    ds_read_b128 v[132:135], v27 offset:47872
    ds_read_b128 v[136:139], v27 offset:48512
    s_mov_b64 exec, -1
    v_exp_f32 v68, v68
    v_exp_f32 v69, v69
    v_exp_f32 v70, v70
    v_exp_f32 v71, v71
    v_smfmac_f32_32x32x32_bf16 v[28:43], v[124:127], v[60:67], v24
    s_waitcnt lgkmcnt(2)
    v_exp_f32 v72, v72
    v_exp_f32 v73, v73
    v_exp_f32 v74, v74
    v_exp_f32 v75, v75
    v_mfma_f32_32x32x16_bf16 v[92:107], v[112:115], v[8:11], 0
    s_setprio 1
    v_exp_f32 v76, v76
    v_exp_f32 v77, v77
    v_exp_f32 v78, v78
    v_exp_f32 v79, v79
    v_mfma_f32_32x32x8_bf16 v[92:107], v[116:117], v[18:19], v[92:107]
    v_exp_f32 v80, v80
    v_exp_f32 v81, v81
    v_exp_f32 v82, v82
    v_exp_f32 v83, v83
    v_smfmac_f32_32x32x32_bf16 v[28:43], v[128:131], v[68:75], v24
    v_exp_f32 v84, v84
    v_exp_f32 v85, v85
    v_exp_f32 v86, v86
    v_exp_f32 v87, v87
    v_smfmac_f32_32x32x32_bf16 v[44:59], v[124:127], v[76:83], v24
    s_waitcnt lgkmcnt(0)
    s_setprio 0
    v_exp_f32 v88, v88
    v_exp_f32 v89, v89
    v_exp_f32 v90, v90
    v_exp_f32 v91, v91
    v_mfma_f32_32x32x16_bf16 v[60:75], v[112:115], v[12:15], 0
    v_exp_f32 v92, v92
    v_exp_f32 v93, v93
    v_exp_f32 v94, v94
    v_exp_f32 v95, v95
    v_mfma_f32_32x32x8_bf16 v[60:75], v[116:117], v[22:23], v[60:75]
    v_exp_f32 v96, v96
    v_exp_f32 v97, v97
    v_exp_f32 v98, v98
    v_exp_f32 v99, v99
    v_smfmac_f32_32x32x32_bf16 v[44:59], v[128:131], v[84:91], v24
    v_exp_f32 v100, v100
    v_exp_f32 v101, v101
    v_exp_f32 v102, v102
    v_exp_f32 v103, v103
    v_smfmac_f32_32x32x32_bf16 v[28:43], v[132:135], v[92:99], v24
    v_exp_f32 v104, v104
    v_exp_f32 v105, v105
    v_exp_f32 v106, v106
    v_exp_f32 v107, v107
    v_exp_f32 v60, v60
    v_exp_f32 v61, v61
    v_exp_f32 v62, v62
    v_exp_f32 v63, v63
    v_exp_f32 v64, v64
    v_exp_f32 v65, v65
    v_exp_f32 v66, v66
    v_exp_f32 v67, v67
    v_smfmac_f32_32x32x32_bf16 v[28:43], v[136:139], v[100:107], v24
    v_exp_f32 v68, v68
    v_exp_f32 v69, v69
    v_exp_f32 v70, v70
    v_exp_f32 v71, v71
    v_smfmac_f32_32x32x32_bf16 v[44:59], v[132:135], v[60:67], v24
    v_exp_f32 v72, v72
    v_exp_f32 v73, v73
    v_exp_f32 v74, v74
    v_exp_f32 v75, v75
    s_nop 1
    v_smfmac_f32_32x32x32_bf16 v[44:59], v[136:139], v[68:75], v24
La_128:
    ds_write_b128 v248, v[28:31] offset:0
    ds_write_b128 v248, v[32:35] offset:1024
    ds_write_b128 v248, v[36:39] offset:2048
    s_setprio 0
    s_lshl_b32 s72, s94, 12
    s_add_u32 s72, s72, s66
    s_add_u32 s72, s72, 98304
    s_lshl_b32 s34, s55, 7
    s_add_u32 s34, s34, s72
    s_waitcnt vmcnt(0) lgkmcnt(0)
    s_barrier
    ds_read_b128 v[84:87], v249 offset:2048
    ds_read_b128 v[76:79], v249 offset:0
    ds_read_b128 v[80:83], v249 offset:1024
    s_cmp_lg_u32 s3, 0
    s_cbranch_scc1 Lsg_152
    v_lshlrev_b32 v5, 7, v1
    v_mov_b32 v6, 1
    s_bfm_b64 exec, 32, 0
    buffer_atomic_add v6, v5, s[20:23], s72 offen sc1
    s_mov_b64 exec, -1
Lsg_152:
    s_waitcnt lgkmcnt(2)
    v_pk_add_f32 v[52:53], v[52:53], v[84:85]
    v_pk_add_f32 v[54:55], v[54:55], v[86:87]
    v_mov_b32 v6, v52
    v_mov_b32 v7, v52
    s_waitcnt lgkmcnt(0)
    v_pk_add_f32 v[44:45], v[44:45], v[76:77]
    v_pk_add_f32 v[46:47], v[46:47], v[78:79]
    v_permlane32_swap_b32 v7, v6
    v_rcp_f32 v6, v6
    v_pk_add_f32 v[48:49], v[48:49], v[80:81]
    v_pk_add_f32 v[50:51], v[50:51], v[82:83]
    v_pk_mul_f32 v[44:45], v[44:45], v[6:7] op_sel_hi:[1,0]
    v_pk_mul_f32 v[46:47], v[46:47], v[6:7] op_sel_hi:[1,0]
    v_pk_mul_f32 v[48:49], v[48:49], v[6:7] op_sel_hi:[1,0]
    v_pk_mul_f32 v[50:51], v[50:51], v[6:7] op_sel_hi:[1,0]
    v_cvt_pk_bf16_f32 v8, v44, v45
    v_cvt_pk_bf16_f32 v9, v46, v47
    v_cvt_pk_bf16_f32 v10, v48, v49
    v_cvt_pk_bf16_f32 v11, v50, v51
    v_min_u32 v8, -2, v8
    v_min_u32 v9, -2, v9
    v_min_u32 v10, -2, v10
    v_min_u32 v11, -2, v11
    buffer_store_dwordx4 v[8:11], v250, s[20:23], s18 offen sc1
    v_pk_mul_f32 v[52:53], v[52:53], v[6:7] op_sel_hi:[1,0]
    v_pk_mul_f32 v[54:55], v[54:55], v[6:7] op_sel_hi:[1,0]
    v_cvt_pk_bf16_f32 v12, v52, v53
    v_cvt_pk_bf16_f32 v13, v54, v55
    v_min_u32 v12, -2, v12
    v_min_u32 v13, -2, v13
    s_mov_b32 exec_hi, 0
    buffer_store_dwordx2 v[12:13], v251, s[20:23], s19 offen sc1
    s_mov_b64 exec, -1
    s_barrier
    s_cmp_lg_u32 s58, 0
    s_cbranch_scc1 Lm_53
    s_cmp_lg_u32 s69, 0
    s_cbranch_scc1 Lm_49
    s_movk_i32 s79, 144
    v_lshrrev_b32 v5, 3, v0
    v_and_b32 v6, 7, v0
    v_lshlrev_b32 v6, 4, v6
    v_mad_u32_u24 v141, v5, s79, v6
    v_lshl_add_u32 v142, v5, 8, v6
    v_add_u32 v141, 133120, v141
    s_cmp_ge_u32 s53, 20
    s_cbranch_scc1 Lm_50
    v_and_b32 v5, 31, v1
    v_lshrrev_b32 v6, 5, v1
    s_mov_b32 s74, s68
Lk_153:
    v_lshl_add_u32 v7, v5, 1, v6
    s_lshl_b32 s72, s74, 3
    v_mul_u32_u24 v8, s72, v7
    s_lshl_b32 s72, s74, 5
    s_sub_u32 s72, s72, 127
    v_lshl_add_u32 v9, v6, 4, s72
    v_mul_u32_u24 v9, v9, v5
    v_lshlrev_b32 v10, 1, v5
    s_cmp_lt_u32 s74, 4
    s_cselect_b64 vcc, -1, 0
    v_cndmask_b32 v8, v9, v8, vcc
    v_cndmask_b32 v7, v10, v7, vcc
    v_cvt_f32_u32 v8, v8
    v_cvt_f32_u32 v7, v7
    v_mul_f32 v60, 0x3c800000, v8
    v_mul_f32 v7, 0x3c800000, v7
    s_lshl_b32 s73, s74, 10
    s_add_u32 s73, s73, 145408
    v_add_f32 v61, v60, v7
    v_add_f32 v62, v61, v7
    v_add_f32 v63, v62, v7
    v_add_f32 v64, v63, v7
    v_add_f32 v65, v64, v7
    v_add_f32 v66, v65, v7
    v_add_f32 v67, v66, v7
    v_sin_f32 v68, v60
    v_cos_f32 v60, v60
    v_sin_f32 v69, v61
    v_cos_f32 v61, v61
    v_sin_f32 v70, v62
    v_cos_f32 v62, v62
    v_sin_f32 v71, v63
    v_cos_f32 v63, v63
    v_sin_f32 v72, v64
    v_cos_f32 v64, v64
    v_sin_f32 v73, v65
    v_cos_f32 v65, v65
    v_sin_f32 v74, v66
    v_cos_f32 v66, v66
    v_sin_f32 v75, v67
    v_cos_f32 v67, v67
    v_add_u32 v9, s73, v4
    v_cvt_pk_bf16_f32 v76, v60, v61
    v_cvt_pk_bf16_f32 v80, v68, v69
    v_cvt_pk_bf16_f32 v77, v62, v63
    v_cvt_pk_bf16_f32 v81, v70, v71
    v_cvt_pk_bf16_f32 v78, v64, v65
    v_cvt_pk_bf16_f32 v82, v72, v73
    v_cvt_pk_bf16_f32 v79, v66, v67
    v_cvt_pk_bf16_f32 v83, v74, v75
    s_add_u32 s74, s74, 4
    s_cmp_lt_u32 s74, 6
    ds_write_b128 v9, v[76:79]
    ds_write_b128 v9, v[80:83] offset:6144
    s_cbranch_scc1 Lk_153
    s_cmp_ge_u32 s53, 20
    s_cbranch_scc1 Lk_154
    s_call_b64 s[70:71], Lcolearly
Lk_154:
Lm_50:
    s_add_u32 s76, s32, 131072
    s_waitcnt lgkmcnt(0)
    s_barrier
    ds_read_b128 v[84:87], v141 offset:0
    ds_read_b128 v[88:91], v141 offset:4608
    ds_read_b128 v[92:95], v141 offset:9216
    s_add_u32 s72, s0, 8192
    s_add_u32 s73, s0, 16384
    s_waitcnt lgkmcnt(2)
    buffer_store_dwordx4 v[84:87], v142, s[20:23], s0 offen sc1
    s_waitcnt lgkmcnt(1)
    buffer_store_dwordx4 v[88:91], v142, s[20:23], s72 offen sc1
    s_cmp_gt_u32 s3, 1
    s_waitcnt lgkmcnt(0)
    s_cbranch_scc1 Le_155
    buffer_store_dwordx4 v[92:95], v142, s[20:23], s73 offen sc1
Le_155:
    s_branch Lm_51
Lm_49:
    s_setprio 2
    v_mov_b32 v19, 0
    s_mov_b64 exec, 1
    buffer_atomic_add v19, v4, s[20:23], s34 offen sc0 sc1
    s_mov_b64 exec, -1
    v_lshlrev_b32 v144, 16, v164
    v_and_b32 v145, 0xffff0000, v164
    v_lshlrev_b32 v146, 16, v165
    v_and_b32 v147, 0xffff0000, v165
    v_lshlrev_b32 v148, 16, v166
    v_and_b32 v149, 0xffff0000, v166
    v_lshlrev_b32 v150, 16, v167
    v_and_b32 v151, 0xffff0000, v167
    v_lshlrev_b32 v152, 16, v168
    v_and_b32 v153, 0xffff0000, v168
    v_lshlrev_b32 v154, 16, v169
    v_and_b32 v155, 0xffff0000, v169
    v_lshlrev_b32 v156, 16, v170
    v_and_b32 v157, 0xffff0000, v170
    v_lshlrev_b32 v158, 16, v171
    v_and_b32 v159, 0xffff0000, v171
    v_lshlrev_b32 v160, 16, v172
    v_and_b32 v161, 0xffff0000, v172
    v_lshlrev_b32 v162, 16, v173
    v_and_b32 v163, 0xffff0000, v173
    s_cmp_ge_u32 s53, 20
    s_cbranch_scc1 Lk_156
    s_call_b64 s[70:71], Lcolearly
Lk_156:
    v_mul_u32_u24 v5, 144, v2
    v_lshl_add_u32 v5, v3, 3, v5
    s_lshl_b32 s72, s68, 5
    s_add_u32 s72, s72, 133120
    v_add_u32 v140, s72, v5
    s_lshl_b32 s72, s56, 6
    s_lshl_b32 s73, s68, 4
    s_add_u32 s72, s72, s73
    v_add_u32 v5, s72, v2
    v_lshlrev_b32 v6, 11, v3
    v_lshl_add_u32 v141, v5, 4, v6
    v_lshl_add_u32 v142, v5, 3, v6
    s_lshl_b32 s72, s54, 17
    s_add_u32 s72, s72, s64
    s_lshl_b32 s73, s54, 15
    s_add_u32 s73, s73, s64
    s_add_u32 s73, s73, 2097152
    s_mov_b32 s78, s72
    s_mov_b32 s79, s73
    v_mov_b32 v120, v144
    v_mov_b32 v121, v145
    v_mov_b32 v122, v146
    v_mov_b32 v123, v147
    v_mov_b32 v124, v148
    v_mov_b32 v125, v149
    v_mov_b32 v126, v150
    v_mov_b32 v127, v151
    v_mov_b32 v128, v152
    v_mov_b32 v129, v153
    v_mov_b32 v130, v154
    v_mov_b32 v131, v155
    v_mov_b32 v132, v156
    v_mov_b32 v133, v157
    v_mov_b32 v134, v158
    v_mov_b32 v135, v159
    v_mov_b32 v136, v160
    v_mov_b32 v137, v161
    v_mov_b32 v138, v162
    v_mov_b32 v139, v163
    s_waitcnt vmcnt(0)
    v_readfirstlane_b32 s74, v19
    s_nop 0
    s_cmp_ge_u32 s74, 32
    s_cbranch_scc1 Lo_157
    v_lshlrev_b32 v5, 7, v1
    s_mov_b32 s88, 65536
    s_mov_b64 exec, 0x1
Lp_158:
    v_mov_b32 v6, 0
    buffer_atomic_add v6, v5, s[20:23], s34 offen sc0 sc1
    s_sub_u32 s88, s88, 1
    s_cbranch_scc1 Ld_159
    s_waitcnt vmcnt(0)
    v_cmpx_gt_u32 vcc, 32, v6
    s_nop 4
    s_cbranch_execnz Lp_158
Ld_159:
    s_waitcnt vmcnt(0)
    s_mov_b64 exec, -1
Lo_157:
    s_mov_b32 s76, s3
    s_add_u32 s77, s32, 131072
    v_lshlrev_b32 v19, 11, v1
    v_mov_b32 v143, 1
    s_mov_b32 s88, 8192
Lo_160:
    buffer_load_dwordx4 v[164:167], v141, s[20:23], s72 offen sc1
    s_add_u32 s72, s72, 8192
    buffer_load_dwordx4 v[168:171], v141, s[20:23], s72 offen sc1
    s_add_u32 s72, s72, 8192
    buffer_load_dwordx4 v[172:175], v141, s[20:23], s72 offen sc1
    s_add_u32 s72, s72, 8192
    buffer_load_dwordx4 v[176:179], v141, s[20:23], s72 offen sc1
    s_add_u32 s72, s72, 8192
    buffer_load_dwordx4 v[180:183], v141, s[20:23], s72 offen sc1
    s_add_u32 s72, s72, 8192
    buffer_load_dwordx4 v[184:187], v141, s[20:23], s72 offen sc1
    s_add_u32 s72, s72, 8192
    buffer_load_dwordx4 v[188:191], v141, s[20:23], s72 offen sc1
    s_add_u32 s72, s72, 8192
    buffer_load_dwordx4 v[192:195], v141, s[20:23], s72 offen sc1
    s_add_u32 s72, s72, 8192
    buffer_load_dwordx4 v[196:199], v141, s[20:23], s72 offen sc1
    s_add_u32 s72, s72, 8192
    buffer_load_dwordx4 v[200:203], v141, s[20:23], s72 offen sc1
    s_add_u32 s72, s72, 8192
    v_add_u32 v6, 0, v4
    v_add_u32 v7, 61440, v4
    ds_read_b128 v[60:63], v6 offset:0
    ds_read_b128 v[64:67], v6 offset:1024
    ds_read_b128 v[68:71], v6 offset:2048
    ds_read_b128 v[72:75], v6 offset:3072
    ds_read_b128 v[76:79], v6 offset:4096
    ds_read_b128 v[80:83], v6 offset:5120
    ds_read_b128 v[84:87], v6 offset:6144
    ds_read_b128 v[88:91], v6 offset:7168
    ds_read_b128 v[92:95], v6 offset:8192
    ds_read_b128 v[96:99], v6 offset:9216
    s_waitcnt vmcnt(9) lgkmcnt(5)
    v_mfma_f32_16x16x32_bf16 v[144:147], v[164:167], v[60:63], v[144:147]
    buffer_load_dwordx4 v[204:207], v141, s[20:23], s72 offen sc1
    s_add_u32 s72, s72, 8192
    ds_read_b128 v[100:103], v6 offset:10240
    v_mfma_f32_16x16x32_bf16 v[148:151], v[164:167], v[64:67], v[148:151]
    ds_read_b128 v[104:107], v6 offset:11264
    v_mfma_f32_16x16x32_bf16 v[152:155], v[164:167], v[68:71], v[152:155]
    ds_read_b128 v[108:111], v6 offset:12288
    v_mfma_f32_16x16x32_bf16 v[156:159], v[164:167], v[72:75], v[156:159]
    ds_read_b128 v[112:115], v6 offset:13312
    v_mfma_f32_16x16x32_bf16 v[160:163], v[164:167], v[76:79], v[160:163]
    ds_read_b128 v[116:119], v6 offset:14336
    s_waitcnt vmcnt(9) lgkmcnt(5)
    v_mfma_f32_16x16x32_bf16 v[144:147], v[168:171], v[80:83], v[144:147]
    buffer_load_dwordx4 v[208:211], v141, s[20:23], s72 offen sc1
    s_add_u32 s72, s72, 8192
    ds_read_b128 v[60:63], v6 offset:15360
    v_mfma_f32_16x16x32_bf16 v[148:151], v[168:171], v[84:87], v[148:151]
    ds_read_b128 v[64:67], v6 offset:16384
    v_mfma_f32_16x16x32_bf16 v[152:155], v[168:171], v[88:91], v[152:155]
    ds_read_b128 v[68:71], v6 offset:17408
    v_mfma_f32_16x16x32_bf16 v[156:159], v[168:171], v[92:95], v[156:159]
    ds_read_b128 v[72:75], v6 offset:18432
    v_mfma_f32_16x16x32_bf16 v[160:163], v[168:171], v[96:99], v[160:163]
    ds_read_b128 v[76:79], v6 offset:19456
    s_waitcnt vmcnt(9) lgkmcnt(5)
    v_mfma_f32_16x16x32_bf16 v[144:147], v[172:175], v[100:103], v[144:147]
    buffer_load_dwordx4 v[212:215], v141, s[20:23], s72 offen sc1
    s_add_u32 s72, s72, 8192
    ds_read_b128 v[80:83], v6 offset:20480
    v_mfma_f32_16x16x32_bf16 v[148:151], v[172:175], v[104:107], v[148:151]
    ds_read_b128 v[84:87], v6 offset:21504
    v_mfma_f32_16x16x32_bf16 v[152:155], v[172:175], v[108:111], v[152:155]
    ds_read_b128 v[88:91], v6 offset:22528
    v_mfma_f32_16x16x32_bf16 v[156:159], v[172:175], v[112:115], v[156:159]
    ds_read_b128 v[92:95], v6 offset:23552
    v_mfma_f32_16x16x32_bf16 v[160:163], v[172:175], v[116:119], v[160:163]
    ds_read_b128 v[96:99], v6 offset:24576
    s_waitcnt vmcnt(9) lgkmcnt(5)
    v_mfma_f32_16x16x32_bf16 v[144:147], v[176:179], v[60:63], v[144:147]
    buffer_load_dwordx4 v[216:219], v141, s[20:23], s72 offen sc1
    s_add_u32 s72, s72, 8192
    ds_read_b128 v[100:103], v6 offset:25600
    v_mfma_f32_16x16x32_bf16 v[148:151], v[176:179], v[64:67], v[148:151]
    ds_read_b128 v[104:107], v6 offset:26624
    v_mfma_f32_16x16x32_bf16 v[152:155], v[176:179], v[68:71], v[152:155]
    ds_read_b128 v[108:111], v6 offset:27648
    v_mfma_f32_16x16x32_bf16 v[156:159], v[176:179], v[72:75], v[156:159]
    ds_read_b128 v[112:115], v6 offset:28672
    v_mfma_f32_16x16x32_bf16 v[160:163], v[176:179], v[76:79], v[160:163]
    ds_read_b128 v[116:119], v6 offset:29696
    s_waitcnt vmcnt(9) lgkmcnt(5)
    v_mfma_f32_16x16x32_bf16 v[144:147], v[180:183], v[80:83], v[144:147]
    buffer_load_dwordx4 v[220:223], v141, s[20:23], s72 offen sc1
    s_add_u32 s72, s72, 8192
    ds_read_b128 v[60:63], v6 offset:30720
    v_mfma_f32_16x16x32_bf16 v[148:151], v[180:183], v[84:87], v[148:151]
    ds_read_b128 v[64:67], v6 offset:31744
    v_mfma_f32_16x16x32_bf16 v[152:155], v[180:183], v[88:91], v[152:155]
    ds_read_b128 v[68:71], v6 offset:32768
    v_mfma_f32_16x16x32_bf16 v[156:159], v[180:183], v[92:95], v[156:159]
    ds_read_b128 v[72:75], v6 offset:33792
    v_mfma_f32_16x16x32_bf16 v[160:163], v[180:183], v[96:99], v[160:163]
    ds_read_b128 v[76:79], v6 offset:34816
    s_waitcnt vmcnt(9) lgkmcnt(5)
    v_mfma_f32_16x16x32_bf16 v[144:147], v[184:187], v[100:103], v[144:147]
    buffer_load_dwordx4 v[224:227], v141, s[20:23], s72 offen sc1
    s_add_u32 s72, s72, 8192
    ds_read_b128 v[80:83], v6 offset:35840
    v_mfma_f32_16x16x32_bf16 v[148:151], v[184:187], v[104:107], v[148:151]
    ds_read_b128 v[84:87], v6 offset:36864
    v_mfma_f32_16x16x32_bf16 v[152:155], v[184:187], v[108:111], v[152:155]
    ds_read_b128 v[88:91], v6 offset:37888
    v_mfma_f32_16x16x32_bf16 v[156:159], v[184:187], v[112:115], v[156:159]
    ds_read_b128 v[92:95], v6 offset:38912
    v_mfma_f32_16x16x32_bf16 v[160:163], v[184:187], v[116:119], v[160:163]
    ds_read_b128 v[96:99], v6 offset:39936
    s_waitcnt vmcnt(9) lgkmcnt(5)
    v_mfma_f32_16x16x32_bf16 v[144:147], v[188:191], v[60:63], v[144:147]
    buffer_load_dwordx2 v[228:229], v142, s[20:23], s73 offen offset:0 sc1
    buffer_load_dwordx2 v[230:231], v142, s[20:23], s73 offen offset:1024 sc1
    s_add_u32 s73, s73, 8192
    ds_read_b128 v[100:103], v6 offset:40960
    v_mfma_f32_16x16x32_bf16 v[148:151], v[188:191], v[64:67], v[148:151]
    ds_read_b128 v[104:107], v6 offset:41984
    v_mfma_f32_16x16x32_bf16 v[152:155], v[188:191], v[68:71], v[152:155]
    ds_read_b128 v[108:111], v6 offset:43008
    v_mfma_f32_16x16x32_bf16 v[156:159], v[188:191], v[72:75], v[156:159]
    ds_read_b128 v[112:115], v6 offset:44032
    v_mfma_f32_16x16x32_bf16 v[160:163], v[188:191], v[76:79], v[160:163]
    ds_read_b128 v[116:119], v6 offset:45056
    s_waitcnt vmcnt(10) lgkmcnt(5)
    v_mfma_f32_16x16x32_bf16 v[144:147], v[192:195], v[80:83], v[144:147]
    buffer_load_dwordx2 v[232:233], v142, s[20:23], s73 offen offset:0 sc1
    buffer_load_dwordx2 v[234:235], v142, s[20:23], s73 offen offset:1024 sc1
    s_add_u32 s73, s73, 8192
    ds_read_b128 v[60:63], v6 offset:46080
    v_mfma_f32_16x16x32_bf16 v[148:151], v[192:195], v[84:87], v[148:151]
    ds_read_b128 v[64:67], v6 offset:47104
    v_mfma_f32_16x16x32_bf16 v[152:155], v[192:195], v[88:91], v[152:155]
    ds_read_b128 v[68:71], v6 offset:48128
    v_mfma_f32_16x16x32_bf16 v[156:159], v[192:195], v[92:95], v[156:159]
    ds_read_b128 v[72:75], v6 offset:49152
    v_mfma_f32_16x16x32_bf16 v[160:163], v[192:195], v[96:99], v[160:163]
    ds_read_b128 v[76:79], v6 offset:50176
    s_waitcnt vmcnt(11) lgkmcnt(5)
    v_mfma_f32_16x16x32_bf16 v[144:147], v[196:199], v[100:103], v[144:147]
    buffer_load_dwordx2 v[236:237], v142, s[20:23], s73 offen offset:0 sc1
    buffer_load_dwordx2 v[238:239], v142, s[20:23], s73 offen offset:1024 sc1
    s_add_u32 s73, s73, 8192
    ds_read_b128 v[80:83], v6 offset:51200
    v_mfma_f32_16x16x32_bf16 v[148:151], v[196:199], v[104:107], v[148:151]
    ds_read_b128 v[84:87], v6 offset:52224
    v_mfma_f32_16x16x32_bf16 v[152:155], v[196:199], v[108:111], v[152:155]
    ds_read_b128 v[88:91], v6 offset:53248
    v_mfma_f32_16x16x32_bf16 v[156:159], v[196:199], v[112:115], v[156:159]
    ds_read_b128 v[92:95], v6 offset:54272
    v_mfma_f32_16x16x32_bf16 v[160:163], v[196:199], v[116:119], v[160:163]
    ds_read_b128 v[96:99], v6 offset:55296
    s_waitcnt vmcnt(12) lgkmcnt(5)
    v_mfma_f32_16x16x32_bf16 v[144:147], v[200:203], v[60:63], v[144:147]
    buffer_load_dwordx2 v[240:241], v142, s[20:23], s73 offen offset:0 sc1
    buffer_load_dwordx2 v[242:243], v142, s[20:23], s73 offen offset:1024 sc1
    s_add_u32 s73, s73, 8192
    ds_read_b128 v[100:103], v6 offset:56320
    v_mfma_f32_16x16x32_bf16 v[148:151], v[200:203], v[64:67], v[148:151]
    ds_read_b128 v[104:107], v6 offset:57344
    v_mfma_f32_16x16x32_bf16 v[152:155], v[200:203], v[68:71], v[152:155]
    ds_read_b128 v[108:111], v6 offset:58368
    v_mfma_f32_16x16x32_bf16 v[156:159], v[200:203], v[72:75], v[156:159]
    ds_read_b128 v[112:115], v6 offset:59392
    v_mfma_f32_16x16x32_bf16 v[160:163], v[200:203], v[76:79], v[160:163]
    ds_read_b128 v[116:119], v6 offset:60416
    s_waitcnt vmcnt(13) lgkmcnt(5)
    v_mfma_f32_16x16x32_bf16 v[144:147], v[204:207], v[80:83], v[144:147]
    ds_read_b128 v[60:63], v7 offset:0
    v_mfma_f32_16x16x32_bf16 v[148:151], v[204:207], v[84:87], v[148:151]
    ds_read_b128 v[64:67], v7 offset:1024
    v_mfma_f32_16x16x32_bf16 v[152:155], v[204:207], v[88:91], v[152:155]
    ds_read_b128 v[68:71], v7 offset:2048
    v_mfma_f32_16x16x32_bf16 v[156:159], v[204:207], v[92:95], v[156:159]
    ds_read_b128 v[72:75], v7 offset:3072
    v_mfma_f32_16x16x32_bf16 v[160:163], v[204:207], v[96:99], v[160:163]
    ds_read_b128 v[76:79], v7 offset:4096
    s_waitcnt vmcnt(12) lgkmcnt(5)
    v_mfma_f32_16x16x32_bf16 v[144:147], v[208:211], v[100:103], v[144:147]
    ds_read_b128 v[80:83], v7 offset:5120
    v_mfma_f32_16x16x32_bf16 v[148:151], v[208:211], v[104:107], v[148:151]
    ds_read_b128 v[84:87], v7 offset:6144
    v_mfma_f32_16x16x32_bf16 v[152:155], v[208:211], v[108:111], v[152:155]
    ds_read_b128 v[88:91], v7 offset:7168
    v_mfma_f32_16x16x32_bf16 v[156:159], v[208:211], v[112:115], v[156:159]
    ds_read_b128 v[92:95], v7 offset:8192
    v_mfma_f32_16x16x32_bf16 v[160:163], v[208:211], v[116:119], v[160:163]
    ds_read_b128 v[96:99], v7 offset:9216
    s_waitcnt vmcnt(11) lgkmcnt(5)
    v_mfma_f32_16x16x32_bf16 v[144:147], v[212:215], v[60:63], v[144:147]
    ds_read_b128 v[100:103], v7 offset:10240
    v_mfma_f32_16x16x32_bf16 v[148:151], v[212:215], v[64:67], v[148:151]
    ds_read_b128 v[104:107], v7 offset:11264
    v_mfma_f32_16x16x32_bf16 v[152:155], v[212:215], v[68:71], v[152:155]
    ds_read_b128 v[108:111], v7 offset:12288
    v_mfma_f32_16x16x32_bf16 v[156:159], v[212:215], v[72:75], v[156:159]
    ds_read_b128 v[112:115], v7 offset:13312
    v_mfma_f32_16x16x32_bf16 v[160:163], v[212:215], v[76:79], v[160:163]
    ds_read_b128 v[116:119], v7 offset:14336
    s_waitcnt vmcnt(10) lgkmcnt(5)
    v_mfma_f32_16x16x32_bf16 v[144:147], v[216:219], v[80:83], v[144:147]
    ds_read_b128 v[60:63], v7 offset:15360
    v_mfma_f32_16x16x32_bf16 v[148:151], v[216:219], v[84:87], v[148:151]
    ds_read_b128 v[64:67], v7 offset:16384
    v_mfma_f32_16x16x32_bf16 v[152:155], v[216:219], v[88:91], v[152:155]
    ds_read_b128 v[68:71], v7 offset:17408
    v_mfma_f32_16x16x32_bf16 v[156:159], v[216:219], v[92:95], v[156:159]
    ds_read_b128 v[72:75], v7 offset:18432
    v_mfma_f32_16x16x32_bf16 v[160:163], v[216:219], v[96:99], v[160:163]
    ds_read_b128 v[76:79], v7 offset:19456
    s_waitcnt vmcnt(9) lgkmcnt(5)
    v_mfma_f32_16x16x32_bf16 v[144:147], v[220:223], v[100:103], v[144:147]
    ds_read_b128 v[80:83], v7 offset:20480
    v_mfma_f32_16x16x32_bf16 v[148:151], v[220:223], v[104:107], v[148:151]
    ds_read_b128 v[84:87], v7 offset:21504
    v_mfma_f32_16x16x32_bf16 v[152:155], v[220:223], v[108:111], v[152:155]
    ds_read_b128 v[88:91], v7 offset:22528
    v_mfma_f32_16x16x32_bf16 v[156:159], v[220:223], v[112:115], v[156:159]
    ds_read_b128 v[92:95], v7 offset:23552
    v_mfma_f32_16x16x32_bf16 v[160:163], v[220:223], v[116:119], v[160:163]
    ds_read_b128 v[96:99], v7 offset:24576
    s_waitcnt vmcnt(8) lgkmcnt(5)
    v_mfma_f32_16x16x32_bf16 v[144:147], v[224:227], v[60:63], v[144:147]
    ds_read_b128 v[100:103], v7 offset:25600
    v_mfma_f32_16x16x32_bf16 v[148:151], v[224:227], v[64:67], v[148:151]
    ds_read_b128 v[104:107], v7 offset:26624
    v_mfma_f32_16x16x32_bf16 v[152:155], v[224:227], v[68:71], v[152:155]
    ds_read_b128 v[108:111], v7 offset:27648
    v_mfma_f32_16x16x32_bf16 v[156:159], v[224:227], v[72:75], v[156:159]
    ds_read_b128 v[112:115], v7 offset:28672
    v_mfma_f32_16x16x32_bf16 v[160:163], v[224:227], v[76:79], v[160:163]
    ds_read_b128 v[116:119], v7 offset:29696
    s_waitcnt vmcnt(6) lgkmcnt(5)
    v_mfma_f32_16x16x32_bf16 v[144:147], v[228:231], v[80:83], v[144:147]
    ds_read_b128 v[60:63], v7 offset:30720
    v_mfma_f32_16x16x32_bf16 v[148:151], v[228:231], v[84:87], v[148:151]
    ds_read_b128 v[64:67], v7 offset:31744
    v_mfma_f32_16x16x32_bf16 v[152:155], v[228:231], v[88:91], v[152:155]
    ds_read_b128 v[68:71], v7 offset:32768
    v_mfma_f32_16x16x32_bf16 v[156:159], v[228:231], v[92:95], v[156:159]
    ds_read_b128 v[72:75], v7 offset:33792
    v_mfma_f32_16x16x32_bf16 v[160:163], v[228:231], v[96:99], v[160:163]
    ds_read_b128 v[76:79], v7 offset:34816
    s_waitcnt vmcnt(4) lgkmcnt(5)
    v_mfma_f32_16x16x32_bf16 v[144:147], v[232:235], v[100:103], v[144:147]
    ds_read_b128 v[80:83], v7 offset:35840
    v_mfma_f32_16x16x32_bf16 v[148:151], v[232:235], v[104:107], v[148:151]
    ds_read_b128 v[84:87], v7 offset:36864
    v_mfma_f32_16x16x32_bf16 v[152:155], v[232:235], v[108:111], v[152:155]
    ds_read_b128 v[88:91], v7 offset:37888
    v_mfma_f32_16x16x32_bf16 v[156:159], v[232:235], v[112:115], v[156:159]
    ds_read_b128 v[92:95], v7 offset:38912
    v_mfma_f32_16x16x32_bf16 v[160:163], v[232:235], v[116:119], v[160:163]
    ds_read_b128 v[96:99], v7 offset:39936
    s_waitcnt vmcnt(2) lgkmcnt(5)
    v_mfma_f32_16x16x32_bf16 v[144:147], v[236:239], v[60:63], v[144:147]
    v_mfma_f32_16x16x32_bf16 v[148:151], v[236:239], v[64:67], v[148:151]
    v_mfma_f32_16x16x32_bf16 v[152:155], v[236:239], v[68:71], v[152:155]
    v_mfma_f32_16x16x32_bf16 v[156:159], v[236:239], v[72:75], v[156:159]
    v_mfma_f32_16x16x32_bf16 v[160:163], v[236:239], v[76:79], v[160:163]
    s_waitcnt vmcnt(0) lgkmcnt(0)
    s_cmp_lg_u32 s76, 4
    s_cbranch_scc1 Lo_163
    s_mov_b64 exec, 0xffff
    buffer_atomic_add v143, v19, s[20:23], s77 offen sc1
    s_mov_b64 exec, -1
    s_mov_b32 s76, 0
Lo_163:
    v_mfma_f32_16x16x32_bf16 v[144:147], v[240:243], v[80:83], v[144:147]
    v_mfma_f32_16x16x32_bf16 v[148:151], v[240:243], v[84:87], v[148:151]
    v_mfma_f32_16x16x32_bf16 v[152:155], v[240:243], v[88:91], v[152:155]
    v_mfma_f32_16x16x32_bf16 v[156:159], v[240:243], v[92:95], v[156:159]
    v_mfma_f32_16x16x32_bf16 v[160:163], v[240:243], v[96:99], v[160:163]
    s_nop 3
    v_cmp_u_f32 vcc, v144, v145
    v_cmp_u_f32 s[74:75], v146, v147
    s_nop 0
    s_or_b64 vcc, vcc, s[74:75]
    s_cbranch_scc1 Lbad_161
Lok_162:
    v_cvt_pk_bf16_f32 v60, v144, v145
    v_cvt_pk_bf16_f32 v61, v146, v147
    v_min_u32 v60, -2, v60
    v_min_u32 v61, -2, v61
    ds_write_b64 v140, v[60:61] offset:0
    v_cvt_pk_bf16_f32 v62, v148, v149
    v_cvt_pk_bf16_f32 v63, v150, v151
    v_min_u32 v62, -2, v62
    v_min_u32 v63, -2, v63
    ds_write_b64 v140, v[62:63] offset:2304
    v_cvt_pk_bf16_f32 v64, v152, v153
    v_cvt_pk_bf16_f32 v65, v154, v155
    v_min_u32 v64, -2, v64
    v_min_u32 v65, -2, v65
    ds_write_b64 v140, v[64:65] offset:4608
    v_cvt_pk_bf16_f32 v66, v156, v157
    v_cvt_pk_bf16_f32 v67, v158, v159
    v_min_u32 v66, -2, v66
    v_min_u32 v67, -2, v67
    ds_write_b64 v140, v[66:67] offset:6912
    v_cvt_pk_bf16_f32 v68, v160, v161
    v_cvt_pk_bf16_f32 v69, v162, v163
    v_min_u32 v68, -2, v68
    v_min_u32 v69, -2, v69
    ds_write_b64 v140, v[68:69] offset:9216
    s_lshl_b32 s85, s54, 11
    s_lshl_b32 s86, s57, 8
    s_add_u32 s85, s85, s86
    s_lshl_b32 s86, s56, 7
    s_add_u32 s85, s85, s86
    s_add_u32 s85, s85, 11599872
    s_waitcnt lgkmcnt(0)
    s_barrier
    s_cmp_eq_u32 s57, 0
    s_cselect_b32 s72, 1, 99
    v_cmp_ne_u32 vcc, s72, v2
    v_pk_mul_f32 v[76:77], v[148:149], v[148:149]
    v_pk_mul_f32 v[78:79], v[150:151], v[150:151]
    v_cndmask_b32 v144, 0, v144, vcc
    v_cndmask_b32 v145, 0, v145, vcc
    v_cndmask_b32 v146, 0, v146, vcc
    v_cndmask_b32 v147, 0, v147, vcc
    v_pk_fma_f32 v[76:77], v[152:153], v[152:153], v[76:77]
    v_pk_fma_f32 v[78:79], v[154:155], v[154:155], v[78:79]
    v_pk_fma_f32 v[76:77], v[156:157], v[156:157], v[76:77]
    v_pk_fma_f32 v[78:79], v[158:159], v[158:159], v[78:79]
    v_pk_fma_f32 v[76:77], v[160:161], v[160:161], v[76:77]
    v_pk_fma_f32 v[78:79], v[162:163], v[162:163], v[78:79]
    v_pk_fma_f32 v[76:77], v[144:145], v[144:145], v[76:77]
    v_pk_fma_f32 v[78:79], v[146:147], v[146:147], v[78:79]
    s_nop 0
    v_add_f32 v76, v76, v76 row_ror:8 row_mask:0xf bank_mask:0xf
    v_add_f32 v77, v77, v77 row_ror:8 row_mask:0xf bank_mask:0xf
    v_add_f32 v78, v78, v78 row_ror:8 row_mask:0xf bank_mask:0xf
    v_add_f32 v79, v79, v79 row_ror:8 row_mask:0xf bank_mask:0xf
    v_add_f32 v76, v76, v76 row_ror:4 row_mask:0xf bank_mask:0xf
    v_add_f32 v77, v77, v77 row_ror:4 row_mask:0xf bank_mask:0xf
    v_add_f32 v78, v78, v78 row_ror:4 row_mask:0xf bank_mask:0xf
    v_add_f32 v79, v79, v79 row_ror:4 row_mask:0xf bank_mask:0xf
    v_add_f32 v76, v76, v76 row_ror:2 row_mask:0xf bank_mask:0xf
    v_add_f32 v77, v77, v77 row_ror:2 row_mask:0xf bank_mask:0xf
    v_add_f32 v78, v78, v78 row_ror:2 row_mask:0xf bank_mask:0xf
    v_add_f32 v79, v79, v79 row_ror:2 row_mask:0xf bank_mask:0xf
    v_add_f32 v76, v76, v76 row_ror:1 row_mask:0xf bank_mask:0xf
    v_add_f32 v77, v77, v77 row_ror:1 row_mask:0xf bank_mask:0xf
    v_add_f32 v78, v78, v78 row_ror:1 row_mask:0xf bank_mask:0xf
    v_add_f32 v79, v79, v79 row_ror:1 row_mask:0xf bank_mask:0xf
    v_cvt_pk_bf16_f32 v76, v76, v77
    v_cvt_pk_bf16_f32 v77, v78, v79
    v_lshlrev_b32 v5, 3, v3
    v_min_u32 v76, -2, v76
    v_min_u32 v77, -2, v77
    s_lshl_b32 s72, s68, 5
    s_add_u32 s72, s72, s85
    s_mov_b32 exec_lo, 0x00010001
    s_mov_b32 exec_hi, 0x00010001
    buffer_store_dwordx2 v[76:77], v5, s[20:23], s72 offen sc1
    s_mov_b64 exec, -1
    s_setprio 0
Lm_51:
    s_mov_b32 s58, 1
    s_mov_b32 s61, 6291456
    s_mov_b32 s62, 8912896
    s_mov_b32 s63, 24608768
    s_mov_b32 s64, 32473088
    s_mov_b32 s65, 11599872
    s_mov_b32 s66, 131072
    s_branch Llayer
Lm_53:
    s_cmp_eq_u32 s69, 0
    s_cbranch_scc1 Lfin
    v_mov_b32 v19, 0
    s_mov_b64 exec, 1
    buffer_atomic_add v19, v4, s[20:23], s34 offen sc0 sc1
    s_mov_b64 exec, -1
    s_mul_i32 s72, s68, 2816
    s_add_u32 s72, s72, 133120
    v_mul_u32_u24 v5, 176, v2
    v_lshl_add_u32 v5, v3, 3, v5
    v_add_u32 v11, s72, v5
    s_and_b32 s73, s54, 7
    s_lshl_b32 s73, s73, 8
    s_lshr_b32 s74, s54, 3
    s_lshl_b32 s74, s74, 4
    s_add_u32 s73, s73, s74
    s_lshl_b32 s74, s56, 3
    s_add_u32 s73, s73, s74
    s_lshl_b32 s74, s68, 1
    s_add_u32 s73, s73, s74
    s_mul_i32 s73, s73, 1280
    s_mul_i32 s74, s57, 160
    s_add_u32 s73, s73, s74
    s_movk_i32 s74, 176
    s_movk_i32 s75, 1280
    v_add_u32 v5, 0, v1
    v_mul_u32_u24 v6, 205, v5
    v_lshrrev_b32 v6, 11, v6
    v_mul_u32_u24 v7, 10, v6
    v_sub_u32 v5, v5, v7
    v_lshlrev_b32 v5, 4, v5
    v_mad_u32_u24 v8, v6, s74, v5
    v_add_u32 v8, s72, v8
    v_and_b32 v7, 7, v6
    v_lshrrev_b32 v6, 3, v6
    v_lshl_add_u32 v6, v7, 5, v6
    v_mad_u32_u24 v12, v6, s75, v5
    v_add_u32 v5, 64, v1
    v_mul_u32_u24 v6, 205, v5
    v_lshrrev_b32 v6, 11, v6
    v_mul_u32_u24 v7, 10, v6
    v_sub_u32 v5, v5, v7
    v_lshlrev_b32 v5, 4, v5
    v_mad_u32_u24 v9, v6, s74, v5
    v_add_u32 v9, s72, v9
    v_and_b32 v7, 7, v6
    v_lshrrev_b32 v6, 3, v6
    v_lshl_add_u32 v6, v7, 5, v6
    v_mad_u32_u24 v13, v6, s75, v5
    v_add_u32 v5, 128, v1
    v_mul_u32_u24 v6, 205, v5
    v_lshrrev_b32 v6, 11, v6
    v_mul_u32_u24 v7, 10, v6
    v_sub_u32 v5, v5, v7
    v_lshlrev_b32 v5, 4, v5
    v_mad_u32_u24 v10, v6, s74, v5
    v_add_u32 v10, s72, v10
    v_and_b32 v7, 7, v6
    v_lshrrev_b32 v6, 3, v6
    v_lshl_add_u32 v6, v7, 5, v6
    v_mad_u32_u24 v14, v6, s75, v5
    s_mov_b32 s77, s73
    s_lshl_b32 s72, s56, 6
    s_lshl_b32 s73, s68, 4
    s_add_u32 s72, s72, s73
    v_add_u32 v5, s72, v2
    v_lshlrev_b32 v6, 11, v3
    v_lshl_add_u32 v141, v5, 4, v6
    v_lshl_add_u32 v142, v5, 3, v6
    s_lshl_b32 s72, s54, 17
    s_add_u32 s72, s72, s64
    s_lshl_b32 s73, s54, 15
    s_add_u32 s73, s73, s64
    s_add_u32 s73, s73, 2097152
    s_mov_b32 s78, s72
    s_mov_b32 s79, s73
    v_mov_b32 v120, v144
    v_mov_b32 v121, v145
    v_mov_b32 v122, v146
    v_mov_b32 v123, v147
    v_mov_b32 v124, v148
    v_mov_b32 v125, v149
    v_mov_b32 v126, v150
    v_mov_b32 v127, v151
    v_mov_b32 v128, v152
    v_mov_b32 v129, v153
    v_mov_b32 v130, v154
    v_mov_b32 v131, v155
    v_mov_b32 v132, v156
    v_mov_b32 v133, v157
    v_mov_b32 v134, v158
    v_mov_b32 v135, v159
    v_mov_b32 v136, v160
    v_mov_b32 v137, v161
    v_mov_b32 v138, v162
    v_mov_b32 v139, v163
    s_waitcnt vmcnt(0)
    v_readfirstlane_b32 s74, v19
    s_nop 0
    s_cmp_ge_u32 s74, 32
    s_cbranch_scc1 Lo_164
    v_lshlrev_b32 v5, 7, v1
    s_mov_b32 s88, 65536
    s_mov_b64 exec, 0x1
Lp_165:
    v_mov_b32 v6, 0
    buffer_atomic_add v6, v5, s[20:23], s34 offen sc0 sc1
    s_sub_u32 s88, s88, 1
    s_cbranch_scc1 Ld_166
    s_waitcnt vmcnt(0)
    v_cmpx_gt_u32 vcc, 32, v6
    s_nop 4
    s_cbranch_execnz Lp_165
Ld_166:
    s_waitcnt vmcnt(0)
    s_mov_b64 exec, -1
Lo_164:
    s_mov_b32 s88, 8192
Lo_167:
    buffer_load_dwordx4 v[164:167], v141, s[20:23], s72 offen sc1
    s_add_u32 s72, s72, 8192
    buffer_load_dwordx4 v[168:171], v141, s[20:23], s72 offen sc1
    s_add_u32 s72, s72, 8192
    buffer_load_dwordx4 v[172:175], v141, s[20:23], s72 offen sc1
    s_add_u32 s72, s72, 8192
    buffer_load_dwordx4 v[176:179], v141, s[20:23], s72 offen sc1
    s_add_u32 s72, s72, 8192
    buffer_load_dwordx4 v[180:183], v141, s[20:23], s72 offen sc1
    s_add_u32 s72, s72, 8192
    buffer_load_dwordx4 v[184:187], v141, s[20:23], s72 offen sc1
    s_add_u32 s72, s72, 8192
    buffer_load_dwordx4 v[188:191], v141, s[20:23], s72 offen sc1
    s_add_u32 s72, s72, 8192
    buffer_load_dwordx4 v[192:195], v141, s[20:23], s72 offen sc1
    s_add_u32 s72, s72, 8192
    buffer_load_dwordx4 v[196:199], v141, s[20:23], s72 offen sc1
    s_add_u32 s72, s72, 8192
    buffer_load_dwordx4 v[200:203], v141, s[20:23], s72 offen sc1
    s_add_u32 s72, s72, 8192
    v_add_u32 v6, 0, v4
    v_add_u32 v7, 61440, v4
    ds_read_b128 v[60:63], v6 offset:0
    ds_read_b128 v[64:67], v6 offset:1024
    ds_read_b128 v[68:71], v6 offset:2048
    ds_read_b128 v[72:75], v6 offset:3072
    ds_read_b128 v[76:79], v6 offset:4096
    ds_read_b128 v[80:83], v6 offset:5120
    ds_read_b128 v[84:87], v6 offset:6144
    ds_read_b128 v[88:91], v6 offset:7168
    ds_read_b128 v[92:95], v6 offset:8192
    ds_read_b128 v[96:99], v6 offset:9216
    s_waitcnt vmcnt(9) lgkmcnt(5)
    v_mfma_f32_16x16x32_bf16 v[144:147], v[60:63], v[164:167], v[144:147]
    buffer_load_dwordx4 v[204:207], v141, s[20:23], s72 offen sc1
    s_add_u32 s72, s72, 8192
    ds_read_b128 v[100:103], v6 offset:10240
    v_mfma_f32_16x16x32_bf16 v[148:151], v[64:67], v[164:167], v[148:151]
    ds_read_b128 v[104:107], v6 offset:11264
    v_mfma_f32_16x16x32_bf16 v[152:155], v[68:71], v[164:167], v[152:155]
    ds_read_b128 v[108:111], v6 offset:12288
    v_mfma_f32_16x16x32_bf16 v[156:159], v[72:75], v[164:167], v[156:159]
    ds_read_b128 v[112:115], v6 offset:13312
    v_mfma_f32_16x16x32_bf16 v[160:163], v[76:79], v[164:167], v[160:163]
    ds_read_b128 v[116:119], v6 offset:14336
    s_waitcnt vmcnt(9) lgkmcnt(5)
    v_mfma_f32_16x16x32_bf16 v[144:147], v[80:83], v[168:171], v[144:147]
    buffer_load_dwordx4 v[208:211], v141, s[20:23], s72 offen sc1
    s_add_u32 s72, s72, 8192
    ds_read_b128 v[60:63], v6 offset:15360
    v_mfma_f32_16x16x32_bf16 v[148:151], v[84:87], v[168:171], v[148:151]
    ds_read_b128 v[64:67], v6 offset:16384
    v_mfma_f32_16x16x32_bf16 v[152:155], v[88:91], v[168:171], v[152:155]
    ds_read_b128 v[68:71], v6 offset:17408
    v_mfma_f32_16x16x32_bf16 v[156:159], v[92:95], v[168:171], v[156:159]
    ds_read_b128 v[72:75], v6 offset:18432
    v_mfma_f32_16x16x32_bf16 v[160:163], v[96:99], v[168:171], v[160:163]
    ds_read_b128 v[76:79], v6 offset:19456
    s_waitcnt vmcnt(9) lgkmcnt(5)
    v_mfma_f32_16x16x32_bf16 v[144:147], v[100:103], v[172:175], v[144:147]
    buffer_load_dwordx4 v[212:215], v141, s[20:23], s72 offen sc1
    s_add_u32 s72, s72, 8192
    ds_read_b128 v[80:83], v6 offset:20480
    v_mfma_f32_16x16x32_bf16 v[148:151], v[104:107], v[172:175], v[148:151]
    ds_read_b128 v[84:87], v6 offset:21504
    v_mfma_f32_16x16x32_bf16 v[152:155], v[108:111], v[172:175], v[152:155]
    ds_read_b128 v[88:91], v6 offset:22528
    v_mfma_f32_16x16x32_bf16 v[156:159], v[112:115], v[172:175], v[156:159]
    ds_read_b128 v[92:95], v6 offset:23552
    v_mfma_f32_16x16x32_bf16 v[160:163], v[116:119], v[172:175], v[160:163]
    ds_read_b128 v[96:99], v6 offset:24576
    s_waitcnt vmcnt(9) lgkmcnt(5)
    v_mfma_f32_16x16x32_bf16 v[144:147], v[60:63], v[176:179], v[144:147]
    buffer_load_dwordx4 v[216:219], v141, s[20:23], s72 offen sc1
    s_add_u32 s72, s72, 8192
    ds_read_b128 v[100:103], v6 offset:25600
    v_mfma_f32_16x16x32_bf16 v[148:151], v[64:67], v[176:179], v[148:151]
    ds_read_b128 v[104:107], v6 offset:26624
    v_mfma_f32_16x16x32_bf16 v[152:155], v[68:71], v[176:179], v[152:155]
    ds_read_b128 v[108:111], v6 offset:27648
    v_mfma_f32_16x16x32_bf16 v[156:159], v[72:75], v[176:179], v[156:159]
    ds_read_b128 v[112:115], v6 offset:28672
    v_mfma_f32_16x16x32_bf16 v[160:163], v[76:79], v[176:179], v[160:163]
    ds_read_b128 v[116:119], v6 offset:29696
    s_waitcnt vmcnt(9) lgkmcnt(5)
    v_mfma_f32_16x16x32_bf16 v[144:147], v[80:83], v[180:183], v[144:147]
    buffer_load_dwordx4 v[220:223], v141, s[20:23], s72 offen sc1
    s_add_u32 s72, s72, 8192
    ds_read_b128 v[60:63], v6 offset:30720
    v_mfma_f32_16x16x32_bf16 v[148:151], v[84:87], v[180:183], v[148:151]
    ds_read_b128 v[64:67], v6 offset:31744
    v_mfma_f32_16x16x32_bf16 v[152:155], v[88:91], v[180:183], v[152:155]
    ds_read_b128 v[68:71], v6 offset:32768
    v_mfma_f32_16x16x32_bf16 v[156:159], v[92:95], v[180:183], v[156:159]
    ds_read_b128 v[72:75], v6 offset:33792
    v_mfma_f32_16x16x32_bf16 v[160:163], v[96:99], v[180:183], v[160:163]
    ds_read_b128 v[76:79], v6 offset:34816
    s_waitcnt vmcnt(9) lgkmcnt(5)
    v_mfma_f32_16x16x32_bf16 v[144:147], v[100:103], v[184:187], v[144:147]
    buffer_load_dwordx4 v[224:227], v141, s[20:23], s72 offen sc1
    s_add_u32 s72, s72, 8192
    ds_read_b128 v[80:83], v6 offset:35840
    v_mfma_f32_16x16x32_bf16 v[148:151], v[104:107], v[184:187], v[148:151]
    ds_read_b128 v[84:87], v6 offset:36864
    v_mfma_f32_16x16x32_bf16 v[152:155], v[108:111], v[184:187], v[152:155]
    ds_read_b128 v[88:91], v6 offset:37888
    v_mfma_f32_16x16x32_bf16 v[156:159], v[112:115], v[184:187], v[156:159]
    ds_read_b128 v[92:95], v6 offset:38912
    v_mfma_f32_16x16x32_bf16 v[160:163], v[116:119], v[184:187], v[160:163]
    ds_read_b128 v[96:99], v6 offset:39936
    s_waitcnt vmcnt(9) lgkmcnt(5)
    v_mfma_f32_16x16x32_bf16 v[144:147], v[60:63], v[188:191], v[144:147]
    buffer_load_dwordx2 v[228:229], v142, s[20:23], s73 offen offset:0 sc1
    buffer_load_dwordx2 v[230:231], v142, s[20:23], s73 offen offset:1024 sc1
    s_add_u32 s73, s73, 8192
    ds_read_b128 v[100:103], v6 offset:40960
    v_mfma_f32_16x16x32_bf16 v[148:151], v[64:67], v[188:191], v[148:151]
    ds_read_b128 v[104:107], v6 offset:41984
    v_mfma_f32_16x16x32_bf16 v[152:155], v[68:71], v[188:191], v[152:155]
    ds_read_b128 v[108:111], v6 offset:43008
    v_mfma_f32_16x16x32_bf16 v[156:159], v[72:75], v[188:191], v[156:159]
    ds_read_b128 v[112:115], v6 offset:44032
    v_mfma_f32_16x16x32_bf16 v[160:163], v[76:79], v[188:191], v[160:163]
    ds_read_b128 v[116:119], v6 offset:45056
    s_waitcnt vmcnt(10) lgkmcnt(5)
    v_mfma_f32_16x16x32_bf16 v[144:147], v[80:83], v[192:195], v[144:147]
    buffer_load_dwordx2 v[232:233], v142, s[20:23], s73 offen offset:0 sc1
    buffer_load_dwordx2 v[234:235], v142, s[20:23], s73 offen offset:1024 sc1
    s_add_u32 s73, s73, 8192
    ds_read_b128 v[60:63], v6 offset:46080
    v_mfma_f32_16x16x32_bf16 v[148:151], v[84:87], v[192:195], v[148:151]
    ds_read_b128 v[64:67], v6 offset:47104
    v_mfma_f32_16x16x32_bf16 v[152:155], v[88:91], v[192:195], v[152:155]
    ds_read_b128 v[68:71], v6 offset:48128
    v_mfma_f32_16x16x32_bf16 v[156:159], v[92:95], v[192:195], v[156:159]
    ds_read_b128 v[72:75], v6 offset:49152
    v_mfma_f32_16x16x32_bf16 v[160:163], v[96:99], v[192:195], v[160:163]
    ds_read_b128 v[76:79], v6 offset:50176
    s_waitcnt vmcnt(11) lgkmcnt(5)
    v_mfma_f32_16x16x32_bf16 v[144:147], v[100:103], v[196:199], v[144:147]
    buffer_load_dwordx2 v[236:237], v142, s[20:23], s73 offen offset:0 sc1
    buffer_load_dwordx2 v[238:239], v142, s[20:23], s73 offen offset:1024 sc1
    s_add_u32 s73, s73, 8192
    ds_read_b128 v[80:83], v6 offset:51200
    v_mfma_f32_16x16x32_bf16 v[148:151], v[104:107], v[196:199], v[148:151]
    ds_read_b128 v[84:87], v6 offset:52224
    v_mfma_f32_16x16x32_bf16 v[152:155], v[108:111], v[196:199], v[152:155]
    ds_read_b128 v[88:91], v6 offset:53248
    v_mfma_f32_16x16x32_bf16 v[156:159], v[112:115], v[196:199], v[156:159]
    ds_read_b128 v[92:95], v6 offset:54272
    v_mfma_f32_16x16x32_bf16 v[160:163], v[116:119], v[196:199], v[160:163]
    ds_read_b128 v[96:99], v6 offset:55296
    s_waitcnt vmcnt(12) lgkmcnt(5)
    v_mfma_f32_16x16x32_bf16 v[144:147], v[60:63], v[200:203], v[144:147]
    buffer_load_dwordx2 v[240:241], v142, s[20:23], s73 offen offset:0 sc1
    buffer_load_dwordx2 v[242:243], v142, s[20:23], s73 offen offset:1024 sc1
    s_add_u32 s73, s73, 8192
    ds_read_b128 v[100:103], v6 offset:56320
    v_mfma_f32_16x16x32_bf16 v[148:151], v[64:67], v[200:203], v[148:151]
    ds_read_b128 v[104:107], v6 offset:57344
    v_mfma_f32_16x16x32_bf16 v[152:155], v[68:71], v[200:203], v[152:155]
    ds_read_b128 v[108:111], v6 offset:58368
    v_mfma_f32_16x16x32_bf16 v[156:159], v[72:75], v[200:203], v[156:159]
    ds_read_b128 v[112:115], v6 offset:59392
    v_mfma_f32_16x16x32_bf16 v[160:163], v[76:79], v[200:203], v[160:163]
    ds_read_b128 v[116:119], v6 offset:60416
    s_waitcnt vmcnt(13) lgkmcnt(5)
    v_mfma_f32_16x16x32_bf16 v[144:147], v[80:83], v[204:207], v[144:147]
    ds_read_b128 v[60:63], v7 offset:0
    v_mfma_f32_16x16x32_bf16 v[148:151], v[84:87], v[204:207], v[148:151]
    ds_read_b128 v[64:67], v7 offset:1024
    v_mfma_f32_16x16x32_bf16 v[152:155], v[88:91], v[204:207], v[152:155]
    ds_read_b128 v[68:71], v7 offset:2048
    v_mfma_f32_16x16x32_bf16 v[156:159], v[92:95], v[204:207], v[156:159]
    ds_read_b128 v[72:75], v7 offset:3072
    v_mfma_f32_16x16x32_bf16 v[160:163], v[96:99], v[204:207], v[160:163]
    ds_read_b128 v[76:79], v7 offset:4096
    s_waitcnt vmcnt(12) lgkmcnt(5)
    v_mfma_f32_16x16x32_bf16 v[144:147], v[100:103], v[208:211], v[144:147]
    ds_read_b128 v[80:83], v7 offset:5120
    v_mfma_f32_16x16x32_bf16 v[148:151], v[104:107], v[208:211], v[148:151]
    ds_read_b128 v[84:87], v7 offset:6144
    v_mfma_f32_16x16x32_bf16 v[152:155], v[108:111], v[208:211], v[152:155]
    ds_read_b128 v[88:91], v7 offset:7168
    v_mfma_f32_16x16x32_bf16 v[156:159], v[112:115], v[208:211], v[156:159]
    ds_read_b128 v[92:95], v7 offset:8192
    v_mfma_f32_16x16x32_bf16 v[160:163], v[116:119], v[208:211], v[160:163]
    ds_read_b128 v[96:99], v7 offset:9216
    s_waitcnt vmcnt(11) lgkmcnt(5)
    v_mfma_f32_16x16x32_bf16 v[144:147], v[60:63], v[212:215], v[144:147]
    ds_read_b128 v[100:103], v7 offset:10240
    v_mfma_f32_16x16x32_bf16 v[148:151], v[64:67], v[212:215], v[148:151]
    ds_read_b128 v[104:107], v7 offset:11264
    v_mfma_f32_16x16x32_bf16 v[152:155], v[68:71], v[212:215], v[152:155]
    ds_read_b128 v[108:111], v7 offset:12288
    v_mfma_f32_16x16x32_bf16 v[156:159], v[72:75], v[212:215], v[156:159]
    ds_read_b128 v[112:115], v7 offset:13312
    v_mfma_f32_16x16x32_bf16 v[160:163], v[76:79], v[212:215], v[160:163]
    ds_read_b128 v[116:119], v7 offset:14336
    s_waitcnt vmcnt(10) lgkmcnt(5)
    v_mfma_f32_16x16x32_bf16 v[144:147], v[80:83], v[216:219], v[144:147]
    ds_read_b128 v[60:63], v7 offset:15360
    v_mfma_f32_16x16x32_bf16 v[148:151], v[84:87], v[216:219], v[148:151]
    ds_read_b128 v[64:67], v7 offset:16384
    v_mfma_f32_16x16x32_bf16 v[152:155], v[88:91], v[216:219], v[152:155]
    ds_read_b128 v[68:71], v7 offset:17408
    v_mfma_f32_16x16x32_bf16 v[156:159], v[92:95], v[216:219], v[156:159]
    ds_read_b128 v[72:75], v7 offset:18432
    v_mfma_f32_16x16x32_bf16 v[160:163], v[96:99], v[216:219], v[160:163]
    ds_read_b128 v[76:79], v7 offset:19456
    s_waitcnt vmcnt(9) lgkmcnt(5)
    v_mfma_f32_16x16x32_bf16 v[144:147], v[100:103], v[220:223], v[144:147]
    ds_read_b128 v[80:83], v7 offset:20480
    v_mfma_f32_16x16x32_bf16 v[148:151], v[104:107], v[220:223], v[148:151]
    ds_read_b128 v[84:87], v7 offset:21504
    v_mfma_f32_16x16x32_bf16 v[152:155], v[108:111], v[220:223], v[152:155]
    ds_read_b128 v[88:91], v7 offset:22528
    v_mfma_f32_16x16x32_bf16 v[156:159], v[112:115], v[220:223], v[156:159]
    ds_read_b128 v[92:95], v7 offset:23552
    v_mfma_f32_16x16x32_bf16 v[160:163], v[116:119], v[220:223], v[160:163]
    ds_read_b128 v[96:99], v7 offset:24576
    s_waitcnt vmcnt(8) lgkmcnt(5)
    v_mfma_f32_16x16x32_bf16 v[144:147], v[60:63], v[224:227], v[144:147]
    ds_read_b128 v[100:103], v7 offset:25600
    v_mfma_f32_16x16x32_bf16 v[148:151], v[64:67], v[224:227], v[148:151]
    ds_read_b128 v[104:107], v7 offset:26624
    v_mfma_f32_16x16x32_bf16 v[152:155], v[68:71], v[224:227], v[152:155]
    ds_read_b128 v[108:111], v7 offset:27648
    v_mfma_f32_16x16x32_bf16 v[156:159], v[72:75], v[224:227], v[156:159]
    ds_read_b128 v[112:115], v7 offset:28672
    v_mfma_f32_16x16x32_bf16 v[160:163], v[76:79], v[224:227], v[160:163]
    ds_read_b128 v[116:119], v7 offset:29696
    s_waitcnt vmcnt(6) lgkmcnt(5)
    v_mfma_f32_16x16x32_bf16 v[144:147], v[80:83], v[228:231], v[144:147]
    ds_read_b128 v[60:63], v7 offset:30720
    v_mfma_f32_16x16x32_bf16 v[148:151], v[84:87], v[228:231], v[148:151]
    ds_read_b128 v[64:67], v7 offset:31744
    v_mfma_f32_16x16x32_bf16 v[152:155], v[88:91], v[228:231], v[152:155]
    ds_read_b128 v[68:71], v7 offset:32768
    v_mfma_f32_16x16x32_bf16 v[156:159], v[92:95], v[228:231], v[156:159]
    ds_read_b128 v[72:75], v7 offset:33792
    v_mfma_f32_16x16x32_bf16 v[160:163], v[96:99], v[228:231], v[160:163]
    ds_read_b128 v[76:79], v7 offset:34816
    s_waitcnt vmcnt(4) lgkmcnt(5)
    v_mfma_f32_16x16x32_bf16 v[144:147], v[100:103], v[232:235], v[144:147]
    ds_read_b128 v[80:83], v7 offset:35840
    v_mfma_f32_16x16x32_bf16 v[148:151], v[104:107], v[232:235], v[148:151]
    ds_read_b128 v[84:87], v7 offset:36864
    v_mfma_f32_16x16x32_bf16 v[152:155], v[108:111], v[232:235], v[152:155]
    ds_read_b128 v[88:91], v7 offset:37888
    v_mfma_f32_16x16x32_bf16 v[156:159], v[112:115], v[232:235], v[156:159]
    ds_read_b128 v[92:95], v7 offset:38912
    v_mfma_f32_16x16x32_bf16 v[160:163], v[116:119], v[232:235], v[160:163]
    ds_read_b128 v[96:99], v7 offset:39936
    s_waitcnt vmcnt(2) lgkmcnt(5)
    v_mfma_f32_16x16x32_bf16 v[144:147], v[60:63], v[236:239], v[144:147]
    v_mfma_f32_16x16x32_bf16 v[148:151], v[64:67], v[236:239], v[148:151]
    v_mfma_f32_16x16x32_bf16 v[152:155], v[68:71], v[236:239], v[152:155]
    v_mfma_f32_16x16x32_bf16 v[156:159], v[72:75], v[236:239], v[156:159]
    v_mfma_f32_16x16x32_bf16 v[160:163], v[76:79], v[236:239], v[160:163]
    s_waitcnt vmcnt(0) lgkmcnt(0)
    v_mfma_f32_16x16x32_bf16 v[144:147], v[80:83], v[240:243], v[144:147]
    v_mfma_f32_16x16x32_bf16 v[148:151], v[84:87], v[240:243], v[148:151]
    v_mfma_f32_16x16x32_bf16 v[152:155], v[88:91], v[240:243], v[152:155]
    v_mfma_f32_16x16x32_bf16 v[156:159], v[92:95], v[240:243], v[156:159]
    v_mfma_f32_16x16x32_bf16 v[160:163], v[96:99], v[240:243], v[160:163]
    s_nop 3
    v_cmp_u_f32 vcc, v144, v145
    v_cmp_u_f32 s[74:75], v146, v147
    s_nop 0
    s_or_b64 vcc, vcc, s[74:75]
    s_cbranch_scc1 Lbad_168
Lok_169:
    v_cvt_pk_bf16_f32 v16, v144, v145
    v_cvt_pk_bf16_f32 v17, v146, v147
    ds_write_b64 v11, v[16:17] offset:0
    v_cvt_pk_bf16_f32 v18, v148, v149
    v_cvt_pk_bf16_f32 v19, v150, v151
    ds_write_b64 v11, v[18:19] offset:32
    v_cvt_pk_bf16_f32 v20, v152, v153
    v_cvt_pk_bf16_f32 v21, v154, v155
    ds_write_b64 v11, v[20:21] offset:64
    v_cvt_pk_bf16_f32 v22, v156, v157
    v_cvt_pk_bf16_f32 v23, v158, v159
    ds_write_b64 v11, v[22:23] offset:96
    v_cvt_pk_bf16_f32 v24, v160, v161
    v_cvt_pk_bf16_f32 v25, v162, v163
    ds_write_b64 v11, v[24:25] offset:128
    ds_read_b128 v[28:31], v8
    ds_read_b128 v[32:35], v9
    ds_read_b128 v[36:39], v10
    s_waitcnt lgkmcnt(2)
    buffer_store_dwordx4 v[28:31], v12, s[44:47], s77 offen
    s_waitcnt lgkmcnt(1)
    buffer_store_dwordx4 v[32:35], v13, s[44:47], s77 offen
    s_mov_b32 exec_hi, 0
    s_waitcnt lgkmcnt(0)
    buffer_store_dwordx4 v[36:39], v14, s[44:47], s77 offen
Lfin:
    s_endpgm
Lcolearly:
    s_nop 4
    s_lshr_b32 s72, s68, 1
    s_and_b32 s73, s68, 1
    s_lshl_b32 s74, s73, 5
    s_add_u32 s74, s74, s72
    v_lshl_add_u32 v5, v2, 1, s74
    v_cvt_f32_u32 v5, v5
    v_mul_f32 v5, 0x3a000000, v5
    v_lshlrev_b32 v6, 3, v3
    v_cvt_f32_u32 v7, v6
    v_mul_f32 v20, v7, v5
    v_add_f32 v21, v20, v5
    v_add_f32 v22, v21, v5
    v_add_f32 v23, v22, v5
    v_add_f32 v24, v23, v5
    v_add_f32 v25, v24, v5
    v_add_f32 v26, v25, v5
    v_add_f32 v27, v26, v5
    v_sin_f32 v28, -v20
    v_cos_f32 v20, v20
    v_sin_f32 v29, -v21
    v_cos_f32 v21, v21
    v_sin_f32 v30, -v22
    v_cos_f32 v22, v22
    v_sin_f32 v31, -v23
    v_cos_f32 v23, v23
    v_sin_f32 v32, -v24
    v_cos_f32 v24, v24
    v_sin_f32 v33, -v25
    v_cos_f32 v25, v25
    v_sin_f32 v34, -v26
    v_cos_f32 v26, v26
    v_sin_f32 v35, -v27
    v_cos_f32 v27, v27
    v_add_u32 v6, s74, v6
    v_cvt_f32_u32 v6, v6
    v_lshrrev_b32 v7, 2, v2
    v_and_b32 v8, 3, v2
    v_lshl_add_u32 v8, v7, 3, v8
    v_cvt_f32_u32 v7, v8
    v_mul_f32 v9, 0x3a000000, v7
    v_add_f32 v10, 0x3b000000, v9
    v_mul_f32 v36, v6, v9
    v_add_f32 v9, v9, v9
    v_add_f32 v37, v36, v9
    v_add_f32 v38, v37, v9
    v_add_f32 v39, v38, v9
    v_mul_f32 v40, v6, v10
    v_add_f32 v10, v10, v10
    v_add_f32 v41, v40, v10
    v_add_f32 v42, v41, v10
    v_add_f32 v43, v42, v10
    v_sin_f32 v44, v36
    v_cos_f32 v36, v36
    v_sin_f32 v45, v37
    v_cos_f32 v37, v37
    v_sin_f32 v46, v38
    v_cos_f32 v38, v38
    v_sin_f32 v47, v39
    v_cos_f32 v39, v39
    v_sin_f32 v48, v40
    v_cos_f32 v40, v40
    v_sin_f32 v49, v41
    v_cos_f32 v41, v41
    v_sin_f32 v50, v42
    v_cos_f32 v42, v42
    v_sin_f32 v51, v43
    v_cos_f32 v43, v43
    s_lshr_b32 s72, s68, 1
    s_and_b32 s73, s68, 1
    v_and_b32 v8, 3, v2
    s_mul_i32 s77, s52, 20
    s_add_u32 s77, s77, s53
    s_lshl_b32 s77, s77, 1
    s_add_u32 s77, s77, s69
    s_lshl_b32 s4, s77, 1
    s_add_u32 s4, s4, s73
    s_lshl_b32 s5, s4, 8
    s_mul_i32 s74, s72, 1310720
    s_add_u32 s5, s5, s74
    s_lshl_b32 s10, s77, 13
    s_lshl_b32 s74, s68, 11
    s_add_u32 s10, s10, s74
    s_add_u32 s10, s10, 11665408
    s_mov_b32 s74, 163840
    v_mul_lo_u32 v11, v3, s74
    v_lshl_add_u32 v11, v2, 4, v11
    s_lshl_b32 s74, s69, 11
    s_lshl_b32 s76, s68, 8
    s_add_u32 s74, s74, s76
    s_add_u32 s74, s74, 114688
    v_lshlrev_b32 v5, 12, v3
    v_lshl_add_u32 v5, v2, 4, v5
    v_add_u32 v12, s74, v5
    s_lshl_b32 s75, s69, 13
    s_lshl_b32 s74, s73, 12
    s_add_u32 s74, s74, s75
    s_lshl_b32 s76, s72, 11
    s_add_u32 s74, s74, s76
    s_add_u32 s74, s74, 114688
    v_add_u32 v13, s74, v4
    s_lshl_b32 s74, s69, 7
    s_lshl_b32 s76, s68, 8
    s_add_u32 s74, s74, s76
    s_add_u32 s74, s74, 81920
    v_bfe_u32 v5, v2, 2, 1
    v_lshlrev_b32 v5, 10, v5
    v_lshrrev_b32 v6, 1, v3
    v_lshl_add_u32 v5, v6, 13, v5
    v_and_b32 v6, 1, v3
    v_lshl_add_u32 v5, v6, 11, v5
    v_lshrrev_b32 v6, 3, v2
    v_lshl_add_u32 v5, v6, 6, v5
    v_lshl_add_u32 v5, v8, 4, v5
    v_add_u32 v14, s74, v5
    v_and_b32 v5, 1, v2
    v_lshlrev_b32 v5, 4, v5
    s_movk_i32 s74, 0x3f80
    v_lshlrev_b32 v5, v5, s74
    v_cmp_gt_u32 vcc, 2, v8
    s_nop 1
    v_cndmask_b32 v16, 0, v5, vcc
    v_sub_u32 v17, v5, v16
    s_lshl_b32 s74, s72, 12
    s_add_u32 s74, s74, s75
    s_add_u32 s74, s74, 81920
    v_add_u32 v15, s74, v4
    s_lshl_b32 s76, s73, 9
    s_add_u32 s74, s74, s76
    v_lshlrev_b32 v5, 10, v6
    v_lshl_add_u32 v5, v8, 4, v5
    v_bfe_u32 v6, v2, 2, 1
    v_lshl_add_u32 v5, v6, 7, v5
    v_lshrrev_b32 v6, 1, v3
    v_lshl_add_u32 v5, v6, 8, v5
    v_and_b32 v6, 1, v3
    v_lshl_add_u32 v5, v6, 3, v5
    v_add_u32 v8, s74, v5
    s_lshl_b32 s74, s72, 10
    s_add_u32 s74, s74, s75
    s_lshl_b32 s76, s73, 11
    s_add_u32 s74, s74, s76
    s_add_u32 s74, s74, 98304
    v_add_u32 v9, s74, v4
    v_xor_b32 v10, 0x800, v9
    v_mov_b32 v18, 0x3727c5ac
    s_nop 4
    s_setpc_b64 s[70:71]
Lend:
    s_endpgm
La_127:
    v_mov_b32 v28, 0
    v_mov_b32 v29, 0
    v_mov_b32 v30, 0
    v_mov_b32 v31, 0
    v_mov_b32 v32, 0
    v_mov_b32 v33, 0
    v_mov_b32 v34, 0
    v_mov_b32 v35, 0
    v_mov_b32 v36, 0
    v_mov_b32 v37, 0
    v_mov_b32 v38, 0
    v_mov_b32 v39, 0
    v_mov_b32 v40, 0
    v_mov_b32 v41, 0
    v_mov_b32 v42, 0
    v_mov_b32 v43, 0
    v_mov_b32 v44, 0
    v_mov_b32 v45, 0
    v_mov_b32 v46, 0
    v_mov_b32 v47, 0
    v_mov_b32 v48, 0
    v_mov_b32 v49, 0
    v_mov_b32 v50, 0
    v_mov_b32 v51, 0
    v_mov_b32 v52, 0
    v_mov_b32 v53, 0
    v_mov_b32 v54, 0
    v_mov_b32 v55, 0
    v_mov_b32 v56, 0
    v_mov_b32 v57, 0
    v_mov_b32 v58, 0
    v_mov_b32 v59, 0
    v_mov_b32 v140, -1
    v_mov_b32 v141, -1
    v_mov_b32 v142, -1
    v_mov_b32 v143, -1
    buffer_store_dwordx4 v[140:143], v250, s[20:23], s18 offen sc1
    s_mov_b32 exec_hi, 0
    buffer_store_dwordx2 v[140:141], v251, s[20:23], s19 offen sc1
    s_mov_b32 exec_hi, -1
    v_lshrrev_b32 v5, 3, v0
    v_lshlrev_b32 v5, 7, v5
    v_lshl_add_u32 v5, v0, 4, v5
    s_cmp_eq_u32 s58, 0
    s_cselect_b32 s15, s0, s22
    s_cselect_b32 s16, s1, s22
    buffer_store_dwordx4 v[140:143], v5, s[20:23], s15 offen sc1
    s_add_u32 s15, s15, 16384
    s_cmp_gt_u32 s3, 1
    s_cselect_b32 s15, s22, s15
    buffer_store_dwordx4 v[140:143], v5, s[20:23], s15 offen sc1
    buffer_store_dwordx4 v[140:143], v4, s[20:23], s16 offen sc1
    s_add_u32 s16, s16, 163840
    buffer_store_dwordx4 v[140:143], v4, s[20:23], s16 offen sc1
    s_lshl_b32 s73, s68, 5
    s_add_u32 s13, s0, s73
    s_sub_u32 s13, s13, 2621440
    s_cmp_gt_u32 s69, s58
    s_cselect_b32 s13, s13, s22
    v_lshlrev_b32 v7, 8, v2
    v_lshl_add_u32 v7, v3, 3, v7
    buffer_load_dwordx2 v[164:165], v7, s[20:23], s13 offen sc1
    s_add_u32 s13, s13, 4096
    buffer_load_dwordx2 v[166:167], v7, s[20:23], s13 offen sc1
    s_add_u32 s13, s13, 4096
    buffer_load_dwordx2 v[168:169], v7, s[20:23], s13 offen sc1
    s_add_u32 s13, s13, 4096
    buffer_load_dwordx2 v[170:171], v7, s[20:23], s13 offen sc1
    s_add_u32 s13, s13, 4096
    buffer_load_dwordx2 v[172:173], v7, s[20:23], s13 offen sc1
    s_add_u32 s13, s13, 4096
    v_mov_b32 v140, 0xff800000
    v_mov_b32 v141, 0xff800000
    s_waitcnt vmcnt(0)
    s_mov_b32 s80, 0
Lsl_170:
    s_barrier
    s_mul_i32 s81, s80, 20480
    s_add_u32 m0, s85, 20480
    s_add_u32 s81, s81, s86
    buffer_load_dwordx4 v4, s[20:23], s81 offen sc1 lds
    buffer_load_dwordx4 v4, s[20:23], s81 offen offset:1024 sc1 lds
    s_mov_b32 exec_hi, 0
    buffer_load_dwordx4 v4, s[20:23], s81 offen offset:2048 sc1 lds
    s_mov_b32 exec_hi, -1
    s_add_u32 s80, s80, 1
    s_and_b32 s80, s80, 7
    s_waitcnt vmcnt(0)
    s_barrier
    ds_read_b128 v[108:111], v25 offset:20480
    ds_read_b64 v[116:117], v26 offset:20480
    s_waitcnt lgkmcnt(0)
    v_mfma_f32_32x32x16_bf16 v[60:75], v[108:111], v[8:11], 0
    v_mfma_f32_32x32x8_bf16 v[60:75], v[116:117], v[16:17], v[60:75]
    s_nop 11
    v_max3_f32 v140, v140, v60, v61
    v_max3_f32 v140, v140, v62, v63
    v_max3_f32 v140, v140, v64, v65
    v_max3_f32 v140, v140, v66, v67
    v_max3_f32 v140, v140, v68, v69
    v_max3_f32 v140, v140, v70, v71
    v_max3_f32 v140, v140, v72, v73
    v_max3_f32 v140, v140, v74, v75
    v_mfma_f32_32x32x16_bf16 v[76:91], v[108:111], v[12:15], 0
    v_mfma_f32_32x32x8_bf16 v[76:91], v[116:117], v[20:21], v[76:91]
    s_nop 11
    v_max3_f32 v141, v141, v76, v77
    v_max3_f32 v141, v141, v78, v79
    v_max3_f32 v141, v141, v80, v81
    v_max3_f32 v141, v141, v82, v83
    v_max3_f32 v141, v141, v84, v85
    v_max3_f32 v141, v141, v86, v87
    v_max3_f32 v141, v141, v88, v89
    v_max3_f32 v141, v141, v90, v91
    ds_read_b128 v[112:115], v25 offset:22784
    s_waitcnt lgkmcnt(0)
    v_mfma_f32_32x32x16_bf16 v[92:107], v[112:115], v[8:11], 0
    v_mfma_f32_32x32x8_bf16 v[92:107], v[116:117], v[18:19], v[92:107]
    s_nop 11
    v_max3_f32 v140, v140, v92, v93
    v_max3_f32 v140, v140, v94, v95
    v_max3_f32 v140, v140, v96, v97
    v_max3_f32 v140, v140, v98, v99
    v_max3_f32 v140, v140, v100, v101
    v_max3_f32 v140, v140, v102, v103
    v_max3_f32 v140, v140, v104, v105
    v_max3_f32 v140, v140, v106, v107
    v_mfma_f32_32x32x16_bf16 v[60:75], v[112:115], v[12:15], 0
    v_mfma_f32_32x32x8_bf16 v[60:75], v[116:117], v[22:23], v[60:75]
    s_nop 11
    v_max3_f32 v141, v141, v60, v61
    v_max3_f32 v141, v141, v62, v63
    v_max3_f32 v141, v141, v64, v65
    v_max3_f32 v141, v141, v66, v67
    v_max3_f32 v141, v141, v68, v69
    v_max3_f32 v141, v141, v70, v71
    v_max3_f32 v141, v141, v72, v73
    v_max3_f32 v141, v141, v74, v75
    ds_read_b128 v[108:111], v25 offset:25088
    ds_read_b64 v[118:119], v26 offset:20992
    s_waitcnt lgkmcnt(0)
    v_mfma_f32_32x32x16_bf16 v[76:91], v[108:111], v[8:11], 0
    v_mfma_f32_32x32x8_bf16 v[76:91], v[118:119], v[16:17], v[76:91]
    s_nop 11
    v_max3_f32 v140, v140, v76, v77
    v_max3_f32 v140, v140, v78, v79
    v_max3_f32 v140, v140, v80, v81
    v_max3_f32 v140, v140, v82, v83
    v_max3_f32 v140, v140, v84, v85
    v_max3_f32 v140, v140, v86, v87
    v_max3_f32 v140, v140, v88, v89
    v_max3_f32 v140, v140, v90, v91
    v_mfma_f32_32x32x16_bf16 v[92:107], v[108:111], v[12:15], 0
    v_mfma_f32_32x32x8_bf16 v[92:107], v[118:119], v[20:21], v[92:107]
    s_nop 11
    v_max3_f32 v141, v141, v92, v93
    v_max3_f32 v141, v141, v94, v95
    v_max3_f32 v141, v141, v96, v97
    v_max3_f32 v141, v141, v98, v99
    v_max3_f32 v141, v141, v100, v101
    v_max3_f32 v141, v141, v102, v103
    v_max3_f32 v141, v141, v104, v105
    v_max3_f32 v141, v141, v106, v107
    ds_read_b128 v[112:115], v25 offset:27392
    s_waitcnt lgkmcnt(0)
    v_mfma_f32_32x32x16_bf16 v[60:75], v[112:115], v[8:11], 0
    v_mfma_f32_32x32x8_bf16 v[60:75], v[118:119], v[18:19], v[60:75]
    s_nop 11
    v_max3_f32 v140, v140, v60, v61
    v_max3_f32 v140, v140, v62, v63
    v_max3_f32 v140, v140, v64, v65
    v_max3_f32 v140, v140, v66, v67
    v_max3_f32 v140, v140, v68, v69
    v_max3_f32 v140, v140, v70, v71
    v_max3_f32 v140, v140, v72, v73
    v_max3_f32 v140, v140, v74, v75
    v_mfma_f32_32x32x16_bf16 v[76:91], v[112:115], v[12:15], 0
    v_mfma_f32_32x32x8_bf16 v[76:91], v[118:119], v[22:23], v[76:91]
    s_nop 11
    v_max3_f32 v141, v141, v76, v77
    v_max3_f32 v141, v141, v78, v79
    v_max3_f32 v141, v141, v80, v81
    v_max3_f32 v141, v141, v82, v83
    v_max3_f32 v141, v141, v84, v85
    v_max3_f32 v141, v141, v86, v87
    v_max3_f32 v141, v141, v88, v89
    v_max3_f32 v141, v141, v90, v91
    s_cmp_lg_u32 s80, 0
    s_cbranch_scc1 Lsl_170
    v_lshlrev_b32 v5, 3, v0
    v_xor_b32 v6, 0x800, v5
    v_add_u32 v5, 143360, v5
    v_add_u32 v6, 143360, v6
    ds_write_b64 v5, v[140:141]
    s_waitcnt lgkmcnt(0)
    s_barrier
    ds_read_b64 v[142:143], v6
    s_waitcnt lgkmcnt(0)
    v_max_f32 v140, v140, v143
    v_mov_b32 v5, v140
    s_nop 1
    v_permlane32_swap_b32 v5, v140
    v_max_f32 v140, v5, v140
    v_max_f32 v141, v141, v142
    v_mov_b32 v5, v141
    s_nop 1
    v_permlane32_swap_b32 v5, v141
    v_max_f32 v141, v5, v141
    s_mov_b32 s80, 0
Lsl_171:
    s_barrier
    s_mul_i32 s81, s80, 20480
    s_add_u32 m0, s85, 20480
    s_add_u32 s81, s81, s86
    buffer_load_dwordx4 v4, s[20:23], s81 offen sc1 lds
    buffer_load_dwordx4 v4, s[20:23], s81 offen offset:1024 sc1 lds
    s_mov_b32 exec_hi, 0
    buffer_load_dwordx4 v4, s[20:23], s81 offen offset:2048 sc1 lds
    s_mov_b32 exec_hi, -1
    s_add_u32 s80, s80, 1
    s_and_b32 s80, s80, 7
    s_waitcnt vmcnt(0)
    s_barrier
    ds_read_b128 v[108:111], v25 offset:20480
    ds_read_b64 v[116:117], v26 offset:20480
    s_mov_b64 exec, s[4:5]
    ds_read_b128 v[124:127], v27 offset:20480
    ds_read_b128 v[128:131], v27 offset:21120
    s_mov_b64 exec, -1
    s_waitcnt lgkmcnt(0)
    v_mfma_f32_32x32x16_bf16 v[60:75], v[108:111], v[8:11], 0
    v_mfma_f32_32x32x8_bf16 v[60:75], v[116:117], v[16:17], v[60:75]
    s_nop 11
    v_sub_f32 v60, v60, v140
    v_sub_f32 v61, v61, v140
    v_sub_f32 v62, v62, v140
    v_sub_f32 v63, v63, v140
    v_sub_f32 v64, v64, v140
    v_sub_f32 v65, v65, v140
    v_sub_f32 v66, v66, v140
    v_sub_f32 v67, v67, v140
    v_sub_f32 v68, v68, v140
    v_sub_f32 v69, v69, v140
    v_sub_f32 v70, v70, v140
    v_sub_f32 v71, v71, v140
    v_sub_f32 v72, v72, v140
    v_sub_f32 v73, v73, v140
    v_sub_f32 v74, v74, v140
    v_sub_f32 v75, v75, v140
    v_exp_f32 v60, v60
    v_exp_f32 v61, v61
    v_exp_f32 v62, v62
    v_exp_f32 v63, v63
    v_exp_f32 v64, v64
    v_exp_f32 v65, v65
    v_exp_f32 v66, v66
    v_exp_f32 v67, v67
    v_exp_f32 v68, v68
    v_exp_f32 v69, v69
    v_exp_f32 v70, v70
    v_exp_f32 v71, v71
    v_exp_f32 v72, v72
    v_exp_f32 v73, v73
    v_exp_f32 v74, v74
    v_exp_f32 v75, v75
    v_smfmac_f32_32x32x32_bf16 v[28:43], v[124:127], v[60:67], v24
    s_nop 0
    v_smfmac_f32_32x32x32_bf16 v[28:43], v[128:131], v[68:75], v24
    v_mfma_f32_32x32x16_bf16 v[76:91], v[108:111], v[12:15], 0
    v_mfma_f32_32x32x8_bf16 v[76:91], v[116:117], v[20:21], v[76:91]
    s_nop 11
    v_sub_f32 v76, v76, v141
    v_sub_f32 v77, v77, v141
    v_sub_f32 v78, v78, v141
    v_sub_f32 v79, v79, v141
    v_sub_f32 v80, v80, v141
    v_sub_f32 v81, v81, v141
    v_sub_f32 v82, v82, v141
    v_sub_f32 v83, v83, v141
    v_sub_f32 v84, v84, v141
    v_sub_f32 v85, v85, v141
    v_sub_f32 v86, v86, v141
    v_sub_f32 v87, v87, v141
    v_sub_f32 v88, v88, v141
    v_sub_f32 v89, v89, v141
    v_sub_f32 v90, v90, v141
    v_sub_f32 v91, v91, v141
    v_exp_f32 v76, v76
    v_exp_f32 v77, v77
    v_exp_f32 v78, v78
    v_exp_f32 v79, v79
    v_exp_f32 v80, v80
    v_exp_f32 v81, v81
    v_exp_f32 v82, v82
    v_exp_f32 v83, v83
    v_exp_f32 v84, v84
    v_exp_f32 v85, v85
    v_exp_f32 v86, v86
    v_exp_f32 v87, v87
    v_exp_f32 v88, v88
    v_exp_f32 v89, v89
    v_exp_f32 v90, v90
    v_exp_f32 v91, v91
    v_smfmac_f32_32x32x32_bf16 v[44:59], v[124:127], v[76:83], v24
    s_nop 0
    v_smfmac_f32_32x32x32_bf16 v[44:59], v[128:131], v[84:91], v24
    ds_read_b128 v[112:115], v25 offset:22784
    s_mov_b64 exec, s[4:5]
    ds_read_b128 v[132:135], v27 offset:22784
    ds_read_b128 v[136:139], v27 offset:23424
    s_mov_b64 exec, -1
    s_waitcnt lgkmcnt(0)
    v_mfma_f32_32x32x16_bf16 v[92:107], v[112:115], v[8:11], 0
    v_mfma_f32_32x32x8_bf16 v[92:107], v[116:117], v[18:19], v[92:107]
    s_nop 11
    v_sub_f32 v92, v92, v140
    v_sub_f32 v93, v93, v140
    v_sub_f32 v94, v94, v140
    v_sub_f32 v95, v95, v140
    v_sub_f32 v96, v96, v140
    v_sub_f32 v97, v97, v140
    v_sub_f32 v98, v98, v140
    v_sub_f32 v99, v99, v140
    v_sub_f32 v100, v100, v140
    v_sub_f32 v101, v101, v140
    v_sub_f32 v102, v102, v140
    v_sub_f32 v103, v103, v140
    v_sub_f32 v104, v104, v140
    v_sub_f32 v105, v105, v140
    v_sub_f32 v106, v106, v140
    v_sub_f32 v107, v107, v140
    v_exp_f32 v92, v92
    v_exp_f32 v93, v93
    v_exp_f32 v94, v94
    v_exp_f32 v95, v95
    v_exp_f32 v96, v96
    v_exp_f32 v97, v97
    v_exp_f32 v98, v98
    v_exp_f32 v99, v99
    v_exp_f32 v100, v100
    v_exp_f32 v101, v101
    v_exp_f32 v102, v102
    v_exp_f32 v103, v103
    v_exp_f32 v104, v104
    v_exp_f32 v105, v105
    v_exp_f32 v106, v106
    v_exp_f32 v107, v107
    v_smfmac_f32_32x32x32_bf16 v[28:43], v[132:135], v[92:99], v24
    s_nop 0
    v_smfmac_f32_32x32x32_bf16 v[28:43], v[136:139], v[100:107], v24
    v_mfma_f32_32x32x16_bf16 v[60:75], v[112:115], v[12:15], 0
    v_mfma_f32_32x32x8_bf16 v[60:75], v[116:117], v[22:23], v[60:75]
    s_nop 11
    v_sub_f32 v60, v60, v141
    v_sub_f32 v61, v61, v141
    v_sub_f32 v62, v62, v141
    v_sub_f32 v63, v63, v141
    v_sub_f32 v64, v64, v141
    v_sub_f32 v65, v65, v141
    v_sub_f32 v66, v66, v141
    v_sub_f32 v67, v67, v141
    v_sub_f32 v68, v68, v141
    v_sub_f32 v69, v69, v141
    v_sub_f32 v70, v70, v141
    v_sub_f32 v71, v71, v141
    v_sub_f32 v72, v72, v141
    v_sub_f32 v73, v73, v141
    v_sub_f32 v74, v74, v141
    v_sub_f32 v75, v75, v141
    v_exp_f32 v60, v60
    v_exp_f32 v61, v61
    v_exp_f32 v62, v62
    v_exp_f32 v63, v63
    v_exp_f32 v64, v64
    v_exp_f32 v65, v65
    v_exp_f32 v66, v66
    v_exp_f32 v67, v67
    v_exp_f32 v68, v68
    v_exp_f32 v69, v69
    v_exp_f32 v70, v70
    v_exp_f32 v71, v71
    v_exp_f32 v72, v72
    v_exp_f32 v73, v73
    v_exp_f32 v74, v74
    v_exp_f32 v75, v75
    v_smfmac_f32_32x32x32_bf16 v[44:59], v[132:135], v[60:67], v24
    s_nop 0
    v_smfmac_f32_32x32x32_bf16 v[44:59], v[136:139], v[68:75], v24
    ds_read_b128 v[108:111], v25 offset:25088
    ds_read_b64 v[118:119], v26 offset:20992
    s_mov_b64 exec, s[4:5]
    ds_read_b128 v[124:127], v27 offset:25088
    ds_read_b128 v[128:131], v27 offset:25728
    s_mov_b64 exec, -1
    s_waitcnt lgkmcnt(0)
    v_mfma_f32_32x32x16_bf16 v[76:91], v[108:111], v[8:11], 0
    v_mfma_f32_32x32x8_bf16 v[76:91], v[118:119], v[16:17], v[76:91]
    s_nop 11
    v_sub_f32 v76, v76, v140
    v_sub_f32 v77, v77, v140
    v_sub_f32 v78, v78, v140
    v_sub_f32 v79, v79, v140
    v_sub_f32 v80, v80, v140
    v_sub_f32 v81, v81, v140
    v_sub_f32 v82, v82, v140
    v_sub_f32 v83, v83, v140
    v_sub_f32 v84, v84, v140
    v_sub_f32 v85, v85, v140
    v_sub_f32 v86, v86, v140
    v_sub_f32 v87, v87, v140
    v_sub_f32 v88, v88, v140
    v_sub_f32 v89, v89, v140
    v_sub_f32 v90, v90, v140
    v_sub_f32 v91, v91, v140
    v_exp_f32 v76, v76
    v_exp_f32 v77, v77
    v_exp_f32 v78, v78
    v_exp_f32 v79, v79
    v_exp_f32 v80, v80
    v_exp_f32 v81, v81
    v_exp_f32 v82, v82
    v_exp_f32 v83, v83
    v_exp_f32 v84, v84
    v_exp_f32 v85, v85
    v_exp_f32 v86, v86
    v_exp_f32 v87, v87
    v_exp_f32 v88, v88
    v_exp_f32 v89, v89
    v_exp_f32 v90, v90
    v_exp_f32 v91, v91
    v_smfmac_f32_32x32x32_bf16 v[28:43], v[124:127], v[76:83], v24
    s_nop 0
    v_smfmac_f32_32x32x32_bf16 v[28:43], v[128:131], v[84:91], v24
    v_mfma_f32_32x32x16_bf16 v[92:107], v[108:111], v[12:15], 0
    v_mfma_f32_32x32x8_bf16 v[92:107], v[118:119], v[20:21], v[92:107]
    s_nop 11
    v_sub_f32 v92, v92, v141
    v_sub_f32 v93, v93, v141
    v_sub_f32 v94, v94, v141
    v_sub_f32 v95, v95, v141
    v_sub_f32 v96, v96, v141
    v_sub_f32 v97, v97, v141
    v_sub_f32 v98, v98, v141
    v_sub_f32 v99, v99, v141
    v_sub_f32 v100, v100, v141
    v_sub_f32 v101, v101, v141
    v_sub_f32 v102, v102, v141
    v_sub_f32 v103, v103, v141
    v_sub_f32 v104, v104, v141
    v_sub_f32 v105, v105, v141
    v_sub_f32 v106, v106, v141
    v_sub_f32 v107, v107, v141
    v_exp_f32 v92, v92
    v_exp_f32 v93, v93
    v_exp_f32 v94, v94
    v_exp_f32 v95, v95
    v_exp_f32 v96, v96
    v_exp_f32 v97, v97
    v_exp_f32 v98, v98
    v_exp_f32 v99, v99
    v_exp_f32 v100, v100
    v_exp_f32 v101, v101
    v_exp_f32 v102, v102
    v_exp_f32 v103, v103
    v_exp_f32 v104, v104
    v_exp_f32 v105, v105
    v_exp_f32 v106, v106
    v_exp_f32 v107, v107
    v_smfmac_f32_32x32x32_bf16 v[44:59], v[124:127], v[92:99], v24
    s_nop 0
    v_smfmac_f32_32x32x32_bf16 v[44:59], v[128:131], v[100:107], v24
    ds_read_b128 v[112:115], v25 offset:27392
    s_mov_b64 exec, s[4:5]
    ds_read_b128 v[132:135], v27 offset:27392
    ds_read_b128 v[136:139], v27 offset:28032
    s_mov_b64 exec, -1
    s_waitcnt lgkmcnt(0)
    v_mfma_f32_32x32x16_bf16 v[60:75], v[112:115], v[8:11], 0
    v_mfma_f32_32x32x8_bf16 v[60:75], v[118:119], v[18:19], v[60:75]
    s_nop 11
    v_sub_f32 v60, v60, v140
    v_sub_f32 v61, v61, v140
    v_sub_f32 v62, v62, v140
    v_sub_f32 v63, v63, v140
    v_sub_f32 v64, v64, v140
    v_sub_f32 v65, v65, v140
    v_sub_f32 v66, v66, v140
    v_sub_f32 v67, v67, v140
    v_sub_f32 v68, v68, v140
    v_sub_f32 v69, v69, v140
    v_sub_f32 v70, v70, v140
    v_sub_f32 v71, v71, v140
    v_sub_f32 v72, v72, v140
    v_sub_f32 v73, v73, v140
    v_sub_f32 v74, v74, v140
    v_sub_f32 v75, v75, v140
    v_exp_f32 v60, v60
    v_exp_f32 v61, v61
    v_exp_f32 v62, v62
    v_exp_f32 v63, v63
    v_exp_f32 v64, v64
    v_exp_f32 v65, v65
    v_exp_f32 v66, v66
    v_exp_f32 v67, v67
    v_exp_f32 v68, v68
    v_exp_f32 v69, v69
    v_exp_f32 v70, v70
    v_exp_f32 v71, v71
    v_exp_f32 v72, v72
    v_exp_f32 v73, v73
    v_exp_f32 v74, v74
    v_exp_f32 v75, v75
    v_smfmac_f32_32x32x32_bf16 v[28:43], v[132:135], v[60:67], v24
    s_nop 0
    v_smfmac_f32_32x32x32_bf16 v[28:43], v[136:139], v[68:75], v24
    v_mfma_f32_32x32x16_bf16 v[76:91], v[112:115], v[12:15], 0
    v_mfma_f32_32x32x8_bf16 v[76:91], v[118:119], v[22:23], v[76:91]
    s_nop 11
    v_sub_f32 v76, v76, v141
    v_sub_f32 v77, v77, v141
    v_sub_f32 v78, v78, v141
    v_sub_f32 v79, v79, v141
    v_sub_f32 v80, v80, v141
    v_sub_f32 v81, v81, v141
    v_sub_f32 v82, v82, v141
    v_sub_f32 v83, v83, v141
    v_sub_f32 v84, v84, v141
    v_sub_f32 v85, v85, v141
    v_sub_f32 v86, v86, v141
    v_sub_f32 v87, v87, v141
    v_sub_f32 v88, v88, v141
    v_sub_f32 v89, v89, v141
    v_sub_f32 v90, v90, v141
    v_sub_f32 v91, v91, v141
    v_exp_f32 v76, v76
    v_exp_f32 v77, v77
    v_exp_f32 v78, v78
    v_exp_f32 v79, v79
    v_exp_f32 v80, v80
    v_exp_f32 v81, v81
    v_exp_f32 v82, v82
    v_exp_f32 v83, v83
    v_exp_f32 v84, v84
    v_exp_f32 v85, v85
    v_exp_f32 v86, v86
    v_exp_f32 v87, v87
    v_exp_f32 v88, v88
    v_exp_f32 v89, v89
    v_exp_f32 v90, v90
    v_exp_f32 v91, v91
    v_smfmac_f32_32x32x32_bf16 v[44:59], v[132:135], v[76:83], v24
    s_nop 0
    v_smfmac_f32_32x32x32_bf16 v[44:59], v[136:139], v[84:91], v24
    s_cmp_lg_u32 s80, 0
    s_cbranch_scc1 Lsl_171
    s_mov_b32 m0, s8
    s_add_u32 s8, s8, 1024
    buffer_load_dwordx4 v4, s[20:23], s9 offen sc1 lds
    s_add_u32 s9, s9, 1024
    s_mov_b32 m0, s8
    s_add_u32 s8, s8, 1024
    buffer_load_dwordx4 v4, s[20:23], s9 offen sc1 lds
    s_add_u32 s9, s9, 1024
    s_mov_b32 m0, s8
    s_add_u32 s8, s8, 1024
    buffer_load_dwordx4 v4, s[20:23], s9 offen sc1 lds
    s_add_u32 s9, s9, 1024
    s_mov_b32 m0, s8
    s_add_u32 s8, s8, 1024
    buffer_load_dwordx4 v4, s[20:23], s9 offen sc1 lds
    s_add_u32 s9, s9, 1024
    s_mov_b32 m0, s8
    s_add_u32 s8, s8, 1024
    buffer_load_dwordx4 v4, s[20:23], s9 offen sc1 lds
    s_add_u32 s9, s9, 1024
    s_mov_b32 m0, s8
    s_add_u32 s8, s8, 1024
    buffer_load_dwordx4 v4, s[20:23], s9 offen sc1 lds
    s_add_u32 s9, s9, 1024
    s_mov_b32 m0, s8
    s_add_u32 s8, s8, 1024
    buffer_load_dwordx4 v4, s[20:23], s9 offen sc1 lds
    s_add_u32 s9, s9, 1024
    s_mov_b32 m0, s8
    s_add_u32 s8, s8, 1024
    buffer_load_dwordx4 v4, s[20:23], s9 offen sc1 lds
    s_add_u32 s9, s9, 1024
    s_mov_b32 m0, s8
    s_add_u32 s8, s8, 1024
    buffer_load_dwordx4 v4, s[20:23], s9 offen sc1 lds
    s_add_u32 s9, s9, 1024
    s_mov_b32 m0, s8
    s_add_u32 s8, s8, 1024
    buffer_load_dwordx4 v4, s[20:23], s9 offen sc1 lds
    s_add_u32 s9, s9, 1024
    s_mov_b32 m0, s8
    s_add_u32 s8, s8, 1024
    buffer_load_dwordx4 v4, s[20:23], s9 offen sc1 lds
    s_add_u32 s9, s9, 1024
    s_mov_b32 m0, s8
    s_add_u32 s8, s8, 1024
    buffer_load_dwordx4 v4, s[20:23], s9 offen sc1 lds
    s_add_u32 s9, s9, 1024
    s_mov_b32 m0, s8
    s_add_u32 s8, s8, 512
    s_mov_b32 exec_hi, 0
    buffer_load_dwordx4 v4, s[20:23], s9 offen sc1 lds
    s_mov_b32 exec_hi, -1
    s_add_u32 s9, s9, 512
    s_barrier
    s_branch La_128
Lb_39:
    v_mov_b32 v60, 0
    v_mov_b32 v61, 0
    v_mov_b32 v62, 0
    v_mov_b32 v63, 0
    v_mov_b32 v64, 0
    v_mov_b32 v65, 0
    v_mov_b32 v66, 0
    v_mov_b32 v67, 0
    v_mov_b32 v68, 0
    v_mov_b32 v69, 0
    v_mov_b32 v70, 0
    v_mov_b32 v71, 0
    s_branch Lb_40
Lbad_84:
    s_mov_b32 s88, 65536
Lbad_86:
    buffer_load_dwordx4 v[220:223], v4, s[20:23], s16 offen offset:0 sc1
    buffer_load_dwordx4 v[224:227], v4, s[20:23], s16 offen offset:1024 sc1
    buffer_load_dwordx4 v[228:231], v4, s[20:23], s16 offen offset:2048 sc1
    s_sub_u32 s88, s88, 1
    s_waitcnt vmcnt(0)
    s_cbranch_scc1 Lok_85
    v_max3_u32 v5, v220, v221, v222
    v_max3_u32 v5, v5, v223, v224
    v_max3_u32 v5, v5, v225, v226
    v_max3_u32 v5, v5, v227, v228
    v_max3_u32 v5, v5, v229, v230
    v_max_u32 v5, v5, v231
    v_cmp_eq_u32 vcc, -1, v5
    s_nop 4
    s_cbranch_vccnz Lbad_86
    s_branch Lok_85
Lbad_113:
    s_mov_b32 s88, 65536
Lbad_115:
    buffer_load_dwordx4 v[60:63], v4, s[20:23], s13 offen offset:0 sc1
    buffer_load_dwordx4 v[64:67], v4, s[20:23], s13 offen offset:1024 sc1
    buffer_load_dwordx4 v[68:71], v4, s[20:23], s13 offen offset:2048 sc1
    buffer_load_dwordx4 v[72:75], v4, s[20:23], s13 offen offset:3072 sc1
    s_sub_u32 s88, s88, 1
    s_waitcnt vmcnt(0)
    s_cbranch_scc1 Lok_114
    v_min3_u32 v5, v60, v61, v62
    v_min3_u32 v5, v5, v63, v64
    v_min3_u32 v5, v5, v65, v66
    v_min3_u32 v5, v5, v67, v68
    v_min3_u32 v5, v5, v69, v70
    v_min3_u32 v5, v5, v71, v72
    v_min3_u32 v5, v5, v73, v74
    v_min_u32 v5, v5, v75
    v_cmp_eq_u32 vcc, 0, v5
    s_nop 4
    s_cbranch_vccnz Lbad_115
    s_branch Lok_114
Lredo_130:
    s_cmp_lg_u32 s14, 0
    s_cbranch_scc1 Lredo_131
    s_mov_b32 s14, 1
    s_mov_b32 s88, 4096
Lredo_132:
    s_mul_i32 s72, s94, 327680
    s_add_u32 s72, s72, s62
    s_mul_i32 s73, s3, 40960
    s_add_u32 s72, s72, s73
    s_add_u32 s73, s72, 40960
    v_mov_b32 v5, 0
Lredo_133:
    buffer_load_dwordx4 v[60:63], v4, s[20:23], s72 offen sc1
    s_add_u32 s72, s72, 1024
    s_cmp_lt_u32 s72, s73
    s_waitcnt vmcnt(0)
    v_max3_u32 v5, v5, v60, v61
    v_max3_u32 v5, v5, v62, v63
    s_cbranch_scc1 Lredo_133
    v_cmp_eq_u32 vcc, -1, v5
    s_sub_u32 s88, s88, 1
    s_cselect_b64 vcc, 0, vcc
    s_nop 2
    s_cbranch_vccnz Lredo_132
    s_waitcnt lgkmcnt(0)
    s_barrier
    s_branch Lqkv
Lbad_147:
    buffer_load_dwordx4 v[140:143], v245, s[20:23], s76 offen sc1
    s_sub_u32 s88, s88, 1
    s_waitcnt vmcnt(0)
    s_cbranch_scc1 Lok_148
    v_min3_u32 v7, v140, v141, v142
    v_min_u32 v7, v7, v143
    v_cmp_eq_u32 vcc, 0, v7
    s_nop 4
    s_cbranch_vccnz Lbad_147
    s_branch Lok_148
Lbad_161:
    v_max3_u32 v5, v164, v165, v166
    v_max3_u32 v5, v5, v167, v168
    v_max3_u32 v5, v5, v169, v170
    v_max3_u32 v5, v5, v171, v172
    v_max3_u32 v5, v5, v173, v174
    v_max3_u32 v5, v5, v175, v176
    v_max3_u32 v5, v5, v177, v178
    v_max3_u32 v5, v5, v179, v180
    v_max3_u32 v5, v5, v181, v182
    v_max3_u32 v5, v5, v183, v184
    v_max3_u32 v5, v5, v185, v186
    v_max3_u32 v5, v5, v187, v188
    v_max3_u32 v5, v5, v189, v190
    v_max3_u32 v5, v5, v191, v192
    v_max3_u32 v5, v5, v193, v194
    v_max3_u32 v5, v5, v195, v196
    v_max3_u32 v5, v5, v197, v198
    v_max3_u32 v5, v5, v199, v200
    v_max3_u32 v5, v5, v201, v202
    v_max3_u32 v5, v5, v203, v204
    v_max3_u32 v5, v5, v205, v206
    v_max3_u32 v5, v5, v207, v208
    v_max3_u32 v5, v5, v209, v210
    v_max3_u32 v5, v5, v211, v212
    v_max3_u32 v5, v5, v213, v214
    v_max3_u32 v5, v5, v215, v216
    v_max3_u32 v5, v5, v217, v218
    v_max3_u32 v5, v5, v219, v220
    v_max3_u32 v5, v5, v221, v222
    v_max3_u32 v5, v5, v223, v224
    v_max3_u32 v5, v5, v225, v226
    v_max3_u32 v5, v5, v227, v228
    v_max3_u32 v5, v5, v229, v230
    v_max3_u32 v5, v5, v231, v232
    v_max3_u32 v5, v5, v233, v234
    v_max3_u32 v5, v5, v235, v236
    v_max3_u32 v5, v5, v237, v238
    v_max3_u32 v5, v5, v239, v240
    v_max3_u32 v5, v5, v241, v242
    v_max_u32 v5, v5, v243
    v_cmp_eq_u32 vcc, -1, v5
    s_nop 4
    s_cbranch_vccz Lok_162
    s_sub_u32 s88, s88, 1
    s_cbranch_scc1 Lok_162
    s_mov_b32 s72, s78
    s_mov_b32 s73, s79
    v_mov_b32 v144, v120
    v_mov_b32 v145, v121
    v_mov_b32 v146, v122
    v_mov_b32 v147, v123
    v_mov_b32 v148, v124
    v_mov_b32 v149, v125
    v_mov_b32 v150, v126
    v_mov_b32 v151, v127
    v_mov_b32 v152, v128
    v_mov_b32 v153, v129
    v_mov_b32 v154, v130
    v_mov_b32 v155, v131
    v_mov_b32 v156, v132
    v_mov_b32 v157, v133
    v_mov_b32 v158, v134
    v_mov_b32 v159, v135
    v_mov_b32 v160, v136
    v_mov_b32 v161, v137
    v_mov_b32 v162, v138
    v_mov_b32 v163, v139
    s_branch Lo_160
Lbad_168:
    v_max3_u32 v5, v164, v165, v166
    v_max3_u32 v5, v5, v167, v168
    v_max3_u32 v5, v5, v169, v170
    v_max3_u32 v5, v5, v171, v172
    v_max3_u32 v5, v5, v173, v174
    v_max3_u32 v5, v5, v175, v176
    v_max3_u32 v5, v5, v177, v178
    v_max3_u32 v5, v5, v179, v180
    v_max3_u32 v5, v5, v181, v182
    v_max3_u32 v5, v5, v183, v184
    v_max3_u32 v5, v5, v185, v186
    v_max3_u32 v5, v5, v187, v188
    v_max3_u32 v5, v5, v189, v190
    v_max3_u32 v5, v5, v191, v192
    v_max3_u32 v5, v5, v193, v194
    v_max3_u32 v5, v5, v195, v196
    v_max3_u32 v5, v5, v197, v198
    v_max3_u32 v5, v5, v199, v200
    v_max3_u32 v5, v5, v201, v202
    v_max3_u32 v5, v5, v203, v204
    v_max3_u32 v5, v5, v205, v206
    v_max3_u32 v5, v5, v207, v208
    v_max3_u32 v5, v5, v209, v210
    v_max3_u32 v5, v5, v211, v212
    v_max3_u32 v5, v5, v213, v214
    v_max3_u32 v5, v5, v215, v216
    v_max3_u32 v5, v5, v217, v218
    v_max3_u32 v5, v5, v219, v220
    v_max3_u32 v5, v5, v221, v222
    v_max3_u32 v5, v5, v223, v224
    v_max3_u32 v5, v5, v225, v226
    v_max3_u32 v5, v5, v227, v228
    v_max3_u32 v5, v5, v229, v230
    v_max3_u32 v5, v5, v231, v232
    v_max3_u32 v5, v5, v233, v234
    v_max3_u32 v5, v5, v235, v236
    v_max3_u32 v5, v5, v237, v238
    v_max3_u32 v5, v5, v239, v240
    v_max3_u32 v5, v5, v241, v242
    v_max_u32 v5, v5, v243
    v_cmp_eq_u32 vcc, -1, v5
    s_nop 4
    s_cbranch_vccz Lok_169
    s_sub_u32 s88, s88, 1
    s_cbranch_scc1 Lok_169
    s_mov_b32 s72, s78
    s_mov_b32 s73, s79
    v_mov_b32 v144, v120
    v_mov_b32 v145, v121
    v_mov_b32 v146, v122
    v_mov_b32 v147, v123
    v_mov_b32 v148, v124
    v_mov_b32 v149, v125
    v_mov_b32 v150, v126
    v_mov_b32 v151, v127
    v_mov_b32 v152, v128
    v_mov_b32 v153, v129
    v_mov_b32 v154, v130
    v_mov_b32 v155, v131
    v_mov_b32 v156, v132
    v_mov_b32 v157, v133
    v_mov_b32 v158, v134
    v_mov_b32 v159, v135
    v_mov_b32 v160, v136
    v_mov_b32 v161, v137
    v_mov_b32 v162, v138
    v_mov_b32 v163, v139
    s_branch Lo_167
.section .rodata,"a"
.p2align 6
.amdhsa_kernel interleave_layers__spectral_gfnet__mha_block__prompt_kernel
  .amdhsa_next_free_vgpr 256
  .amdhsa_next_free_sgpr 102
  .amdhsa_accum_offset 256
  .amdhsa_group_segment_fixed_size 0
  .amdhsa_kernarg_size 72
  .amdhsa_user_sgpr_count 2
  .amdhsa_user_sgpr_kernarg_segment_ptr 1
  .amdhsa_system_sgpr_workgroup_id_x 1
.end_amdhsa_kernel
```
